```python
import torch

def _softmax(x, axis=-1):
    return torch.softmax(x, dim=axis)

def _gelu(x):
    return torch.nn.functional.gelu(x, approximate='tanh')

def _silu(x):
    return torch.nn.functional.silu(x)

def _sigmoid(x):
    return torch.sigmoid(x)

def _layernorm(x, axis=-1, eps=1e-05):
    m = x.mean(dim=axis, keepdim=True)
    v = x.var(dim=axis, keepdim=True, unbiased=False)
    return (x - m) / torch.sqrt(v + eps)

def _scatter_add(tgt, idx, src, axis=0):
    return tgt.clone().index_add_(axis, idx, src)

def _segment_sum(src, seg, n):
    out = torch.zeros((n,) + src.shape[1:], dtype=src.dtype)
    return out.index_add_(0, seg, src)

def _pad(x, pw):
    flat = tuple((v for pair in reversed(pw) for v in pair))
    return torch.nn.functional.pad(x, flat)
kernel_name = 'adaLN_cond__mha_block__glu_gated_bilinear__prompt'

def setup_inputs():

    _w = lambda a: (lambda t: t.to(torch.bfloat16) if t.is_floating_point() else t)(torch.as_tensor(a))

    def _A_setup():
        B, S, D, H = (1, 2048, 1024, 32)
        return {'x': _w((lambda *s: torch.randn(*s, dtype=torch.bfloat16) * 0.05)(B, S, D)), 'wqkv': _w((lambda *s: torch.randn(*s, dtype=torch.bfloat16) * 0.05)(D, 3 * D)), 'wo': _w((lambda *s: torch.randn(*s, dtype=torch.bfloat16) * 0.05)(D, D))}
    _A_in = _A_setup()

    def _B_setup():
        B, S, D, F = (1, 2048, 1024, 3584)
        return {'x': _w((lambda *s: torch.randn(*s, dtype=torch.bfloat16) * 0.05)(B, S, D)), 'w_gate': _w((lambda *s: torch.randn(*s, dtype=torch.bfloat16) * 1.6)(D, F) * D ** (-0.5)), 'w_up': _w((lambda *s: torch.randn(*s, dtype=torch.bfloat16) * 1.6)(D, F) * D ** (-0.5)), 'w_down': _w((lambda *s: torch.randn(*s, dtype=torch.bfloat16) * 1.6)(F, D) * F ** (-0.5))}
    _B_in = _B_setup()
    return {'A_x': _A_in['x'], 'A_wqkv': _A_in['wqkv'], 'A_wo': _A_in['wo'], 'B_x': _B_in['x'], 'B_w_gate': _B_in['w_gate'], 'B_w_up': _B_in['w_up'], 'B_w_down': _B_in['w_down'], 'c': _w((lambda *s: torch.randn(*s, dtype=torch.bfloat16) * 0.2)(1, 1024) * 8.0), 'w_mod': _w((lambda *s: torch.randn(*s, dtype=torch.bfloat16) * 0.2)(1024, 6 * 1024) * 1024 ** (-0.5) * 8.0)}

def reference(A_x, A_wqkv, A_wo, B_x, B_w_gate, B_w_up, B_w_down, c, w_mod):

    def _A_ref(x, wqkv, wo):
        B, S, D = x.shape
        H = 32
        Dh = D // H
        qkv = (lambda x, *d: x.permute(*d))((x @ wqkv).reshape(B, S, 3, H, Dh), 2, 0, 3, 1, 4)
        q, k, v = (qkv[0], qkv[1], qkv[2])
        scores = torch.einsum('bhqd,bhkd->bhqk', q, k) * Dh ** (-0.5)
        p = _softmax(scores, axis=-1)
        o = torch.einsum('bhqk,bhkd->bhqd', p, v)
        return (lambda x, *d: x.permute(*d))(o, 0, 2, 1, 3).reshape(B, S, D) @ wo

    def _B_ref(x, w_gate, w_up, w_down):
        g = torch.einsum('bsd,df->bsf', x, w_gate)
        u = torch.einsum('bsd,df->bsf', x, w_up)
        h = g * u
        return torch.einsum('bsf,fd->bsd', h, w_down)
    x = A_x
    mod = (_silu(c) @ w_mod).reshape(c.shape[0], 6, 1, -1)
    sa, ca, ga, sb, cb, gb = (mod[:, 0].clone(), mod[:, 1].clone(), mod[:, 2].clone(), mod[:, 3].clone(), mod[:, 4].clone(), mod[:, 5].clone())
    h = _layernorm(x, axis=-1) * (1 + ca) + sa
    x = x + ga * _A_ref(h, A_wqkv, A_wo)
    h = _layernorm(x, axis=-1) * (1 + cb) + sb
    x = x + gb * _B_ref(h, B_w_gate, B_w_up, B_w_down)
    return x
```

```asm
; @launch kernel=mod_kernel grid=(192,1,1) block=(256,1,1) lds=8192
; @launch kernel=ln1_kernel grid=(512,1,1) block=(256,1,1) lds=0
; @launch kernel=qkv_kernel grid=(256,1,1) block=(512,1,1) lds=135168
; @launch kernel=attn_kernel grid=(256,1,1) block=(512,1,1) lds=65792
; @launch kernel=wo_kernel grid=(256,1,1) block=(512,1,1) lds=98304
; @launch kernel=ln2_kernel grid=(512,1,1) block=(256,1,1) lds=0
; @launch kernel=gu_kernel grid=(256,1,1) block=(512,1,1) lds=123392
; @launch kernel=down_kernel grid=(256,1,1) block=(512,1,1) lds=98304
.amdgcn_target "amdgcn-amd-amdhsa--gfx950"
.text
.globl mod_kernel
.p2align 8
.type mod_kernel,@function
mod_kernel:
    s_cmp_ge_u32 s2, 192
    s_cbranch_scc1 mod_kernel_end
    s_load_dwordx2 s[4:5], s[0:1], 56
    s_load_dwordx2 s[6:7], s[0:1], 64
    s_load_dwordx2 s[8:9], s[0:1], 88
    v_and_b32 v1, 3, v0
    v_lshrrev_b32 v2, 2, v0
    s_waitcnt lgkmcnt(0)
    s_mov_b32 s12, s4
    s_and_b32 s13, s5, 0xffff
    s_mov_b32 s14, 2048
    s_mov_b32 s15, 0x00020000
    s_mov_b32 s16, s6
    s_and_b32 s17, s7, 0xffff
    s_mov_b32 s18, 12582912
    s_mov_b32 s19, 0x00020000
    s_add_u32 s20, s8, 0
    s_addc_u32 s21, s9, 0
    s_and_b32 s21, s21, 0xffff
    s_mov_b32 s22, 24576
    s_mov_b32 s23, 0x00020000
    v_lshlrev_b32 v3, 1, v2
    v_mul_u32_u24 v4, 12288, v2
    v_lshlrev_b32 v5, 4, v1
    s_lshl_b32 s3, s2, 6
    v_add3_u32 v4, v4, v5, s3
    s_mov_b32 s24, 0
    s_mov_b32 s25, 786432
    s_mov_b32 s26, 1572864
    s_mov_b32 s27, 2359296
    s_mov_b32 s28, 3145728
    s_mov_b32 s29, 3932160
    s_mov_b32 s30, 4718592
    s_mov_b32 s31, 5505024
    s_mov_b32 s32, 6291456
    s_mov_b32 s33, 7077888
    s_mov_b32 s34, 7864320
    s_mov_b32 s35, 8650752
    s_mov_b32 s36, 9437184
    s_mov_b32 s37, 10223616
    s_mov_b32 s38, 11010048
    s_mov_b32 s39, 11796480
    buffer_load_ushort v16, v3, s[12:15], 0 offen offset:0
    buffer_load_ushort v17, v3, s[12:15], 0 offen offset:128
    buffer_load_ushort v18, v3, s[12:15], 0 offen offset:256
    buffer_load_ushort v19, v3, s[12:15], 0 offen offset:384
    buffer_load_ushort v20, v3, s[12:15], 0 offen offset:512
    buffer_load_ushort v21, v3, s[12:15], 0 offen offset:640
    buffer_load_ushort v22, v3, s[12:15], 0 offen offset:768
    buffer_load_ushort v23, v3, s[12:15], 0 offen offset:896
    buffer_load_ushort v24, v3, s[12:15], 0 offen offset:1024
    buffer_load_ushort v25, v3, s[12:15], 0 offen offset:1152
    buffer_load_ushort v26, v3, s[12:15], 0 offen offset:1280
    buffer_load_ushort v27, v3, s[12:15], 0 offen offset:1408
    buffer_load_ushort v28, v3, s[12:15], 0 offen offset:1536
    buffer_load_ushort v29, v3, s[12:15], 0 offen offset:1664
    buffer_load_ushort v30, v3, s[12:15], 0 offen offset:1792
    buffer_load_ushort v31, v3, s[12:15], 0 offen offset:1920
    buffer_load_dwordx4 v[32:35], v4, s[16:19], s24 offen
    buffer_load_dwordx4 v[36:39], v4, s[16:19], s25 offen
    buffer_load_dwordx4 v[40:43], v4, s[16:19], s26 offen
    buffer_load_dwordx4 v[44:47], v4, s[16:19], s27 offen
    buffer_load_dwordx4 v[48:51], v4, s[16:19], s28 offen
    buffer_load_dwordx4 v[52:55], v4, s[16:19], s29 offen
    buffer_load_dwordx4 v[56:59], v4, s[16:19], s30 offen
    buffer_load_dwordx4 v[60:63], v4, s[16:19], s31 offen
    buffer_load_dwordx4 v[64:67], v4, s[16:19], s32 offen
    buffer_load_dwordx4 v[68:71], v4, s[16:19], s33 offen
    buffer_load_dwordx4 v[72:75], v4, s[16:19], s34 offen
    buffer_load_dwordx4 v[76:79], v4, s[16:19], s35 offen
    buffer_load_dwordx4 v[80:83], v4, s[16:19], s36 offen
    buffer_load_dwordx4 v[84:87], v4, s[16:19], s37 offen
    buffer_load_dwordx4 v[88:91], v4, s[16:19], s38 offen
    buffer_load_dwordx4 v[92:95], v4, s[16:19], s39 offen
    v_mov_b32 v96, 0
    v_mov_b32 v97, 0
    v_mov_b32 v98, 0
    v_mov_b32 v99, 0
    v_mov_b32 v100, 0
    v_mov_b32 v101, 0
    v_mov_b32 v102, 0
    v_mov_b32 v103, 0
    s_waitcnt vmcnt(16)
    v_lshlrev_b32 v16, 16, v16
    v_mul_f32 v6, 0xbfb8aa3b, v16
    v_exp_f32 v6, v6
    s_nop 0
    v_add_f32 v6, 1.0, v6
    v_rcp_f32 v6, v6
    s_nop 0
    v_mul_f32 v16, v16, v6
    v_cvt_pk_bf16_f32 v6, v16, v16
    v_lshlrev_b32 v16, 16, v6
    v_lshlrev_b32 v17, 16, v17
    v_mul_f32 v6, 0xbfb8aa3b, v17
    v_exp_f32 v6, v6
    s_nop 0
    v_add_f32 v6, 1.0, v6
    v_rcp_f32 v6, v6
    s_nop 0
    v_mul_f32 v17, v17, v6
    v_cvt_pk_bf16_f32 v6, v17, v17
    v_lshlrev_b32 v17, 16, v6
    v_lshlrev_b32 v18, 16, v18
    v_mul_f32 v6, 0xbfb8aa3b, v18
    v_exp_f32 v6, v6
    s_nop 0
    v_add_f32 v6, 1.0, v6
    v_rcp_f32 v6, v6
    s_nop 0
    v_mul_f32 v18, v18, v6
    v_cvt_pk_bf16_f32 v6, v18, v18
    v_lshlrev_b32 v18, 16, v6
    v_lshlrev_b32 v19, 16, v19
    v_mul_f32 v6, 0xbfb8aa3b, v19
    v_exp_f32 v6, v6
    s_nop 0
    v_add_f32 v6, 1.0, v6
    v_rcp_f32 v6, v6
    s_nop 0
    v_mul_f32 v19, v19, v6
    v_cvt_pk_bf16_f32 v6, v19, v19
    v_lshlrev_b32 v19, 16, v6
    v_lshlrev_b32 v20, 16, v20
    v_mul_f32 v6, 0xbfb8aa3b, v20
    v_exp_f32 v6, v6
    s_nop 0
    v_add_f32 v6, 1.0, v6
    v_rcp_f32 v6, v6
    s_nop 0
    v_mul_f32 v20, v20, v6
    v_cvt_pk_bf16_f32 v6, v20, v20
    v_lshlrev_b32 v20, 16, v6
    v_lshlrev_b32 v21, 16, v21
    v_mul_f32 v6, 0xbfb8aa3b, v21
    v_exp_f32 v6, v6
    s_nop 0
    v_add_f32 v6, 1.0, v6
    v_rcp_f32 v6, v6
    s_nop 0
    v_mul_f32 v21, v21, v6
    v_cvt_pk_bf16_f32 v6, v21, v21
    v_lshlrev_b32 v21, 16, v6
    v_lshlrev_b32 v22, 16, v22
    v_mul_f32 v6, 0xbfb8aa3b, v22
    v_exp_f32 v6, v6
    s_nop 0
    v_add_f32 v6, 1.0, v6
    v_rcp_f32 v6, v6
    s_nop 0
    v_mul_f32 v22, v22, v6
    v_cvt_pk_bf16_f32 v6, v22, v22
    v_lshlrev_b32 v22, 16, v6
    v_lshlrev_b32 v23, 16, v23
    v_mul_f32 v6, 0xbfb8aa3b, v23
    v_exp_f32 v6, v6
    s_nop 0
    v_add_f32 v6, 1.0, v6
    v_rcp_f32 v6, v6
    s_nop 0
    v_mul_f32 v23, v23, v6
    v_cvt_pk_bf16_f32 v6, v23, v23
    v_lshlrev_b32 v23, 16, v6
    v_lshlrev_b32 v24, 16, v24
    v_mul_f32 v6, 0xbfb8aa3b, v24
    v_exp_f32 v6, v6
    s_nop 0
    v_add_f32 v6, 1.0, v6
    v_rcp_f32 v6, v6
    s_nop 0
    v_mul_f32 v24, v24, v6
    v_cvt_pk_bf16_f32 v6, v24, v24
    v_lshlrev_b32 v24, 16, v6
    v_lshlrev_b32 v25, 16, v25
    v_mul_f32 v6, 0xbfb8aa3b, v25
    v_exp_f32 v6, v6
    s_nop 0
    v_add_f32 v6, 1.0, v6
    v_rcp_f32 v6, v6
    s_nop 0
    v_mul_f32 v25, v25, v6
    v_cvt_pk_bf16_f32 v6, v25, v25
    v_lshlrev_b32 v25, 16, v6
    v_lshlrev_b32 v26, 16, v26
    v_mul_f32 v6, 0xbfb8aa3b, v26
    v_exp_f32 v6, v6
    s_nop 0
    v_add_f32 v6, 1.0, v6
    v_rcp_f32 v6, v6
    s_nop 0
    v_mul_f32 v26, v26, v6
    v_cvt_pk_bf16_f32 v6, v26, v26
    v_lshlrev_b32 v26, 16, v6
    v_lshlrev_b32 v27, 16, v27
    v_mul_f32 v6, 0xbfb8aa3b, v27
    v_exp_f32 v6, v6
    s_nop 0
    v_add_f32 v6, 1.0, v6
    v_rcp_f32 v6, v6
    s_nop 0
    v_mul_f32 v27, v27, v6
    v_cvt_pk_bf16_f32 v6, v27, v27
    v_lshlrev_b32 v27, 16, v6
    v_lshlrev_b32 v28, 16, v28
    v_mul_f32 v6, 0xbfb8aa3b, v28
    v_exp_f32 v6, v6
    s_nop 0
    v_add_f32 v6, 1.0, v6
    v_rcp_f32 v6, v6
    s_nop 0
    v_mul_f32 v28, v28, v6
    v_cvt_pk_bf16_f32 v6, v28, v28
    v_lshlrev_b32 v28, 16, v6
    v_lshlrev_b32 v29, 16, v29
    v_mul_f32 v6, 0xbfb8aa3b, v29
    v_exp_f32 v6, v6
    s_nop 0
    v_add_f32 v6, 1.0, v6
    v_rcp_f32 v6, v6
    s_nop 0
    v_mul_f32 v29, v29, v6
    v_cvt_pk_bf16_f32 v6, v29, v29
    v_lshlrev_b32 v29, 16, v6
    v_lshlrev_b32 v30, 16, v30
    v_mul_f32 v6, 0xbfb8aa3b, v30
    v_exp_f32 v6, v6
    s_nop 0
    v_add_f32 v6, 1.0, v6
    v_rcp_f32 v6, v6
    s_nop 0
    v_mul_f32 v30, v30, v6
    v_cvt_pk_bf16_f32 v6, v30, v30
    v_lshlrev_b32 v30, 16, v6
    v_lshlrev_b32 v31, 16, v31
    v_mul_f32 v6, 0xbfb8aa3b, v31
    v_exp_f32 v6, v6
    s_nop 0
    v_add_f32 v6, 1.0, v6
    v_rcp_f32 v6, v6
    s_nop 0
    v_mul_f32 v31, v31, v6
    v_cvt_pk_bf16_f32 v6, v31, v31
    v_lshlrev_b32 v31, 16, v6
    s_waitcnt vmcnt(15)
    v_lshlrev_b32 v6, 16, v32
    v_and_b32 v7, 0xffff0000, v32
    v_fmac_f32 v96, v16, v6
    v_fmac_f32 v97, v16, v7
    v_lshlrev_b32 v6, 16, v33
    v_and_b32 v7, 0xffff0000, v33
    v_fmac_f32 v98, v16, v6
    v_fmac_f32 v99, v16, v7
    v_lshlrev_b32 v6, 16, v34
    v_and_b32 v7, 0xffff0000, v34
    v_fmac_f32 v100, v16, v6
    v_fmac_f32 v101, v16, v7
    v_lshlrev_b32 v6, 16, v35
    v_and_b32 v7, 0xffff0000, v35
    v_fmac_f32 v102, v16, v6
    v_fmac_f32 v103, v16, v7
    s_waitcnt vmcnt(14)
    v_lshlrev_b32 v6, 16, v36
    v_and_b32 v7, 0xffff0000, v36
    v_fmac_f32 v96, v17, v6
    v_fmac_f32 v97, v17, v7
    v_lshlrev_b32 v6, 16, v37
    v_and_b32 v7, 0xffff0000, v37
    v_fmac_f32 v98, v17, v6
    v_fmac_f32 v99, v17, v7
    v_lshlrev_b32 v6, 16, v38
    v_and_b32 v7, 0xffff0000, v38
    v_fmac_f32 v100, v17, v6
    v_fmac_f32 v101, v17, v7
    v_lshlrev_b32 v6, 16, v39
    v_and_b32 v7, 0xffff0000, v39
    v_fmac_f32 v102, v17, v6
    v_fmac_f32 v103, v17, v7
    s_waitcnt vmcnt(13)
    v_lshlrev_b32 v6, 16, v40
    v_and_b32 v7, 0xffff0000, v40
    v_fmac_f32 v96, v18, v6
    v_fmac_f32 v97, v18, v7
    v_lshlrev_b32 v6, 16, v41
    v_and_b32 v7, 0xffff0000, v41
    v_fmac_f32 v98, v18, v6
    v_fmac_f32 v99, v18, v7
    v_lshlrev_b32 v6, 16, v42
    v_and_b32 v7, 0xffff0000, v42
    v_fmac_f32 v100, v18, v6
    v_fmac_f32 v101, v18, v7
    v_lshlrev_b32 v6, 16, v43
    v_and_b32 v7, 0xffff0000, v43
    v_fmac_f32 v102, v18, v6
    v_fmac_f32 v103, v18, v7
    s_waitcnt vmcnt(12)
    v_lshlrev_b32 v6, 16, v44
    v_and_b32 v7, 0xffff0000, v44
    v_fmac_f32 v96, v19, v6
    v_fmac_f32 v97, v19, v7
    v_lshlrev_b32 v6, 16, v45
    v_and_b32 v7, 0xffff0000, v45
    v_fmac_f32 v98, v19, v6
    v_fmac_f32 v99, v19, v7
    v_lshlrev_b32 v6, 16, v46
    v_and_b32 v7, 0xffff0000, v46
    v_fmac_f32 v100, v19, v6
    v_fmac_f32 v101, v19, v7
    v_lshlrev_b32 v6, 16, v47
    v_and_b32 v7, 0xffff0000, v47
    v_fmac_f32 v102, v19, v6
    v_fmac_f32 v103, v19, v7
    s_waitcnt vmcnt(11)
    v_lshlrev_b32 v6, 16, v48
    v_and_b32 v7, 0xffff0000, v48
    v_fmac_f32 v96, v20, v6
    v_fmac_f32 v97, v20, v7
    v_lshlrev_b32 v6, 16, v49
    v_and_b32 v7, 0xffff0000, v49
    v_fmac_f32 v98, v20, v6
    v_fmac_f32 v99, v20, v7
    v_lshlrev_b32 v6, 16, v50
    v_and_b32 v7, 0xffff0000, v50
    v_fmac_f32 v100, v20, v6
    v_fmac_f32 v101, v20, v7
    v_lshlrev_b32 v6, 16, v51
    v_and_b32 v7, 0xffff0000, v51
    v_fmac_f32 v102, v20, v6
    v_fmac_f32 v103, v20, v7
    s_waitcnt vmcnt(10)
    v_lshlrev_b32 v6, 16, v52
    v_and_b32 v7, 0xffff0000, v52
    v_fmac_f32 v96, v21, v6
    v_fmac_f32 v97, v21, v7
    v_lshlrev_b32 v6, 16, v53
    v_and_b32 v7, 0xffff0000, v53
    v_fmac_f32 v98, v21, v6
    v_fmac_f32 v99, v21, v7
    v_lshlrev_b32 v6, 16, v54
    v_and_b32 v7, 0xffff0000, v54
    v_fmac_f32 v100, v21, v6
    v_fmac_f32 v101, v21, v7
    v_lshlrev_b32 v6, 16, v55
    v_and_b32 v7, 0xffff0000, v55
    v_fmac_f32 v102, v21, v6
    v_fmac_f32 v103, v21, v7
    s_waitcnt vmcnt(9)
    v_lshlrev_b32 v6, 16, v56
    v_and_b32 v7, 0xffff0000, v56
    v_fmac_f32 v96, v22, v6
    v_fmac_f32 v97, v22, v7
    v_lshlrev_b32 v6, 16, v57
    v_and_b32 v7, 0xffff0000, v57
    v_fmac_f32 v98, v22, v6
    v_fmac_f32 v99, v22, v7
    v_lshlrev_b32 v6, 16, v58
    v_and_b32 v7, 0xffff0000, v58
    v_fmac_f32 v100, v22, v6
    v_fmac_f32 v101, v22, v7
    v_lshlrev_b32 v6, 16, v59
    v_and_b32 v7, 0xffff0000, v59
    v_fmac_f32 v102, v22, v6
    v_fmac_f32 v103, v22, v7
    s_waitcnt vmcnt(8)
    v_lshlrev_b32 v6, 16, v60
    v_and_b32 v7, 0xffff0000, v60
    v_fmac_f32 v96, v23, v6
    v_fmac_f32 v97, v23, v7
    v_lshlrev_b32 v6, 16, v61
    v_and_b32 v7, 0xffff0000, v61
    v_fmac_f32 v98, v23, v6
    v_fmac_f32 v99, v23, v7
    v_lshlrev_b32 v6, 16, v62
    v_and_b32 v7, 0xffff0000, v62
    v_fmac_f32 v100, v23, v6
    v_fmac_f32 v101, v23, v7
    v_lshlrev_b32 v6, 16, v63
    v_and_b32 v7, 0xffff0000, v63
    v_fmac_f32 v102, v23, v6
    v_fmac_f32 v103, v23, v7
    s_waitcnt vmcnt(7)
    v_lshlrev_b32 v6, 16, v64
    v_and_b32 v7, 0xffff0000, v64
    v_fmac_f32 v96, v24, v6
    v_fmac_f32 v97, v24, v7
    v_lshlrev_b32 v6, 16, v65
    v_and_b32 v7, 0xffff0000, v65
    v_fmac_f32 v98, v24, v6
    v_fmac_f32 v99, v24, v7
    v_lshlrev_b32 v6, 16, v66
    v_and_b32 v7, 0xffff0000, v66
    v_fmac_f32 v100, v24, v6
    v_fmac_f32 v101, v24, v7
    v_lshlrev_b32 v6, 16, v67
    v_and_b32 v7, 0xffff0000, v67
    v_fmac_f32 v102, v24, v6
    v_fmac_f32 v103, v24, v7
    s_waitcnt vmcnt(6)
    v_lshlrev_b32 v6, 16, v68
    v_and_b32 v7, 0xffff0000, v68
    v_fmac_f32 v96, v25, v6
    v_fmac_f32 v97, v25, v7
    v_lshlrev_b32 v6, 16, v69
    v_and_b32 v7, 0xffff0000, v69
    v_fmac_f32 v98, v25, v6
    v_fmac_f32 v99, v25, v7
    v_lshlrev_b32 v6, 16, v70
    v_and_b32 v7, 0xffff0000, v70
    v_fmac_f32 v100, v25, v6
    v_fmac_f32 v101, v25, v7
    v_lshlrev_b32 v6, 16, v71
    v_and_b32 v7, 0xffff0000, v71
    v_fmac_f32 v102, v25, v6
    v_fmac_f32 v103, v25, v7
    s_waitcnt vmcnt(5)
    v_lshlrev_b32 v6, 16, v72
    v_and_b32 v7, 0xffff0000, v72
    v_fmac_f32 v96, v26, v6
    v_fmac_f32 v97, v26, v7
    v_lshlrev_b32 v6, 16, v73
    v_and_b32 v7, 0xffff0000, v73
    v_fmac_f32 v98, v26, v6
    v_fmac_f32 v99, v26, v7
    v_lshlrev_b32 v6, 16, v74
    v_and_b32 v7, 0xffff0000, v74
    v_fmac_f32 v100, v26, v6
    v_fmac_f32 v101, v26, v7
    v_lshlrev_b32 v6, 16, v75
    v_and_b32 v7, 0xffff0000, v75
    v_fmac_f32 v102, v26, v6
    v_fmac_f32 v103, v26, v7
    s_waitcnt vmcnt(4)
    v_lshlrev_b32 v6, 16, v76
    v_and_b32 v7, 0xffff0000, v76
    v_fmac_f32 v96, v27, v6
    v_fmac_f32 v97, v27, v7
    v_lshlrev_b32 v6, 16, v77
    v_and_b32 v7, 0xffff0000, v77
    v_fmac_f32 v98, v27, v6
    v_fmac_f32 v99, v27, v7
    v_lshlrev_b32 v6, 16, v78
    v_and_b32 v7, 0xffff0000, v78
    v_fmac_f32 v100, v27, v6
    v_fmac_f32 v101, v27, v7
    v_lshlrev_b32 v6, 16, v79
    v_and_b32 v7, 0xffff0000, v79
    v_fmac_f32 v102, v27, v6
    v_fmac_f32 v103, v27, v7
    s_waitcnt vmcnt(3)
    v_lshlrev_b32 v6, 16, v80
    v_and_b32 v7, 0xffff0000, v80
    v_fmac_f32 v96, v28, v6
    v_fmac_f32 v97, v28, v7
    v_lshlrev_b32 v6, 16, v81
    v_and_b32 v7, 0xffff0000, v81
    v_fmac_f32 v98, v28, v6
    v_fmac_f32 v99, v28, v7
    v_lshlrev_b32 v6, 16, v82
    v_and_b32 v7, 0xffff0000, v82
    v_fmac_f32 v100, v28, v6
    v_fmac_f32 v101, v28, v7
    v_lshlrev_b32 v6, 16, v83
    v_and_b32 v7, 0xffff0000, v83
    v_fmac_f32 v102, v28, v6
    v_fmac_f32 v103, v28, v7
    s_waitcnt vmcnt(2)
    v_lshlrev_b32 v6, 16, v84
    v_and_b32 v7, 0xffff0000, v84
    v_fmac_f32 v96, v29, v6
    v_fmac_f32 v97, v29, v7
    v_lshlrev_b32 v6, 16, v85
    v_and_b32 v7, 0xffff0000, v85
    v_fmac_f32 v98, v29, v6
    v_fmac_f32 v99, v29, v7
    v_lshlrev_b32 v6, 16, v86
    v_and_b32 v7, 0xffff0000, v86
    v_fmac_f32 v100, v29, v6
    v_fmac_f32 v101, v29, v7
    v_lshlrev_b32 v6, 16, v87
    v_and_b32 v7, 0xffff0000, v87
    v_fmac_f32 v102, v29, v6
    v_fmac_f32 v103, v29, v7
    s_waitcnt vmcnt(1)
    v_lshlrev_b32 v6, 16, v88
    v_and_b32 v7, 0xffff0000, v88
    v_fmac_f32 v96, v30, v6
    v_fmac_f32 v97, v30, v7
    v_lshlrev_b32 v6, 16, v89
    v_and_b32 v7, 0xffff0000, v89
    v_fmac_f32 v98, v30, v6
    v_fmac_f32 v99, v30, v7
    v_lshlrev_b32 v6, 16, v90
    v_and_b32 v7, 0xffff0000, v90
    v_fmac_f32 v100, v30, v6
    v_fmac_f32 v101, v30, v7
    v_lshlrev_b32 v6, 16, v91
    v_and_b32 v7, 0xffff0000, v91
    v_fmac_f32 v102, v30, v6
    v_fmac_f32 v103, v30, v7
    s_waitcnt vmcnt(0)
    v_lshlrev_b32 v6, 16, v92
    v_and_b32 v7, 0xffff0000, v92
    v_fmac_f32 v96, v31, v6
    v_fmac_f32 v97, v31, v7
    v_lshlrev_b32 v6, 16, v93
    v_and_b32 v7, 0xffff0000, v93
    v_fmac_f32 v98, v31, v6
    v_fmac_f32 v99, v31, v7
    v_lshlrev_b32 v6, 16, v94
    v_and_b32 v7, 0xffff0000, v94
    v_fmac_f32 v100, v31, v6
    v_fmac_f32 v101, v31, v7
    v_lshlrev_b32 v6, 16, v95
    v_and_b32 v7, 0xffff0000, v95
    v_fmac_f32 v102, v31, v6
    v_fmac_f32 v103, v31, v7
    v_lshlrev_b32 v6, 5, v0
    ds_write_b128 v6, v[96:99]
    ds_write_b128 v6, v[100:103] offset:16
    s_waitcnt lgkmcnt(0)
    s_barrier
    v_and_b32 v7, 31, v0
    v_lshrrev_b32 v8, 5, v0
    v_lshlrev_b32 v9, 10, v8
    v_lshl_add_u32 v9, v7, 2, v9
    ds_read_b32 v16, v9 offset:0
    ds_read_b32 v17, v9 offset:128
    ds_read_b32 v18, v9 offset:256
    ds_read_b32 v19, v9 offset:384
    ds_read_b32 v20, v9 offset:512
    ds_read_b32 v21, v9 offset:640
    ds_read_b32 v22, v9 offset:768
    ds_read_b32 v23, v9 offset:896
    s_waitcnt lgkmcnt(0)
    v_add_f32 v16, v16, v17
    v_add_f32 v16, v16, v18
    v_add_f32 v16, v16, v19
    v_add_f32 v16, v16, v20
    v_add_f32 v16, v16, v21
    v_add_f32 v16, v16, v22
    v_add_f32 v16, v16, v23
    s_barrier
    v_lshlrev_b32 v9, 2, v0
    ds_write_b32 v9, v16
    s_waitcnt lgkmcnt(0)
    s_barrier
    v_lshlrev_b32 v9, 2, v7
    ds_read_b32 v16, v9 offset:0
    ds_read_b32 v17, v9 offset:128
    ds_read_b32 v18, v9 offset:256
    ds_read_b32 v19, v9 offset:384
    ds_read_b32 v20, v9 offset:512
    ds_read_b32 v21, v9 offset:640
    ds_read_b32 v22, v9 offset:768
    ds_read_b32 v23, v9 offset:896
    s_waitcnt lgkmcnt(0)
    v_add_f32 v16, v16, v17
    v_add_f32 v16, v16, v18
    v_add_f32 v16, v16, v19
    v_add_f32 v16, v16, v20
    v_add_f32 v16, v16, v21
    v_add_f32 v16, v16, v22
    v_add_f32 v16, v16, v23
    v_cvt_pk_bf16_f32 v6, v16, v16
    v_lshlrev_b32 v16, 16, v6
    v_cmp_gt_u32 vcc, 32, v0
    s_and_saveexec_b64 s[40:41], vcc
    s_cbranch_execz mod_kernel_end
    s_lshl_b32 s3, s2, 7
    v_lshl_add_u32 v9, v7, 2, s3
    buffer_store_dword v16, v9, s[20:23], 0 offen
mod_kernel_end:
    s_endpgm
.globl ln1_kernel
.p2align 8
.type ln1_kernel,@function
ln1_kernel:
    s_cmp_ge_u32 s2, 512
    s_cbranch_scc1 ln1_kernel_end
    s_load_dwordx2 s[4:5], s[0:1], 0
    s_load_dwordx2 s[8:9], s[0:1], 88
    s_load_dwordx2 s[40:41], s[0:1], 8
    v_and_b32 v1, 63, v0
    v_lshrrev_b32 v2, 6, v0
    s_waitcnt lgkmcnt(0)
    s_mov_b32 s12, s4
    s_and_b32 s13, s5, 0xffff
    s_mov_b32 s14, 4194304
    s_mov_b32 s15, 0x00020000
    s_add_u32 s16, s8, 1048576
    s_addc_u32 s17, s9, 0
    s_and_b32 s17, s17, 0xffff
    s_mov_b32 s18, 4194304
    s_mov_b32 s19, 0x00020000
    s_add_u32 s20, s8, 0
    s_addc_u32 s21, s9, 0
    s_and_b32 s21, s21, 0xffff
    s_mov_b32 s22, 8192
    s_mov_b32 s23, 0x00020000
    s_lshl_b32 s3, s2, 13
    v_lshlrev_b32 v3, 11, v2
    v_lshl_add_u32 v3, v1, 4, v3
    v_add_u32 v3, s3, v3
    v_lshlrev_b32 v4, 5, v1
    s_mov_b32 s24, 4096
    buffer_load_dwordx4 v[8:11], v3, s[12:15], 0 offen
    buffer_load_dwordx4 v[12:15], v3, s[12:15], 0 offen offset:1024
    buffer_load_dwordx4 v[16:19], v4, s[20:23], 0 offen offset:0
    buffer_load_dwordx4 v[20:23], v4, s[20:23], 0 offen offset:16
    buffer_load_dwordx4 v[24:27], v4, s[20:23], 0 offen offset:2048
    buffer_load_dwordx4 v[28:31], v4, s[20:23], 0 offen offset:2064
    buffer_load_dwordx4 v[32:35], v4, s[20:23], s24 offen offset:0
    buffer_load_dwordx4 v[36:39], v4, s[20:23], s24 offen offset:16
    buffer_load_dwordx4 v[40:43], v4, s[20:23], s24 offen offset:2048
    buffer_load_dwordx4 v[44:47], v4, s[20:23], s24 offen offset:2064
    s_mov_b32 s44, s40
    s_and_b32 s45, s41, 0xffff
    s_mov_b32 s46, 6291456
    s_mov_b32 s47, 0x00020000
    s_mul_i32 s3, s2, 12288
    v_mul_u32_u24 v64, 3072, v2
    v_lshl_add_u32 v64, v1, 4, v64
    v_add_u32 v64, s3, v64
    buffer_load_dwordx4 v[68:71], v64, s[44:47], 0 offen offset:0
    buffer_load_dwordx4 v[72:75], v64, s[44:47], 0 offen offset:1024
    buffer_load_dwordx4 v[76:79], v64, s[44:47], 0 offen offset:2048
    s_waitcnt vmcnt(11)
    v_lshlrev_b32 v48, 16, v8
    v_and_b32 v49, 0xffff0000, v8
    v_lshlrev_b32 v50, 16, v9
    v_and_b32 v51, 0xffff0000, v9
    v_lshlrev_b32 v52, 16, v10
    v_and_b32 v53, 0xffff0000, v10
    v_lshlrev_b32 v54, 16, v11
    v_and_b32 v55, 0xffff0000, v11
    v_lshlrev_b32 v56, 16, v12
    v_and_b32 v57, 0xffff0000, v12
    v_lshlrev_b32 v58, 16, v13
    v_and_b32 v59, 0xffff0000, v13
    v_lshlrev_b32 v60, 16, v14
    v_and_b32 v61, 0xffff0000, v14
    v_lshlrev_b32 v62, 16, v15
    v_and_b32 v63, 0xffff0000, v15
    v_add_f32 v5, v48, v49
    v_add_f32 v5, v5, v50
    v_add_f32 v5, v5, v51
    v_add_f32 v5, v5, v52
    v_add_f32 v5, v5, v53
    v_add_f32 v5, v5, v54
    v_add_f32 v5, v5, v55
    v_add_f32 v5, v5, v56
    v_add_f32 v5, v5, v57
    v_add_f32 v5, v5, v58
    v_add_f32 v5, v5, v59
    v_add_f32 v5, v5, v60
    v_add_f32 v5, v5, v61
    v_add_f32 v5, v5, v62
    v_add_f32 v5, v5, v63
    s_nop 1
    v_add_f32_dpp v6, v5, v5 quad_perm:[1,0,3,2] row_mask:0xf bank_mask:0xf
    s_nop 1
    v_add_f32_dpp v5, v6, v6 quad_perm:[2,3,0,1] row_mask:0xf bank_mask:0xf
    s_nop 1
    v_add_f32_dpp v6, v5, v5 row_half_mirror row_mask:0xf bank_mask:0xf
    s_nop 1
    v_add_f32_dpp v5, v6, v6 row_mirror row_mask:0xf bank_mask:0xf
    s_nop 1
    v_readlane_b32 s28, v5, 0
    v_readlane_b32 s29, v5, 16
    v_readlane_b32 s30, v5, 32
    v_readlane_b32 s31, v5, 48
    s_nop 1
    v_mov_b32 v5, s28
    v_add_f32 v5, s29, v5
    v_add_f32 v5, s30, v5
    v_add_f32 v5, s31, v5
    v_mul_f32 v5, 0x3a800000, v5
    v_mov_b32 v7, 0
    v_sub_f32 v6, v48, v5
    v_fmac_f32 v7, v6, v6
    v_sub_f32 v6, v49, v5
    v_fmac_f32 v7, v6, v6
    v_sub_f32 v6, v50, v5
    v_fmac_f32 v7, v6, v6
    v_sub_f32 v6, v51, v5
    v_fmac_f32 v7, v6, v6
    v_sub_f32 v6, v52, v5
    v_fmac_f32 v7, v6, v6
    v_sub_f32 v6, v53, v5
    v_fmac_f32 v7, v6, v6
    v_sub_f32 v6, v54, v5
    v_fmac_f32 v7, v6, v6
    v_sub_f32 v6, v55, v5
    v_fmac_f32 v7, v6, v6
    v_sub_f32 v6, v56, v5
    v_fmac_f32 v7, v6, v6
    v_sub_f32 v6, v57, v5
    v_fmac_f32 v7, v6, v6
    v_sub_f32 v6, v58, v5
    v_fmac_f32 v7, v6, v6
    v_sub_f32 v6, v59, v5
    v_fmac_f32 v7, v6, v6
    v_sub_f32 v6, v60, v5
    v_fmac_f32 v7, v6, v6
    v_sub_f32 v6, v61, v5
    v_fmac_f32 v7, v6, v6
    v_sub_f32 v6, v62, v5
    v_fmac_f32 v7, v6, v6
    v_sub_f32 v6, v63, v5
    v_fmac_f32 v7, v6, v6
    s_nop 1
    v_add_f32_dpp v6, v7, v7 quad_perm:[1,0,3,2] row_mask:0xf bank_mask:0xf
    s_nop 1
    v_add_f32_dpp v7, v6, v6 quad_perm:[2,3,0,1] row_mask:0xf bank_mask:0xf
    s_nop 1
    v_add_f32_dpp v6, v7, v7 row_half_mirror row_mask:0xf bank_mask:0xf
    s_nop 1
    v_add_f32_dpp v7, v6, v6 row_mirror row_mask:0xf bank_mask:0xf
    s_nop 1
    v_readlane_b32 s28, v7, 0
    v_readlane_b32 s29, v7, 16
    v_readlane_b32 s30, v7, 32
    v_readlane_b32 s31, v7, 48
    s_nop 1
    v_mov_b32 v7, s28
    v_add_f32 v7, s29, v7
    v_add_f32 v7, s30, v7
    v_add_f32 v7, s31, v7
    v_mul_f32 v7, 0x3a800000, v7
    v_cvt_pk_bf16_f32 v6, v5, v5
    v_lshlrev_b32 v5, 16, v6
    v_cvt_pk_bf16_f32 v6, v7, v7
    v_lshlrev_b32 v7, 16, v6
    v_add_f32 v7, 0x3727c5ac, v7
    v_cvt_pk_bf16_f32 v6, v7, v7
    v_lshlrev_b32 v7, 16, v6
    v_sqrt_f32 v7, v7
    s_nop 0
    v_cvt_pk_bf16_f32 v6, v7, v7
    v_lshlrev_b32 v7, 16, v6
    v_rcp_f32 v7, v7
    s_waitcnt vmcnt(3)
    v_add_f32 v32, 1.0, v32
    v_add_f32 v33, 1.0, v33
    v_cvt_pk_bf16_f32 v6, v32, v33
    v_lshlrev_b32 v32, 16, v6
    v_and_b32 v33, 0xffff0000, v6
    v_add_f32 v34, 1.0, v34
    v_add_f32 v35, 1.0, v35
    v_cvt_pk_bf16_f32 v6, v34, v35
    v_lshlrev_b32 v34, 16, v6
    v_and_b32 v35, 0xffff0000, v6
    v_add_f32 v36, 1.0, v36
    v_add_f32 v37, 1.0, v37
    v_cvt_pk_bf16_f32 v6, v36, v37
    v_lshlrev_b32 v36, 16, v6
    v_and_b32 v37, 0xffff0000, v6
    v_add_f32 v38, 1.0, v38
    v_add_f32 v39, 1.0, v39
    v_cvt_pk_bf16_f32 v6, v38, v39
    v_lshlrev_b32 v38, 16, v6
    v_and_b32 v39, 0xffff0000, v6
    v_add_f32 v40, 1.0, v40
    v_add_f32 v41, 1.0, v41
    v_cvt_pk_bf16_f32 v6, v40, v41
    v_lshlrev_b32 v40, 16, v6
    v_and_b32 v41, 0xffff0000, v6
    v_add_f32 v42, 1.0, v42
    v_add_f32 v43, 1.0, v43
    v_cvt_pk_bf16_f32 v6, v42, v43
    v_lshlrev_b32 v42, 16, v6
    v_and_b32 v43, 0xffff0000, v6
    v_add_f32 v44, 1.0, v44
    v_add_f32 v45, 1.0, v45
    v_cvt_pk_bf16_f32 v6, v44, v45
    v_lshlrev_b32 v44, 16, v6
    v_and_b32 v45, 0xffff0000, v6
    v_add_f32 v46, 1.0, v46
    v_add_f32 v47, 1.0, v47
    v_cvt_pk_bf16_f32 v6, v46, v47
    v_lshlrev_b32 v46, 16, v6
    v_and_b32 v47, 0xffff0000, v6
    v_sub_f32 v48, v48, v5
    v_sub_f32 v49, v49, v5
    v_cvt_pk_bf16_f32 v6, v48, v49
    v_lshlrev_b32 v48, 16, v6
    v_and_b32 v49, 0xffff0000, v6
    v_mul_f32 v48, v48, v7
    v_mul_f32 v49, v49, v7
    v_cvt_pk_bf16_f32 v6, v48, v49
    v_lshlrev_b32 v48, 16, v6
    v_and_b32 v49, 0xffff0000, v6
    v_mul_f32 v48, v48, v32
    v_mul_f32 v49, v49, v33
    v_cvt_pk_bf16_f32 v6, v48, v49
    v_lshlrev_b32 v48, 16, v6
    v_and_b32 v49, 0xffff0000, v6
    v_add_f32 v48, v48, v16
    v_add_f32 v49, v49, v17
    v_cvt_pk_bf16_f32 v8, v48, v49
    v_sub_f32 v50, v50, v5
    v_sub_f32 v51, v51, v5
    v_cvt_pk_bf16_f32 v6, v50, v51
    v_lshlrev_b32 v50, 16, v6
    v_and_b32 v51, 0xffff0000, v6
    v_mul_f32 v50, v50, v7
    v_mul_f32 v51, v51, v7
    v_cvt_pk_bf16_f32 v6, v50, v51
    v_lshlrev_b32 v50, 16, v6
    v_and_b32 v51, 0xffff0000, v6
    v_mul_f32 v50, v50, v34
    v_mul_f32 v51, v51, v35
    v_cvt_pk_bf16_f32 v6, v50, v51
    v_lshlrev_b32 v50, 16, v6
    v_and_b32 v51, 0xffff0000, v6
    v_add_f32 v50, v50, v18
    v_add_f32 v51, v51, v19
    v_cvt_pk_bf16_f32 v9, v50, v51
    v_sub_f32 v52, v52, v5
    v_sub_f32 v53, v53, v5
    v_cvt_pk_bf16_f32 v6, v52, v53
    v_lshlrev_b32 v52, 16, v6
    v_and_b32 v53, 0xffff0000, v6
    v_mul_f32 v52, v52, v7
    v_mul_f32 v53, v53, v7
    v_cvt_pk_bf16_f32 v6, v52, v53
    v_lshlrev_b32 v52, 16, v6
    v_and_b32 v53, 0xffff0000, v6
    v_mul_f32 v52, v52, v36
    v_mul_f32 v53, v53, v37
    v_cvt_pk_bf16_f32 v6, v52, v53
    v_lshlrev_b32 v52, 16, v6
    v_and_b32 v53, 0xffff0000, v6
    v_add_f32 v52, v52, v20
    v_add_f32 v53, v53, v21
    v_cvt_pk_bf16_f32 v10, v52, v53
    v_sub_f32 v54, v54, v5
    v_sub_f32 v55, v55, v5
    v_cvt_pk_bf16_f32 v6, v54, v55
    v_lshlrev_b32 v54, 16, v6
    v_and_b32 v55, 0xffff0000, v6
    v_mul_f32 v54, v54, v7
    v_mul_f32 v55, v55, v7
    v_cvt_pk_bf16_f32 v6, v54, v55
    v_lshlrev_b32 v54, 16, v6
    v_and_b32 v55, 0xffff0000, v6
    v_mul_f32 v54, v54, v38
    v_mul_f32 v55, v55, v39
    v_cvt_pk_bf16_f32 v6, v54, v55
    v_lshlrev_b32 v54, 16, v6
    v_and_b32 v55, 0xffff0000, v6
    v_add_f32 v54, v54, v22
    v_add_f32 v55, v55, v23
    v_cvt_pk_bf16_f32 v11, v54, v55
    v_sub_f32 v56, v56, v5
    v_sub_f32 v57, v57, v5
    v_cvt_pk_bf16_f32 v6, v56, v57
    v_lshlrev_b32 v56, 16, v6
    v_and_b32 v57, 0xffff0000, v6
    v_mul_f32 v56, v56, v7
    v_mul_f32 v57, v57, v7
    v_cvt_pk_bf16_f32 v6, v56, v57
    v_lshlrev_b32 v56, 16, v6
    v_and_b32 v57, 0xffff0000, v6
    v_mul_f32 v56, v56, v40
    v_mul_f32 v57, v57, v41
    v_cvt_pk_bf16_f32 v6, v56, v57
    v_lshlrev_b32 v56, 16, v6
    v_and_b32 v57, 0xffff0000, v6
    v_add_f32 v56, v56, v24
    v_add_f32 v57, v57, v25
    v_cvt_pk_bf16_f32 v12, v56, v57
    v_sub_f32 v58, v58, v5
    v_sub_f32 v59, v59, v5
    v_cvt_pk_bf16_f32 v6, v58, v59
    v_lshlrev_b32 v58, 16, v6
    v_and_b32 v59, 0xffff0000, v6
    v_mul_f32 v58, v58, v7
    v_mul_f32 v59, v59, v7
    v_cvt_pk_bf16_f32 v6, v58, v59
    v_lshlrev_b32 v58, 16, v6
    v_and_b32 v59, 0xffff0000, v6
    v_mul_f32 v58, v58, v42
    v_mul_f32 v59, v59, v43
    v_cvt_pk_bf16_f32 v6, v58, v59
    v_lshlrev_b32 v58, 16, v6
    v_and_b32 v59, 0xffff0000, v6
    v_add_f32 v58, v58, v26
    v_add_f32 v59, v59, v27
    v_cvt_pk_bf16_f32 v13, v58, v59
    v_sub_f32 v60, v60, v5
    v_sub_f32 v61, v61, v5
    v_cvt_pk_bf16_f32 v6, v60, v61
    v_lshlrev_b32 v60, 16, v6
    v_and_b32 v61, 0xffff0000, v6
    v_mul_f32 v60, v60, v7
    v_mul_f32 v61, v61, v7
    v_cvt_pk_bf16_f32 v6, v60, v61
    v_lshlrev_b32 v60, 16, v6
    v_and_b32 v61, 0xffff0000, v6
    v_mul_f32 v60, v60, v44
    v_mul_f32 v61, v61, v45
    v_cvt_pk_bf16_f32 v6, v60, v61
    v_lshlrev_b32 v60, 16, v6
    v_and_b32 v61, 0xffff0000, v6
    v_add_f32 v60, v60, v28
    v_add_f32 v61, v61, v29
    v_cvt_pk_bf16_f32 v14, v60, v61
    v_sub_f32 v62, v62, v5
    v_sub_f32 v63, v63, v5
    v_cvt_pk_bf16_f32 v6, v62, v63
    v_lshlrev_b32 v62, 16, v6
    v_and_b32 v63, 0xffff0000, v6
    v_mul_f32 v62, v62, v7
    v_mul_f32 v63, v63, v7
    v_cvt_pk_bf16_f32 v6, v62, v63
    v_lshlrev_b32 v62, 16, v6
    v_and_b32 v63, 0xffff0000, v6
    v_mul_f32 v62, v62, v46
    v_mul_f32 v63, v63, v47
    v_cvt_pk_bf16_f32 v6, v62, v63
    v_lshlrev_b32 v62, 16, v6
    v_and_b32 v63, 0xffff0000, v6
    v_add_f32 v62, v62, v30
    v_add_f32 v63, v63, v31
    v_cvt_pk_bf16_f32 v15, v62, v63
    buffer_store_dwordx4 v[8:11], v3, s[16:19], 0 offen
    buffer_store_dwordx4 v[12:15], v3, s[16:19], 0 offen offset:1024
ln1_kernel_end:
    s_endpgm
.globl qkv_kernel
.p2align 8
.type qkv_kernel,@function
qkv_kernel:
    s_cmp_ge_u32 s2, 256
    s_cbranch_scc1 qkv_kernel_end
    s_load_dwordx2 s[4:5], s[0:1], 88
    s_load_dwordx2 s[6:7], s[0:1], 8
    v_lshrrev_b32 v1, 6, v0
    v_and_b32 v0, 63, v0
    s_nop 0
    v_readfirstlane_b32 s30, v1
    s_and_b32 s31, s2, 7
    s_lshr_b32 s36, s2, 3
    s_and_b32 s28, s31, 1
    s_lshr_b32 s29, s31, 1
    s_lshl_b32 s28, s28, 2
    s_and_b32 s37, s36, 3
    s_add_u32 s28, s28, s37
    s_lshl_b32 s29, s29, 3
    s_lshr_b32 s37, s36, 2
    s_add_u32 s29, s29, s37
    v_lshrrev_b32 v1, 3, v0
    v_and_b32 v2, 7, v0
    v_lshrrev_b32 v3, 1, v1
    v_xor_b32 v3, v3, v2
    v_xor_b32 v4, 4, v3
    s_mul_i32 s31, s30, 32
    s_mul_i32 s36, s28, 256
    s_add_u32 s36, s36, s31
    v_add_u32 v1, s36, v1
    s_mov_b32 s37, 2048
    v_mul_lo_u32 v1, v1, s37
    v_lshl_add_u32 v7, v3, 4, v1
    v_lshl_add_u32 v8, v4, 4, v1
    v_add_u32 v8, 16384, v8
    v_lshl_add_u32 v9, v3, 4, v1
    v_add_u32 v9, 32768, v9
    v_lshl_add_u32 v10, v4, 4, v1
    v_add_u32 v10, 49152, v10
    s_mov_b32 s31, s30
    s_mul_i32 s31, s31, 2
    s_mul_i32 s38, s29, 192
    s_mov_b32 s39, 32768
    s_add_u32 s37, s31, 0
    s_min_u32 s37, s37, 11
    s_lshl_b32 s50, s37, 10
    s_add_u32 s50, s50, s39
    s_lshl_b32 s37, s37, 6
    v_add_u32 v1, s37, v0
    v_mul_u32_u24 v2, 5462, v1
    v_lshrrev_b32 v2, 16, v2
    v_mul_u32_u24 v3, 12, v2
    v_sub_u32 v3, v1, v3
    v_mul_u32_u24 v2, 6144, v2
    v_lshl_add_u32 v2, v3, 4, v2
    v_add_u32 v11, s38, v2
    s_add_u32 s37, s31, 1
    s_min_u32 s37, s37, 11
    s_lshl_b32 s51, s37, 10
    s_add_u32 s51, s51, s39
    s_lshl_b32 s37, s37, 6
    v_add_u32 v1, s37, v0
    v_mul_u32_u24 v2, 5462, v1
    v_lshrrev_b32 v2, 16, v2
    v_mul_u32_u24 v3, 12, v2
    v_sub_u32 v3, v1, v3
    v_mul_u32_u24 v2, 6144, v2
    v_lshl_add_u32 v2, v3, 4, v2
    v_add_u32 v12, s38, v2
    s_mul_i32 s40, s30, 4096
    s_waitcnt lgkmcnt(0)
    s_add_u32 s8, s4, 1048576
    s_addc_u32 s9, s5, 0
    s_and_b32 s9, s9, 0xffff
    s_mov_b32 s10, 4194304
    s_mov_b32 s11, 0x00020000
    s_mov_b32 s12, s6
    s_and_b32 s13, s7, 0xffff
    s_mov_b32 s14, 6291456
    s_mov_b32 s15, 0x00020000
    s_mov_b32 s42, 0
    s_mov_b32 s43, 0
    s_add_u32 m0, s40, 0
    s_nop 0
    buffer_load_dwordx4 v7, s[8:11], s42 offen lds
    s_add_u32 m0, s40, 1024
    s_nop 0
    buffer_load_dwordx4 v8, s[8:11], s42 offen lds
    s_add_u32 m0, s40, 2048
    s_nop 0
    buffer_load_dwordx4 v9, s[8:11], s42 offen lds
    s_add_u32 m0, s40, 3072
    s_nop 0
    buffer_load_dwordx4 v10, s[8:11], s42 offen lds
    s_add_u32 m0, s50, 0
    s_nop 0
    buffer_load_dwordx4 v11, s[12:15], s43 offen lds
    s_add_u32 m0, s51, 0
    s_nop 0
    buffer_load_dwordx4 v12, s[12:15], s43 offen lds
    s_add_u32 s16, s4, 5242880
    s_addc_u32 s17, s5, 0
    s_and_b32 s17, s17, 0xffff
    s_mov_b32 s18, 12582912
    s_mov_b32 s19, 0x00020000
    s_mov_b32 s44, s30
    s_mov_b32 s45, 0
    v_and_b32 v1, 31, v0
    v_lshrrev_b32 v2, 5, v0
    v_bfe_u32 v3, v1, 1, 3
    v_xor_b32 v3, v3, v2
    s_mul_i32 s31, s44, 4096
    v_lshlrev_b32 v4, 7, v1
    v_lshl_add_u32 v4, v3, 4, v4
    v_add_u32 v4, s31, v4
    v_mov_b32 v13, v4
    v_xor_b32 v14, 32, v4
    v_xor_b32 v15, 64, v4
    v_xor_b32 v16, 96, v4
    v_add_u32 v17, 45056, v4
    v_xor_b32 v18, 32, v4
    v_add_u32 v18, 45056, v18
    v_xor_b32 v19, 64, v4
    v_add_u32 v19, 45056, v19
    v_xor_b32 v20, 96, v4
    v_add_u32 v20, 45056, v20
    v_add_u32 v21, 90112, v4
    v_xor_b32 v22, 32, v4
    v_add_u32 v22, 90112, v22
    v_xor_b32 v23, 64, v4
    v_add_u32 v23, 90112, v23
    v_xor_b32 v24, 96, v4
    v_add_u32 v24, 90112, v24
    v_and_b32 v1, 15, v0
    v_bfe_u32 v2, v0, 4, 1
    v_lshrrev_b32 v3, 5, v0
    v_lshrrev_b32 v4, 2, v1
    v_lshl_add_u32 v4, v3, 3, v4
    v_mul_u32_u24 v4, 192, v4
    v_and_b32 v3, 3, v1
    v_lshl_add_u32 v4, v3, 3, v4
    v_lshl_add_u32 v4, v2, 5, v4
    s_mul_i32 s31, s45, 192
    v_add_u32 v4, s31, v4
    v_add_u32 v25, 32768, v4
    v_add_u32 v26, 77824, v4
    v_add_u32 v27, 122880, v4
    s_mov_b32 s42, 128
    s_mov_b32 s43, 393216
    s_add_u32 m0, s40, 45056
    s_nop 0
    buffer_load_dwordx4 v7, s[8:11], s42 offen lds
    s_add_u32 m0, s40, 46080
    s_nop 0
    buffer_load_dwordx4 v8, s[8:11], s42 offen lds
    s_add_u32 m0, s40, 47104
    s_nop 0
    buffer_load_dwordx4 v9, s[8:11], s42 offen lds
    s_add_u32 m0, s40, 48128
    s_nop 0
    buffer_load_dwordx4 v10, s[8:11], s42 offen lds
    s_add_u32 m0, s50, 45056
    s_nop 0
    buffer_load_dwordx4 v11, s[12:15], s43 offen lds
    s_add_u32 m0, s51, 45056
    s_nop 0
    buffer_load_dwordx4 v12, s[12:15], s43 offen lds
    s_mov_b32 s42, 256
    s_mov_b32 s43, 786432
    s_add_u32 m0, s40, 90112
    s_nop 0
    buffer_load_dwordx4 v7, s[8:11], s42 offen lds
    s_add_u32 m0, s40, 91136
    s_nop 0
    buffer_load_dwordx4 v8, s[8:11], s42 offen lds
    s_add_u32 m0, s40, 92160
    s_nop 0
    buffer_load_dwordx4 v9, s[8:11], s42 offen lds
    s_add_u32 m0, s40, 93184
    s_nop 0
    buffer_load_dwordx4 v10, s[8:11], s42 offen lds
    s_add_u32 m0, s50, 90112
    s_nop 0
    buffer_load_dwordx4 v11, s[12:15], s43 offen lds
    s_add_u32 m0, s51, 90112
    s_nop 0
    buffer_load_dwordx4 v12, s[12:15], s43 offen lds
    v_mov_b32 v92, 0
    v_mov_b32 v93, 0
    v_mov_b32 v94, 0
    v_mov_b32 v95, 0
    v_mov_b32 v96, 0
    v_mov_b32 v97, 0
    v_mov_b32 v98, 0
    v_mov_b32 v99, 0
    v_mov_b32 v100, 0
    v_mov_b32 v101, 0
    v_mov_b32 v102, 0
    v_mov_b32 v103, 0
    v_mov_b32 v104, 0
    v_mov_b32 v105, 0
    v_mov_b32 v106, 0
    v_mov_b32 v107, 0
    v_mov_b32 v108, 0
    v_mov_b32 v109, 0
    v_mov_b32 v110, 0
    v_mov_b32 v111, 0
    v_mov_b32 v112, 0
    v_mov_b32 v113, 0
    v_mov_b32 v114, 0
    v_mov_b32 v115, 0
    v_mov_b32 v116, 0
    v_mov_b32 v117, 0
    v_mov_b32 v118, 0
    v_mov_b32 v119, 0
    v_mov_b32 v120, 0
    v_mov_b32 v121, 0
    v_mov_b32 v122, 0
    v_mov_b32 v123, 0
    v_mov_b32 v124, 0
    v_mov_b32 v125, 0
    v_mov_b32 v126, 0
    v_mov_b32 v127, 0
    v_mov_b32 v128, 0
    v_mov_b32 v129, 0
    v_mov_b32 v130, 0
    v_mov_b32 v131, 0
    v_mov_b32 v132, 0
    v_mov_b32 v133, 0
    v_mov_b32 v134, 0
    v_mov_b32 v135, 0
    v_mov_b32 v136, 0
    v_mov_b32 v137, 0
    v_mov_b32 v138, 0
    v_mov_b32 v139, 0
    s_waitcnt vmcnt(12)
    s_barrier
    ds_read_b128 v[28:31], v13 offset:0
    ds_read_b64_tr_b16 v[32:33], v25 offset:0
    ds_read_b64_tr_b16 v[34:35], v25 offset:768
    ds_read_b64_tr_b16 v[36:37], v25 offset:64
    ds_read_b64_tr_b16 v[38:39], v25 offset:832
    ds_read_b64_tr_b16 v[40:41], v25 offset:128
    ds_read_b64_tr_b16 v[42:43], v25 offset:896
    ds_read_b128 v[44:47], v14 offset:0
    ds_read_b64_tr_b16 v[48:49], v25 offset:3072
    ds_read_b64_tr_b16 v[50:51], v25 offset:3840
    ds_read_b64_tr_b16 v[52:53], v25 offset:3136
    ds_read_b64_tr_b16 v[54:55], v25 offset:3904
    ds_read_b64_tr_b16 v[56:57], v25 offset:3200
    ds_read_b64_tr_b16 v[58:59], v25 offset:3968
    s_mov_b32 s42, 384
    s_mov_b32 s43, 1179648
    s_mov_b32 s47, 4
.p2align 6
qkv_kernel_loop:
    s_waitcnt lgkmcnt(0)
    v_mfma_f32_32x32x16_bf16 v[92:107], v[32:35], v[28:31], v[92:107]
    ds_read_b128 v[60:63], v15 offset:0
    ds_read_b64_tr_b16 v[64:65], v25 offset:6144
    ds_read_b64_tr_b16 v[66:67], v25 offset:6912
    v_mfma_f32_32x32x16_bf16 v[108:123], v[36:39], v[28:31], v[108:123]
    ds_read_b64_tr_b16 v[68:69], v25 offset:6208
    ds_read_b64_tr_b16 v[70:71], v25 offset:6976
    v_mfma_f32_32x32x16_bf16 v[124:139], v[40:43], v[28:31], v[124:139]
    ds_read_b64_tr_b16 v[72:73], v25 offset:6272
    ds_read_b64_tr_b16 v[74:75], v25 offset:7040
    v_mfma_f32_32x32x16_bf16 v[92:107], v[48:51], v[44:47], v[92:107]
    ds_read_b128 v[76:79], v16 offset:0
    ds_read_b64_tr_b16 v[80:81], v25 offset:9216
    ds_read_b64_tr_b16 v[82:83], v25 offset:9984
    v_mfma_f32_32x32x16_bf16 v[108:123], v[52:55], v[44:47], v[108:123]
    ds_read_b64_tr_b16 v[84:85], v25 offset:9280
    ds_read_b64_tr_b16 v[86:87], v25 offset:10048
    v_mfma_f32_32x32x16_bf16 v[124:139], v[56:59], v[44:47], v[124:139]
    ds_read_b64_tr_b16 v[88:89], v25 offset:9344
    ds_read_b64_tr_b16 v[90:91], v25 offset:10112
    s_waitcnt vmcnt(6) lgkmcnt(0)
    s_barrier
    v_mfma_f32_32x32x16_bf16 v[92:107], v[64:67], v[60:63], v[92:107]
    ds_read_b128 v[28:31], v17 offset:0
    ds_read_b64_tr_b16 v[32:33], v26 offset:0
    ds_read_b64_tr_b16 v[34:35], v26 offset:768
    ds_read_b64_tr_b16 v[36:37], v26 offset:64
    v_mfma_f32_32x32x16_bf16 v[108:123], v[68:71], v[60:63], v[108:123]
    ds_read_b64_tr_b16 v[38:39], v26 offset:832
    ds_read_b64_tr_b16 v[40:41], v26 offset:128
    ds_read_b64_tr_b16 v[42:43], v26 offset:896
    v_mfma_f32_32x32x16_bf16 v[124:139], v[72:75], v[60:63], v[124:139]
    ds_read_b128 v[44:47], v18 offset:0
    ds_read_b64_tr_b16 v[48:49], v26 offset:3072
    ds_read_b64_tr_b16 v[50:51], v26 offset:3840
    ds_read_b64_tr_b16 v[52:53], v26 offset:3136
    v_mfma_f32_32x32x16_bf16 v[92:107], v[80:83], v[76:79], v[92:107]
    ds_read_b64_tr_b16 v[54:55], v26 offset:3904
    ds_read_b64_tr_b16 v[56:57], v26 offset:3200
    ds_read_b64_tr_b16 v[58:59], v26 offset:3968
    v_mfma_f32_32x32x16_bf16 v[108:123], v[84:87], v[76:79], v[108:123]
    s_add_u32 m0, s40, 0
    s_nop 0
    buffer_load_dwordx4 v7, s[8:11], s42 offen lds
    s_add_u32 m0, s40, 1024
    s_nop 0
    buffer_load_dwordx4 v8, s[8:11], s42 offen lds
    s_add_u32 m0, s40, 2048
    s_nop 0
    buffer_load_dwordx4 v9, s[8:11], s42 offen lds
    s_add_u32 m0, s40, 3072
    s_nop 0
    buffer_load_dwordx4 v10, s[8:11], s42 offen lds
    v_mfma_f32_32x32x16_bf16 v[124:139], v[88:91], v[76:79], v[124:139]
    s_add_u32 m0, s50, 0
    s_nop 0
    buffer_load_dwordx4 v11, s[12:15], s43 offen lds
    s_add_u32 m0, s51, 0
    s_nop 0
    buffer_load_dwordx4 v12, s[12:15], s43 offen lds
    s_add_u32 s42, s42, 128
    s_add_u32 s43, s43, 393216
    s_waitcnt lgkmcnt(0)
    v_mfma_f32_32x32x16_bf16 v[92:107], v[32:35], v[28:31], v[92:107]
    ds_read_b128 v[60:63], v19 offset:0
    ds_read_b64_tr_b16 v[64:65], v26 offset:6144
    ds_read_b64_tr_b16 v[66:67], v26 offset:6912
    v_mfma_f32_32x32x16_bf16 v[108:123], v[36:39], v[28:31], v[108:123]
    ds_read_b64_tr_b16 v[68:69], v26 offset:6208
    ds_read_b64_tr_b16 v[70:71], v26 offset:6976
    v_mfma_f32_32x32x16_bf16 v[124:139], v[40:43], v[28:31], v[124:139]
    ds_read_b64_tr_b16 v[72:73], v26 offset:6272
    ds_read_b64_tr_b16 v[74:75], v26 offset:7040
    v_mfma_f32_32x32x16_bf16 v[92:107], v[48:51], v[44:47], v[92:107]
    ds_read_b128 v[76:79], v20 offset:0
    ds_read_b64_tr_b16 v[80:81], v26 offset:9216
    ds_read_b64_tr_b16 v[82:83], v26 offset:9984
    v_mfma_f32_32x32x16_bf16 v[108:123], v[52:55], v[44:47], v[108:123]
    ds_read_b64_tr_b16 v[84:85], v26 offset:9280
    ds_read_b64_tr_b16 v[86:87], v26 offset:10048
    v_mfma_f32_32x32x16_bf16 v[124:139], v[56:59], v[44:47], v[124:139]
    ds_read_b64_tr_b16 v[88:89], v26 offset:9344
    ds_read_b64_tr_b16 v[90:91], v26 offset:10112
    s_waitcnt vmcnt(6) lgkmcnt(0)
    s_barrier
    v_mfma_f32_32x32x16_bf16 v[92:107], v[64:67], v[60:63], v[92:107]
    ds_read_b128 v[28:31], v21 offset:0
    ds_read_b64_tr_b16 v[32:33], v27 offset:0
    ds_read_b64_tr_b16 v[34:35], v27 offset:768
    ds_read_b64_tr_b16 v[36:37], v27 offset:64
    v_mfma_f32_32x32x16_bf16 v[108:123], v[68:71], v[60:63], v[108:123]
    ds_read_b64_tr_b16 v[38:39], v27 offset:832
    ds_read_b64_tr_b16 v[40:41], v27 offset:128
    ds_read_b64_tr_b16 v[42:43], v27 offset:896
    v_mfma_f32_32x32x16_bf16 v[124:139], v[72:75], v[60:63], v[124:139]
    ds_read_b128 v[44:47], v22 offset:0
    ds_read_b64_tr_b16 v[48:49], v27 offset:3072
    ds_read_b64_tr_b16 v[50:51], v27 offset:3840
    ds_read_b64_tr_b16 v[52:53], v27 offset:3136
    v_mfma_f32_32x32x16_bf16 v[92:107], v[80:83], v[76:79], v[92:107]
    ds_read_b64_tr_b16 v[54:55], v27 offset:3904
    ds_read_b64_tr_b16 v[56:57], v27 offset:3200
    ds_read_b64_tr_b16 v[58:59], v27 offset:3968
    v_mfma_f32_32x32x16_bf16 v[108:123], v[84:87], v[76:79], v[108:123]
    s_add_u32 m0, s40, 45056
    s_nop 0
    buffer_load_dwordx4 v7, s[8:11], s42 offen lds
    s_add_u32 m0, s40, 46080
    s_nop 0
    buffer_load_dwordx4 v8, s[8:11], s42 offen lds
    s_add_u32 m0, s40, 47104
    s_nop 0
    buffer_load_dwordx4 v9, s[8:11], s42 offen lds
    s_add_u32 m0, s40, 48128
    s_nop 0
    buffer_load_dwordx4 v10, s[8:11], s42 offen lds
    v_mfma_f32_32x32x16_bf16 v[124:139], v[88:91], v[76:79], v[124:139]
    s_add_u32 m0, s50, 45056
    s_nop 0
    buffer_load_dwordx4 v11, s[12:15], s43 offen lds
    s_add_u32 m0, s51, 45056
    s_nop 0
    buffer_load_dwordx4 v12, s[12:15], s43 offen lds
    s_add_u32 s42, s42, 128
    s_add_u32 s43, s43, 393216
    s_waitcnt lgkmcnt(0)
    v_mfma_f32_32x32x16_bf16 v[92:107], v[32:35], v[28:31], v[92:107]
    ds_read_b128 v[60:63], v23 offset:0
    ds_read_b64_tr_b16 v[64:65], v27 offset:6144
    ds_read_b64_tr_b16 v[66:67], v27 offset:6912
    v_mfma_f32_32x32x16_bf16 v[108:123], v[36:39], v[28:31], v[108:123]
    ds_read_b64_tr_b16 v[68:69], v27 offset:6208
    ds_read_b64_tr_b16 v[70:71], v27 offset:6976
    v_mfma_f32_32x32x16_bf16 v[124:139], v[40:43], v[28:31], v[124:139]
    ds_read_b64_tr_b16 v[72:73], v27 offset:6272
    ds_read_b64_tr_b16 v[74:75], v27 offset:7040
    v_mfma_f32_32x32x16_bf16 v[92:107], v[48:51], v[44:47], v[92:107]
    ds_read_b128 v[76:79], v24 offset:0
    ds_read_b64_tr_b16 v[80:81], v27 offset:9216
    ds_read_b64_tr_b16 v[82:83], v27 offset:9984
    v_mfma_f32_32x32x16_bf16 v[108:123], v[52:55], v[44:47], v[108:123]
    ds_read_b64_tr_b16 v[84:85], v27 offset:9280
    ds_read_b64_tr_b16 v[86:87], v27 offset:10048
    v_mfma_f32_32x32x16_bf16 v[124:139], v[56:59], v[44:47], v[124:139]
    ds_read_b64_tr_b16 v[88:89], v27 offset:9344
    ds_read_b64_tr_b16 v[90:91], v27 offset:10112
    s_waitcnt vmcnt(6) lgkmcnt(0)
    s_barrier
    v_mfma_f32_32x32x16_bf16 v[92:107], v[64:67], v[60:63], v[92:107]
    ds_read_b128 v[28:31], v13 offset:0
    ds_read_b64_tr_b16 v[32:33], v25 offset:0
    ds_read_b64_tr_b16 v[34:35], v25 offset:768
    ds_read_b64_tr_b16 v[36:37], v25 offset:64
    v_mfma_f32_32x32x16_bf16 v[108:123], v[68:71], v[60:63], v[108:123]
    ds_read_b64_tr_b16 v[38:39], v25 offset:832
    ds_read_b64_tr_b16 v[40:41], v25 offset:128
    ds_read_b64_tr_b16 v[42:43], v25 offset:896
    v_mfma_f32_32x32x16_bf16 v[124:139], v[72:75], v[60:63], v[124:139]
    ds_read_b128 v[44:47], v14 offset:0
    ds_read_b64_tr_b16 v[48:49], v25 offset:3072
    ds_read_b64_tr_b16 v[50:51], v25 offset:3840
    ds_read_b64_tr_b16 v[52:53], v25 offset:3136
    v_mfma_f32_32x32x16_bf16 v[92:107], v[80:83], v[76:79], v[92:107]
    ds_read_b64_tr_b16 v[54:55], v25 offset:3904
    ds_read_b64_tr_b16 v[56:57], v25 offset:3200
    ds_read_b64_tr_b16 v[58:59], v25 offset:3968
    v_mfma_f32_32x32x16_bf16 v[108:123], v[84:87], v[76:79], v[108:123]
    s_add_u32 m0, s40, 90112
    s_nop 0
    buffer_load_dwordx4 v7, s[8:11], s42 offen lds
    s_add_u32 m0, s40, 91136
    s_nop 0
    buffer_load_dwordx4 v8, s[8:11], s42 offen lds
    s_add_u32 m0, s40, 92160
    s_nop 0
    buffer_load_dwordx4 v9, s[8:11], s42 offen lds
    s_add_u32 m0, s40, 93184
    s_nop 0
    buffer_load_dwordx4 v10, s[8:11], s42 offen lds
    v_mfma_f32_32x32x16_bf16 v[124:139], v[88:91], v[76:79], v[124:139]
    s_add_u32 m0, s50, 90112
    s_nop 0
    buffer_load_dwordx4 v11, s[12:15], s43 offen lds
    s_add_u32 m0, s51, 90112
    s_nop 0
    buffer_load_dwordx4 v12, s[12:15], s43 offen lds
    s_add_u32 s42, s42, 128
    s_add_u32 s43, s43, 393216
    s_sub_u32 s47, s47, 1
    s_cmp_lg_u32 s47, 0
    s_cbranch_scc1 qkv_kernel_loop
    s_waitcnt lgkmcnt(0)
    v_mfma_f32_32x32x16_bf16 v[92:107], v[32:35], v[28:31], v[92:107]
    ds_read_b128 v[60:63], v15 offset:0
    ds_read_b64_tr_b16 v[64:65], v25 offset:6144
    ds_read_b64_tr_b16 v[66:67], v25 offset:6912
    v_mfma_f32_32x32x16_bf16 v[108:123], v[36:39], v[28:31], v[108:123]
    ds_read_b64_tr_b16 v[68:69], v25 offset:6208
    ds_read_b64_tr_b16 v[70:71], v25 offset:6976
    v_mfma_f32_32x32x16_bf16 v[124:139], v[40:43], v[28:31], v[124:139]
    ds_read_b64_tr_b16 v[72:73], v25 offset:6272
    ds_read_b64_tr_b16 v[74:75], v25 offset:7040
    v_mfma_f32_32x32x16_bf16 v[92:107], v[48:51], v[44:47], v[92:107]
    ds_read_b128 v[76:79], v16 offset:0
    ds_read_b64_tr_b16 v[80:81], v25 offset:9216
    ds_read_b64_tr_b16 v[82:83], v25 offset:9984
    v_mfma_f32_32x32x16_bf16 v[108:123], v[52:55], v[44:47], v[108:123]
    ds_read_b64_tr_b16 v[84:85], v25 offset:9280
    ds_read_b64_tr_b16 v[86:87], v25 offset:10048
    v_mfma_f32_32x32x16_bf16 v[124:139], v[56:59], v[44:47], v[124:139]
    ds_read_b64_tr_b16 v[88:89], v25 offset:9344
    ds_read_b64_tr_b16 v[90:91], v25 offset:10112
    s_waitcnt vmcnt(6) lgkmcnt(0)
    s_barrier
    v_mfma_f32_32x32x16_bf16 v[92:107], v[64:67], v[60:63], v[92:107]
    ds_read_b128 v[28:31], v17 offset:0
    ds_read_b64_tr_b16 v[32:33], v26 offset:0
    ds_read_b64_tr_b16 v[34:35], v26 offset:768
    ds_read_b64_tr_b16 v[36:37], v26 offset:64
    v_mfma_f32_32x32x16_bf16 v[108:123], v[68:71], v[60:63], v[108:123]
    ds_read_b64_tr_b16 v[38:39], v26 offset:832
    ds_read_b64_tr_b16 v[40:41], v26 offset:128
    ds_read_b64_tr_b16 v[42:43], v26 offset:896
    v_mfma_f32_32x32x16_bf16 v[124:139], v[72:75], v[60:63], v[124:139]
    ds_read_b128 v[44:47], v18 offset:0
    ds_read_b64_tr_b16 v[48:49], v26 offset:3072
    ds_read_b64_tr_b16 v[50:51], v26 offset:3840
    ds_read_b64_tr_b16 v[52:53], v26 offset:3136
    v_mfma_f32_32x32x16_bf16 v[92:107], v[80:83], v[76:79], v[92:107]
    ds_read_b64_tr_b16 v[54:55], v26 offset:3904
    ds_read_b64_tr_b16 v[56:57], v26 offset:3200
    ds_read_b64_tr_b16 v[58:59], v26 offset:3968
    v_mfma_f32_32x32x16_bf16 v[108:123], v[84:87], v[76:79], v[108:123]
    s_mov_b32 s42, 1920
    s_mov_b32 s43, 5898240
    s_add_u32 m0, s40, 0
    s_nop 0
    buffer_load_dwordx4 v7, s[8:11], s42 offen lds
    s_add_u32 m0, s40, 1024
    s_nop 0
    buffer_load_dwordx4 v8, s[8:11], s42 offen lds
    s_add_u32 m0, s40, 2048
    s_nop 0
    buffer_load_dwordx4 v9, s[8:11], s42 offen lds
    v_mfma_f32_32x32x16_bf16 v[124:139], v[88:91], v[76:79], v[124:139]
    s_add_u32 m0, s40, 3072
    s_nop 0
    buffer_load_dwordx4 v10, s[8:11], s42 offen lds
    s_add_u32 m0, s50, 0
    s_nop 0
    buffer_load_dwordx4 v11, s[12:15], s43 offen lds
    s_add_u32 m0, s51, 0
    s_nop 0
    buffer_load_dwordx4 v12, s[12:15], s43 offen lds
    s_waitcnt lgkmcnt(0)
    v_mfma_f32_32x32x16_bf16 v[92:107], v[32:35], v[28:31], v[92:107]
    ds_read_b128 v[60:63], v19 offset:0
    ds_read_b64_tr_b16 v[64:65], v26 offset:6144
    ds_read_b64_tr_b16 v[66:67], v26 offset:6912
    v_mfma_f32_32x32x16_bf16 v[108:123], v[36:39], v[28:31], v[108:123]
    ds_read_b64_tr_b16 v[68:69], v26 offset:6208
    ds_read_b64_tr_b16 v[70:71], v26 offset:6976
    v_mfma_f32_32x32x16_bf16 v[124:139], v[40:43], v[28:31], v[124:139]
    ds_read_b64_tr_b16 v[72:73], v26 offset:6272
    ds_read_b64_tr_b16 v[74:75], v26 offset:7040
    v_mfma_f32_32x32x16_bf16 v[92:107], v[48:51], v[44:47], v[92:107]
    ds_read_b128 v[76:79], v20 offset:0
    ds_read_b64_tr_b16 v[80:81], v26 offset:9216
    ds_read_b64_tr_b16 v[82:83], v26 offset:9984
    v_mfma_f32_32x32x16_bf16 v[108:123], v[52:55], v[44:47], v[108:123]
    ds_read_b64_tr_b16 v[84:85], v26 offset:9280
    ds_read_b64_tr_b16 v[86:87], v26 offset:10048
    v_mfma_f32_32x32x16_bf16 v[124:139], v[56:59], v[44:47], v[124:139]
    ds_read_b64_tr_b16 v[88:89], v26 offset:9344
    ds_read_b64_tr_b16 v[90:91], v26 offset:10112
    s_waitcnt vmcnt(6) lgkmcnt(0)
    s_barrier
    v_mfma_f32_32x32x16_bf16 v[92:107], v[64:67], v[60:63], v[92:107]
    ds_read_b128 v[28:31], v21 offset:0
    ds_read_b64_tr_b16 v[32:33], v27 offset:0
    ds_read_b64_tr_b16 v[34:35], v27 offset:768
    v_mfma_f32_32x32x16_bf16 v[108:123], v[68:71], v[60:63], v[108:123]
    ds_read_b64_tr_b16 v[36:37], v27 offset:64
    ds_read_b64_tr_b16 v[38:39], v27 offset:832
    v_mfma_f32_32x32x16_bf16 v[124:139], v[72:75], v[60:63], v[124:139]
    ds_read_b64_tr_b16 v[40:41], v27 offset:128
    ds_read_b64_tr_b16 v[42:43], v27 offset:896
    v_mfma_f32_32x32x16_bf16 v[92:107], v[80:83], v[76:79], v[92:107]
    ds_read_b128 v[44:47], v22 offset:0
    ds_read_b64_tr_b16 v[48:49], v27 offset:3072
    ds_read_b64_tr_b16 v[50:51], v27 offset:3840
    v_mfma_f32_32x32x16_bf16 v[108:123], v[84:87], v[76:79], v[108:123]
    ds_read_b64_tr_b16 v[52:53], v27 offset:3136
    ds_read_b64_tr_b16 v[54:55], v27 offset:3904
    v_mfma_f32_32x32x16_bf16 v[124:139], v[88:91], v[76:79], v[124:139]
    ds_read_b64_tr_b16 v[56:57], v27 offset:3200
    ds_read_b64_tr_b16 v[58:59], v27 offset:3968
    s_waitcnt lgkmcnt(0)
    v_mfma_f32_32x32x16_bf16 v[92:107], v[32:35], v[28:31], v[92:107]
    ds_read_b128 v[60:63], v23 offset:0
    ds_read_b64_tr_b16 v[64:65], v27 offset:6144
    ds_read_b64_tr_b16 v[66:67], v27 offset:6912
    v_mfma_f32_32x32x16_bf16 v[108:123], v[36:39], v[28:31], v[108:123]
    ds_read_b64_tr_b16 v[68:69], v27 offset:6208
    ds_read_b64_tr_b16 v[70:71], v27 offset:6976
    v_mfma_f32_32x32x16_bf16 v[124:139], v[40:43], v[28:31], v[124:139]
    ds_read_b64_tr_b16 v[72:73], v27 offset:6272
    ds_read_b64_tr_b16 v[74:75], v27 offset:7040
    v_mfma_f32_32x32x16_bf16 v[92:107], v[48:51], v[44:47], v[92:107]
    ds_read_b128 v[76:79], v24 offset:0
    ds_read_b64_tr_b16 v[80:81], v27 offset:9216
    ds_read_b64_tr_b16 v[82:83], v27 offset:9984
    v_mfma_f32_32x32x16_bf16 v[108:123], v[52:55], v[44:47], v[108:123]
    ds_read_b64_tr_b16 v[84:85], v27 offset:9280
    ds_read_b64_tr_b16 v[86:87], v27 offset:10048
    v_mfma_f32_32x32x16_bf16 v[124:139], v[56:59], v[44:47], v[124:139]
    ds_read_b64_tr_b16 v[88:89], v27 offset:9344
    ds_read_b64_tr_b16 v[90:91], v27 offset:10112
    s_waitcnt vmcnt(0) lgkmcnt(0)
    s_barrier
    v_mfma_f32_32x32x16_bf16 v[92:107], v[64:67], v[60:63], v[92:107]
    ds_read_b128 v[28:31], v13 offset:0
    ds_read_b64_tr_b16 v[32:33], v25 offset:0
    ds_read_b64_tr_b16 v[34:35], v25 offset:768
    v_mfma_f32_32x32x16_bf16 v[108:123], v[68:71], v[60:63], v[108:123]
    ds_read_b64_tr_b16 v[36:37], v25 offset:64
    ds_read_b64_tr_b16 v[38:39], v25 offset:832
    v_mfma_f32_32x32x16_bf16 v[124:139], v[72:75], v[60:63], v[124:139]
    ds_read_b64_tr_b16 v[40:41], v25 offset:128
    ds_read_b64_tr_b16 v[42:43], v25 offset:896
    v_mfma_f32_32x32x16_bf16 v[92:107], v[80:83], v[76:79], v[92:107]
    ds_read_b128 v[44:47], v14 offset:0
    ds_read_b64_tr_b16 v[48:49], v25 offset:3072
    ds_read_b64_tr_b16 v[50:51], v25 offset:3840
    v_mfma_f32_32x32x16_bf16 v[108:123], v[84:87], v[76:79], v[108:123]
    ds_read_b64_tr_b16 v[52:53], v25 offset:3136
    ds_read_b64_tr_b16 v[54:55], v25 offset:3904
    v_mfma_f32_32x32x16_bf16 v[124:139], v[88:91], v[76:79], v[124:139]
    ds_read_b64_tr_b16 v[56:57], v25 offset:3200
    ds_read_b64_tr_b16 v[58:59], v25 offset:3968
    s_waitcnt lgkmcnt(0)
    v_mfma_f32_32x32x16_bf16 v[92:107], v[32:35], v[28:31], v[92:107]
    ds_read_b128 v[60:63], v15 offset:0
    ds_read_b64_tr_b16 v[64:65], v25 offset:6144
    ds_read_b64_tr_b16 v[66:67], v25 offset:6912
    v_mfma_f32_32x32x16_bf16 v[108:123], v[36:39], v[28:31], v[108:123]
    ds_read_b64_tr_b16 v[68:69], v25 offset:6208
    ds_read_b64_tr_b16 v[70:71], v25 offset:6976
    v_mfma_f32_32x32x16_bf16 v[124:139], v[40:43], v[28:31], v[124:139]
    ds_read_b64_tr_b16 v[72:73], v25 offset:6272
    ds_read_b64_tr_b16 v[74:75], v25 offset:7040
    v_mfma_f32_32x32x16_bf16 v[92:107], v[48:51], v[44:47], v[92:107]
    ds_read_b128 v[76:79], v16 offset:0
    ds_read_b64_tr_b16 v[80:81], v25 offset:9216
    ds_read_b64_tr_b16 v[82:83], v25 offset:9984
    v_mfma_f32_32x32x16_bf16 v[108:123], v[52:55], v[44:47], v[108:123]
    ds_read_b64_tr_b16 v[84:85], v25 offset:9280
    ds_read_b64_tr_b16 v[86:87], v25 offset:10048
    v_mfma_f32_32x32x16_bf16 v[124:139], v[56:59], v[44:47], v[124:139]
    ds_read_b64_tr_b16 v[88:89], v25 offset:9344
    ds_read_b64_tr_b16 v[90:91], v25 offset:10112
    s_waitcnt lgkmcnt(0)
    v_mfma_f32_32x32x16_bf16 v[92:107], v[64:67], v[60:63], v[92:107]
    v_mfma_f32_32x32x16_bf16 v[108:123], v[68:71], v[60:63], v[108:123]
    v_mfma_f32_32x32x16_bf16 v[124:139], v[72:75], v[60:63], v[124:139]
    v_mfma_f32_32x32x16_bf16 v[92:107], v[80:83], v[76:79], v[92:107]
    v_mfma_f32_32x32x16_bf16 v[108:123], v[84:87], v[76:79], v[108:123]
    v_mfma_f32_32x32x16_bf16 v[124:139], v[88:91], v[76:79], v[124:139]
    v_and_b32 v1, 31, v0
    v_lshrrev_b32 v2, 5, v0
    s_mul_i32 s36, s28, 256
    s_mul_i32 s31, s44, 32
    s_add_u32 s36, s36, s31
    v_add_u32 v1, s36, v1
    v_lshlrev_b32 v3, 6, v1
    v_lshl_add_u32 v3, v2, 4, v3
    s_mul_i32 s37, s29, 3
    s_add_u32 s37, s37, 0
    s_cmp_lt_u32 s37, 32
    s_cselect_b32 s54, 0x3e8293ee, 1.0
    s_lshl_b32 s57, s37, 17
    s_mul_i32 s37, s29, 3
    s_add_u32 s37, s37, 1
    s_cmp_lt_u32 s37, 32
    s_cselect_b32 s55, 0x3e8293ee, 1.0
    s_lshl_b32 s58, s37, 17
    s_mul_i32 s37, s29, 3
    s_add_u32 s37, s37, 2
    s_cmp_lt_u32 s37, 32
    s_cselect_b32 s56, 0x3e8293ee, 1.0
    s_lshl_b32 s59, s37, 17
    s_nop 15
    v_mul_f32 v92, s54, v92
    v_mul_f32 v93, s54, v93
    v_mul_f32 v94, s54, v94
    v_mul_f32 v95, s54, v95
    v_mul_f32 v96, s54, v96
    v_mul_f32 v97, s54, v97
    v_mul_f32 v98, s54, v98
    v_mul_f32 v99, s54, v99
    v_mul_f32 v100, s54, v100
    v_mul_f32 v101, s54, v101
    v_mul_f32 v102, s54, v102
    v_mul_f32 v103, s54, v103
    v_mul_f32 v104, s54, v104
    v_mul_f32 v105, s54, v105
    v_mul_f32 v106, s54, v106
    v_mul_f32 v107, s54, v107
    v_cvt_pk_bf16_f32 v44, v92, v93
    v_cvt_pk_bf16_f32 v45, v94, v95
    v_cvt_pk_bf16_f32 v46, v96, v97
    v_cvt_pk_bf16_f32 v47, v98, v99
    v_cvt_pk_bf16_f32 v48, v100, v101
    v_cvt_pk_bf16_f32 v49, v102, v103
    v_cvt_pk_bf16_f32 v50, v104, v105
    v_cvt_pk_bf16_f32 v51, v106, v107
    s_nop 1
    v_permlane32_swap_b32 v44, v46
    v_permlane32_swap_b32 v45, v47
    v_permlane32_swap_b32 v48, v50
    v_permlane32_swap_b32 v49, v51
    buffer_store_dwordx4 v[44:47], v3, s[16:19], s57 offen offset:0
    buffer_store_dwordx4 v[48:51], v3, s[16:19], s57 offen offset:32
    v_mul_f32 v108, s55, v108
    v_mul_f32 v109, s55, v109
    v_mul_f32 v110, s55, v110
    v_mul_f32 v111, s55, v111
    v_mul_f32 v112, s55, v112
    v_mul_f32 v113, s55, v113
    v_mul_f32 v114, s55, v114
    v_mul_f32 v115, s55, v115
    v_mul_f32 v116, s55, v116
    v_mul_f32 v117, s55, v117
    v_mul_f32 v118, s55, v118
    v_mul_f32 v119, s55, v119
    v_mul_f32 v120, s55, v120
    v_mul_f32 v121, s55, v121
    v_mul_f32 v122, s55, v122
    v_mul_f32 v123, s55, v123
    v_cvt_pk_bf16_f32 v52, v108, v109
    v_cvt_pk_bf16_f32 v53, v110, v111
    v_cvt_pk_bf16_f32 v54, v112, v113
    v_cvt_pk_bf16_f32 v55, v114, v115
    v_cvt_pk_bf16_f32 v56, v116, v117
    v_cvt_pk_bf16_f32 v57, v118, v119
    v_cvt_pk_bf16_f32 v58, v120, v121
    v_cvt_pk_bf16_f32 v59, v122, v123
    s_nop 1
    v_permlane32_swap_b32 v52, v54
    v_permlane32_swap_b32 v53, v55
    v_permlane32_swap_b32 v56, v58
    v_permlane32_swap_b32 v57, v59
    buffer_store_dwordx4 v[52:55], v3, s[16:19], s58 offen offset:0
    buffer_store_dwordx4 v[56:59], v3, s[16:19], s58 offen offset:32
    v_mul_f32 v124, s56, v124
    v_mul_f32 v125, s56, v125
    v_mul_f32 v126, s56, v126
    v_mul_f32 v127, s56, v127
    v_mul_f32 v128, s56, v128
    v_mul_f32 v129, s56, v129
    v_mul_f32 v130, s56, v130
    v_mul_f32 v131, s56, v131
    v_mul_f32 v132, s56, v132
    v_mul_f32 v133, s56, v133
    v_mul_f32 v134, s56, v134
    v_mul_f32 v135, s56, v135
    v_mul_f32 v136, s56, v136
    v_mul_f32 v137, s56, v137
    v_mul_f32 v138, s56, v138
    v_mul_f32 v139, s56, v139
    v_cvt_pk_bf16_f32 v60, v124, v125
    v_cvt_pk_bf16_f32 v61, v126, v127
    v_cvt_pk_bf16_f32 v62, v128, v129
    v_cvt_pk_bf16_f32 v63, v130, v131
    v_cvt_pk_bf16_f32 v64, v132, v133
    v_cvt_pk_bf16_f32 v65, v134, v135
    v_cvt_pk_bf16_f32 v66, v136, v137
    v_cvt_pk_bf16_f32 v67, v138, v139
    s_nop 1
    v_permlane32_swap_b32 v60, v62
    v_permlane32_swap_b32 v61, v63
    v_permlane32_swap_b32 v64, v66
    v_permlane32_swap_b32 v65, v67
    buffer_store_dwordx4 v[60:63], v3, s[16:19], s59 offen offset:0
    buffer_store_dwordx4 v[64:67], v3, s[16:19], s59 offen offset:32
qkv_kernel_end:
    s_endpgm
.globl attn_kernel
.p2align 8
.type attn_kernel,@function
attn_kernel:
    s_cmp_ge_u32 s2, 256
    s_cbranch_scc1 attn_kernel_end
    s_load_dwordx2 s[4:5], s[0:1], 88
    s_load_dwordx2 s[72:73], s[0:1], 32
    s_load_dwordx2 s[74:75], s[0:1], 40
    s_load_dwordx2 s[76:77], s[0:1], 48
    s_load_dwordx2 s[78:79], s[0:1], 16
    v_lshlrev_b32 v165, 4, v0
    s_lshl_b32 s31, s2, 13
    v_add_u32 v165, s31, v165
    v_lshrrev_b32 v1, 6, v0
    v_and_b32 v0, 63, v0
    s_nop 0
    v_readfirstlane_b32 s30, v1
    s_and_b32 s28, s2, 31
    s_lshr_b32 s29, s2, 5
    v_lshrrev_b32 v1, 2, v0
    v_and_b32 v2, 3, v0
    v_lshrrev_b32 v3, 4, v0
    v_xor_b32 v2, v2, v3
    v_lshlrev_b32 v1, 6, v1
    v_lshl_add_u32 v1, v2, 4, v1
    s_mul_i32 s40, s30, 1024
    v_add_u32 v8, s40, v1
    v_lshlrev_b32 v1, 4, v0
    v_add_u32 v9, s40, v1
    v_and_b32 v1, 31, v0
    v_lshrrev_b32 v2, 5, v0
    s_lshl_b32 s31, s29, 8
    s_lshl_b32 s34, s30, 5
    s_add_u32 s34, s34, s31
    v_add_u32 v3, s34, v1
    v_lshlrev_b32 v16, 6, v3
    v_lshl_add_u32 v16, v2, 4, v16
    s_waitcnt lgkmcnt(0)
    s_lshl_b32 s31, s28, 17
    s_add_u32 s32, s4, s31
    s_addc_u32 s33, s5, 0
    s_add_u32 s8, s32, 5242880
    s_addc_u32 s9, s33, 0
    s_and_b32 s9, s9, 0xffff
    s_mov_b32 s10, 131072
    s_mov_b32 s11, 0x00020000
    s_add_u32 s12, s32, 9437184
    s_addc_u32 s13, s33, 0
    s_and_b32 s13, s13, 0xffff
    s_mov_b32 s14, 131072
    s_mov_b32 s15, 0x00020000
    s_add_u32 s16, s32, 13631488
    s_addc_u32 s17, s33, 0
    s_and_b32 s17, s17, 0xffff
    s_mov_b32 s18, 131072
    s_mov_b32 s19, 0x00020000
    s_add_u32 s20, s4, 17825792
    s_addc_u32 s21, s5, 0
    s_and_b32 s21, s21, 0xffff
    s_mov_b32 s22, 4194304
    s_mov_b32 s23, 0x00020000
    s_mov_b32 s48, s72
    s_and_b32 s49, s73, 0xffff
    s_mov_b32 s50, 7340032
    s_mov_b32 s51, 0x00020000
    s_mov_b32 s52, s74
    s_and_b32 s53, s75, 0xffff
    s_mov_b32 s54, 7340032
    s_mov_b32 s55, 0x00020000
    s_mov_b32 s56, s76
    s_and_b32 s57, s77, 0xffff
    s_mov_b32 s58, 7340032
    s_mov_b32 s59, 0x00020000
    s_mov_b32 s80, s78
    s_and_b32 s81, s79, 0xffff
    s_mov_b32 s82, 2097152
    s_mov_b32 s83, 0x00020000
    s_mov_b32 s42, 0
    buffer_load_dwordx4 v[20:23], v16, s[8:11], 0 offen
    buffer_load_dwordx4 v[24:27], v16, s[8:11], 0 offen offset:32
    s_add_u32 m0, s40, 0
    s_nop 0
    buffer_load_dwordx4 v8, s[12:15], s42 offen offset:0 lds
    s_add_u32 m0, s40, 8192
    s_nop 0
    buffer_load_dwordx4 v9, s[16:19], s42 offen offset:0 lds
    s_add_u32 s42, s42, 8192
    s_add_u32 m0, s40, 16384
    s_nop 0
    buffer_load_dwordx4 v8, s[12:15], s42 offen offset:0 lds
    s_add_u32 m0, s40, 24576
    s_nop 0
    buffer_load_dwordx4 v9, s[16:19], s42 offen offset:0 lds
    s_add_u32 s42, s42, 8192
    v_lshlrev_b32 v5, 11, v3
    v_lshl_add_u32 v5, v2, 4, v5
    s_lshl_b32 s31, s28, 6
    v_add_u32 v5, s31, v5
    v_bfe_u32 v3, v1, 2, 2
    v_xor_b32 v3, v3, v2
    v_lshlrev_b32 v4, 6, v1
    v_lshl_add_u32 v10, v3, 4, v4
    v_xor_b32 v11, 32, v10
    v_add_u32 v12, 0x10000, v10
    v_add_u32 v13, 0x10000, v11
    v_and_b32 v1, 15, v0
    v_bfe_u32 v3, v0, 4, 1
    v_lshrrev_b32 v4, 2, v1
    v_lshl_add_u32 v4, v2, 2, v4
    v_lshlrev_b32 v4, 6, v4
    v_lshl_add_u32 v4, v3, 5, v4
    v_and_b32 v1, 3, v1
    v_lshl_add_u32 v4, v1, 3, v4
    v_add_u32 v14, 8192, v4
    v_add_u32 v15, 0x10000, v14
    v_mov_b32 v28, 0x3f803f80
    v_mov_b32 v29, 0x3f803f80
    v_mov_b32 v30, 0x3f803f80
    v_mov_b32 v31, 0x3f803f80
    v_mov_b32 v80, 0
    v_mov_b32 v96, 0
    v_mov_b32 v81, 0
    v_mov_b32 v97, 0
    v_mov_b32 v82, 0
    v_mov_b32 v98, 0
    v_mov_b32 v83, 0
    v_mov_b32 v99, 0
    v_mov_b32 v84, 0
    v_mov_b32 v100, 0
    v_mov_b32 v85, 0
    v_mov_b32 v101, 0
    v_mov_b32 v86, 0
    v_mov_b32 v102, 0
    v_mov_b32 v87, 0
    v_mov_b32 v103, 0
    v_mov_b32 v88, 0
    v_mov_b32 v104, 0
    v_mov_b32 v89, 0
    v_mov_b32 v105, 0
    v_mov_b32 v90, 0
    v_mov_b32 v106, 0
    v_mov_b32 v91, 0
    v_mov_b32 v107, 0
    v_mov_b32 v92, 0
    v_mov_b32 v108, 0
    v_mov_b32 v93, 0
    v_mov_b32 v109, 0
    v_mov_b32 v94, 0
    v_mov_b32 v110, 0
    v_mov_b32 v95, 0
    v_mov_b32 v111, 0
    v_mov_b32 v152, 0
    v_mov_b32 v136, 0
    v_mov_b32 v153, 0
    v_mov_b32 v137, 0
    v_mov_b32 v154, 0
    v_mov_b32 v138, 0
    v_mov_b32 v155, 0
    v_mov_b32 v139, 0
    v_mov_b32 v156, 0
    v_mov_b32 v140, 0
    v_mov_b32 v157, 0
    v_mov_b32 v141, 0
    v_mov_b32 v158, 0
    v_mov_b32 v142, 0
    v_mov_b32 v159, 0
    v_mov_b32 v143, 0
    v_mov_b32 v164, 0
    s_mov_b32 s46, 0
    s_waitcnt vmcnt(2) lgkmcnt(0)
    s_barrier
    buffer_load_dwordx4 v[168:171], v165, s[80:83], s46 offen
    s_add_u32 m0, s40, 32768
    s_nop 0
    buffer_load_dwordx4 v8, s[12:15], s42 offen offset:0 lds
    s_add_u32 m0, s40, 40960
    s_nop 0
    buffer_load_dwordx4 v9, s[16:19], s42 offen offset:0 lds
    s_add_u32 s42, s42, 8192
    buffer_load_dwordx4 v[168:171], v165, s[80:83], s46 offen
    ds_read_b128 v[112:115], v10 offset:0
    ds_read_b128 v[116:119], v11 offset:0
    ds_read_b128 v[120:123], v10 offset:2048
    ds_read_b128 v[124:127], v11 offset:2048
    s_waitcnt lgkmcnt(2)
    v_mfma_f32_32x32x16_bf16 v[32:47], v[112:115], v[20:23], 0
    v_mfma_f32_32x32x16_bf16 v[32:47], v[116:119], v[24:27], v[32:47]
    s_nop 15
    v_max3_f32 v160, v32, v33, v34
    v_max3_f32 v160, v160, v35, v36
    v_max3_f32 v160, v160, v37, v38
    v_max3_f32 v160, v160, v39, v40
    v_max3_f32 v160, v160, v41, v42
    v_max3_f32 v160, v160, v43, v44
    v_max3_f32 v160, v160, v45, v46
    v_max_f32 v160, v160, v47
    v_mov_b32 v161, v160
    s_nop 1
    v_permlane32_swap_b32 v160, v161
    v_max_f32 v160, v160, v161
    v_sub_f32 v32, v32, v160
    v_sub_f32 v64, 0, v160
    v_sub_f32 v33, v33, v160
    v_sub_f32 v65, 0, v160
    v_sub_f32 v34, v34, v160
    v_sub_f32 v66, 0, v160
    v_sub_f32 v35, v35, v160
    v_sub_f32 v67, 0, v160
    v_sub_f32 v36, v36, v160
    v_sub_f32 v68, 0, v160
    v_sub_f32 v37, v37, v160
    v_sub_f32 v69, 0, v160
    v_sub_f32 v38, v38, v160
    v_sub_f32 v70, 0, v160
    v_sub_f32 v39, v39, v160
    v_sub_f32 v71, 0, v160
    v_sub_f32 v40, v40, v160
    v_sub_f32 v72, 0, v160
    v_sub_f32 v41, v41, v160
    v_sub_f32 v73, 0, v160
    v_sub_f32 v42, v42, v160
    v_sub_f32 v74, 0, v160
    v_sub_f32 v43, v43, v160
    v_sub_f32 v75, 0, v160
    v_sub_f32 v44, v44, v160
    v_sub_f32 v76, 0, v160
    v_sub_f32 v45, v45, v160
    v_sub_f32 v77, 0, v160
    v_sub_f32 v46, v46, v160
    v_sub_f32 v78, 0, v160
    v_sub_f32 v47, v47, v160
    v_sub_f32 v79, 0, v160
    ds_read_b64_tr_b16 v[128:129], v14 offset:0
    ds_read_b64_tr_b16 v[130:131], v14 offset:512
    ds_read_b64_tr_b16 v[132:133], v14 offset:1024
    ds_read_b64_tr_b16 v[134:135], v14 offset:1536
    s_mov_b32 s47, 4
.p2align 6
attn_kernel_loopf:
    v_cmp_lt_f32 vcc, 0x53800000, v164
    s_cbranch_vccnz attn_kernel_fresc1
attn_kernel_fback2:
    s_waitcnt lgkmcnt(4)
    v_mfma_f32_32x32x16_bf16 v[48:63], v[120:123], v[20:23], v[64:79]
    v_exp_f32 v32, v32
    v_exp_f32 v33, v33
    v_exp_f32 v34, v34
    v_mfma_f32_32x32x16_bf16 v[48:63], v[124:127], v[24:27], v[48:63]
    v_exp_f32 v35, v35
    v_cvt_pk_bf16_f32 v144, v32, v33
    v_exp_f32 v36, v36
    v_exp_f32 v37, v37
    s_waitcnt lgkmcnt(0)
    v_mfma_f32_32x32x16_bf16 v[80:95], v[136:139], v[152:155], v[80:95]
    v_cvt_pk_bf16_f32 v145, v34, v35
    ds_read_b128 v[112:115], v10 offset:4096
    ds_read_b128 v[116:119], v11 offset:4096
    v_exp_f32 v38, v38
    v_exp_f32 v39, v39
    v_cvt_pk_bf16_f32 v146, v36, v37
    v_exp_f32 v40, v40
    v_mfma_f32_32x32x16_bf16 v[96:111], v[28:31], v[152:155], v[96:111]
    v_exp_f32 v41, v41
    ds_read_b64_tr_b16 v[128:129], v14 offset:0
    v_cvt_pk_bf16_f32 v147, v38, v39
    v_exp_f32 v42, v42
    v_mfma_f32_32x32x16_bf16 v[80:95], v[140:143], v[156:159], v[80:95]
    v_exp_f32 v43, v43
    ds_read_b64_tr_b16 v[130:131], v14 offset:512
    ds_read_b64_tr_b16 v[132:133], v14 offset:1024
    v_cvt_pk_bf16_f32 v148, v40, v41
    v_exp_f32 v44, v44
    v_exp_f32 v45, v45
    v_mfma_f32_32x32x16_bf16 v[96:111], v[28:31], v[156:159], v[96:111]
    v_cvt_pk_bf16_f32 v149, v42, v43
    ds_read_b64_tr_b16 v[134:135], v14 offset:1536
    v_exp_f32 v46, v46
    v_exp_f32 v47, v47
    v_cvt_pk_bf16_f32 v150, v44, v45
    v_cvt_pk_bf16_f32 v151, v46, v47
    s_waitcnt lgkmcnt(4)
    v_mfma_f32_32x32x16_bf16 v[32:47], v[112:115], v[20:23], v[64:79]
    v_exp_f32 v48, v48
    v_exp_f32 v49, v49
    v_exp_f32 v50, v50
    v_mfma_f32_32x32x16_bf16 v[32:47], v[116:119], v[24:27], v[32:47]
    v_exp_f32 v51, v51
    v_cvt_pk_bf16_f32 v152, v48, v49
    v_exp_f32 v52, v52
    v_exp_f32 v53, v53
    s_waitcnt lgkmcnt(0)
    v_mfma_f32_32x32x16_bf16 v[80:95], v[128:131], v[144:147], v[80:95]
    v_cvt_pk_bf16_f32 v153, v50, v51
    ds_read_b128 v[120:123], v10 offset:6144
    ds_read_b128 v[124:127], v11 offset:6144
    v_exp_f32 v54, v54
    v_exp_f32 v55, v55
    v_cvt_pk_bf16_f32 v154, v52, v53
    v_exp_f32 v56, v56
    v_mfma_f32_32x32x16_bf16 v[96:111], v[28:31], v[144:147], v[96:111]
    v_exp_f32 v57, v57
    ds_read_b64_tr_b16 v[136:137], v14 offset:2048
    v_cvt_pk_bf16_f32 v155, v54, v55
    v_exp_f32 v58, v58
    v_mfma_f32_32x32x16_bf16 v[80:95], v[132:135], v[148:151], v[80:95]
    v_exp_f32 v59, v59
    ds_read_b64_tr_b16 v[138:139], v14 offset:2560
    ds_read_b64_tr_b16 v[140:141], v14 offset:3072
    v_cvt_pk_bf16_f32 v156, v56, v57
    v_exp_f32 v60, v60
    v_exp_f32 v61, v61
    v_mfma_f32_32x32x16_bf16 v[96:111], v[28:31], v[148:151], v[96:111]
    v_cvt_pk_bf16_f32 v157, v58, v59
    ds_read_b64_tr_b16 v[142:143], v14 offset:3584
    v_exp_f32 v62, v62
    v_exp_f32 v63, v63
    v_cvt_pk_bf16_f32 v158, v60, v61
    v_cvt_pk_bf16_f32 v159, v62, v63
    s_waitcnt vmcnt(4) lgkmcnt(0)
    s_barrier
    s_add_u32 m0, s40, 49152
    s_nop 0
    buffer_load_dwordx4 v8, s[12:15], s42 offen offset:0 lds
    s_add_u32 m0, s40, 57344
    s_nop 0
    buffer_load_dwordx4 v9, s[16:19], s42 offen offset:0 lds
    s_add_u32 s42, s42, 8192
    buffer_load_dwordx4 v[168:171], v165, s[52:55], s46 offen
    s_waitcnt lgkmcnt(4)
    v_mfma_f32_32x32x16_bf16 v[48:63], v[120:123], v[20:23], v[64:79]
    v_exp_f32 v32, v32
    v_exp_f32 v33, v33
    v_exp_f32 v34, v34
    v_mfma_f32_32x32x16_bf16 v[48:63], v[124:127], v[24:27], v[48:63]
    v_exp_f32 v35, v35
    v_cvt_pk_bf16_f32 v144, v32, v33
    v_exp_f32 v36, v36
    v_exp_f32 v37, v37
    s_waitcnt lgkmcnt(0)
    v_mfma_f32_32x32x16_bf16 v[80:95], v[136:139], v[152:155], v[80:95]
    v_cvt_pk_bf16_f32 v145, v34, v35
    ds_read_b128 v[112:115], v10 offset:16384
    ds_read_b128 v[116:119], v11 offset:16384
    v_exp_f32 v38, v38
    v_exp_f32 v39, v39
    v_cvt_pk_bf16_f32 v146, v36, v37
    v_exp_f32 v40, v40
    v_mfma_f32_32x32x16_bf16 v[96:111], v[28:31], v[152:155], v[96:111]
    v_exp_f32 v41, v41
    ds_read_b64_tr_b16 v[128:129], v14 offset:4096
    v_cvt_pk_bf16_f32 v147, v38, v39
    v_exp_f32 v42, v42
    v_mfma_f32_32x32x16_bf16 v[80:95], v[140:143], v[156:159], v[80:95]
    v_exp_f32 v43, v43
    ds_read_b64_tr_b16 v[130:131], v14 offset:4608
    ds_read_b64_tr_b16 v[132:133], v14 offset:5120
    v_cvt_pk_bf16_f32 v148, v40, v41
    v_exp_f32 v44, v44
    v_exp_f32 v45, v45
    v_mfma_f32_32x32x16_bf16 v[96:111], v[28:31], v[156:159], v[96:111]
    v_cvt_pk_bf16_f32 v149, v42, v43
    ds_read_b64_tr_b16 v[134:135], v14 offset:5632
    v_exp_f32 v46, v46
    v_exp_f32 v47, v47
    v_cvt_pk_bf16_f32 v150, v44, v45
    v_cvt_pk_bf16_f32 v151, v46, v47
    s_waitcnt lgkmcnt(4)
    v_mfma_f32_32x32x16_bf16 v[32:47], v[112:115], v[20:23], v[64:79]
    v_exp_f32 v48, v48
    v_exp_f32 v49, v49
    v_exp_f32 v50, v50
    v_mfma_f32_32x32x16_bf16 v[32:47], v[116:119], v[24:27], v[32:47]
    v_exp_f32 v51, v51
    v_cvt_pk_bf16_f32 v152, v48, v49
    v_exp_f32 v52, v52
    v_exp_f32 v53, v53
    s_waitcnt lgkmcnt(0)
    v_mov_b32 v164, v96
    v_mfma_f32_32x32x16_bf16 v[80:95], v[128:131], v[144:147], v[80:95]
    v_cvt_pk_bf16_f32 v153, v50, v51
    ds_read_b128 v[120:123], v10 offset:18432
    ds_read_b128 v[124:127], v11 offset:18432
    v_exp_f32 v54, v54
    v_exp_f32 v55, v55
    v_cvt_pk_bf16_f32 v154, v52, v53
    v_exp_f32 v56, v56
    v_mfma_f32_32x32x16_bf16 v[96:111], v[28:31], v[144:147], v[96:111]
    v_exp_f32 v57, v57
    ds_read_b64_tr_b16 v[136:137], v14 offset:6144
    v_cvt_pk_bf16_f32 v155, v54, v55
    v_exp_f32 v58, v58
    v_mfma_f32_32x32x16_bf16 v[80:95], v[132:135], v[148:151], v[80:95]
    v_exp_f32 v59, v59
    ds_read_b64_tr_b16 v[138:139], v14 offset:6656
    ds_read_b64_tr_b16 v[140:141], v14 offset:7168
    v_cvt_pk_bf16_f32 v156, v56, v57
    v_exp_f32 v60, v60
    v_exp_f32 v61, v61
    v_mfma_f32_32x32x16_bf16 v[96:111], v[28:31], v[148:151], v[96:111]
    v_cvt_pk_bf16_f32 v157, v58, v59
    ds_read_b64_tr_b16 v[142:143], v14 offset:7680
    v_exp_f32 v62, v62
    v_exp_f32 v63, v63
    v_cvt_pk_bf16_f32 v158, v60, v61
    v_cvt_pk_bf16_f32 v159, v62, v63
    v_cmp_lt_f32 vcc, 0x53800000, v164
    s_cbranch_vccnz attn_kernel_fresc3
attn_kernel_fback4:
    s_waitcnt lgkmcnt(4)
    v_mfma_f32_32x32x16_bf16 v[48:63], v[120:123], v[20:23], v[64:79]
    v_exp_f32 v32, v32
    v_exp_f32 v33, v33
    v_exp_f32 v34, v34
    v_mfma_f32_32x32x16_bf16 v[48:63], v[124:127], v[24:27], v[48:63]
    v_exp_f32 v35, v35
    v_cvt_pk_bf16_f32 v144, v32, v33
    v_exp_f32 v36, v36
    v_exp_f32 v37, v37
    s_waitcnt lgkmcnt(0)
    v_mfma_f32_32x32x16_bf16 v[80:95], v[136:139], v[152:155], v[80:95]
    v_cvt_pk_bf16_f32 v145, v34, v35
    ds_read_b128 v[112:115], v10 offset:20480
    ds_read_b128 v[116:119], v11 offset:20480
    v_exp_f32 v38, v38
    v_exp_f32 v39, v39
    v_cvt_pk_bf16_f32 v146, v36, v37
    v_exp_f32 v40, v40
    v_mfma_f32_32x32x16_bf16 v[96:111], v[28:31], v[152:155], v[96:111]
    v_exp_f32 v41, v41
    ds_read_b64_tr_b16 v[128:129], v14 offset:16384
    v_cvt_pk_bf16_f32 v147, v38, v39
    v_exp_f32 v42, v42
    v_mfma_f32_32x32x16_bf16 v[80:95], v[140:143], v[156:159], v[80:95]
    v_exp_f32 v43, v43
    ds_read_b64_tr_b16 v[130:131], v14 offset:16896
    ds_read_b64_tr_b16 v[132:133], v14 offset:17408
    v_cvt_pk_bf16_f32 v148, v40, v41
    v_exp_f32 v44, v44
    v_exp_f32 v45, v45
    v_mfma_f32_32x32x16_bf16 v[96:111], v[28:31], v[156:159], v[96:111]
    v_cvt_pk_bf16_f32 v149, v42, v43
    ds_read_b64_tr_b16 v[134:135], v14 offset:17920
    v_exp_f32 v46, v46
    v_exp_f32 v47, v47
    v_cvt_pk_bf16_f32 v150, v44, v45
    v_cvt_pk_bf16_f32 v151, v46, v47
    s_waitcnt lgkmcnt(4)
    v_mfma_f32_32x32x16_bf16 v[32:47], v[112:115], v[20:23], v[64:79]
    v_exp_f32 v48, v48
    v_exp_f32 v49, v49
    v_exp_f32 v50, v50
    v_mfma_f32_32x32x16_bf16 v[32:47], v[116:119], v[24:27], v[32:47]
    v_exp_f32 v51, v51
    v_cvt_pk_bf16_f32 v152, v48, v49
    v_exp_f32 v52, v52
    v_exp_f32 v53, v53
    s_waitcnt lgkmcnt(0)
    v_mfma_f32_32x32x16_bf16 v[80:95], v[128:131], v[144:147], v[80:95]
    v_cvt_pk_bf16_f32 v153, v50, v51
    ds_read_b128 v[120:123], v10 offset:22528
    ds_read_b128 v[124:127], v11 offset:22528
    v_exp_f32 v54, v54
    v_exp_f32 v55, v55
    v_cvt_pk_bf16_f32 v154, v52, v53
    v_exp_f32 v56, v56
    v_mfma_f32_32x32x16_bf16 v[96:111], v[28:31], v[144:147], v[96:111]
    v_exp_f32 v57, v57
    ds_read_b64_tr_b16 v[136:137], v14 offset:18432
    v_cvt_pk_bf16_f32 v155, v54, v55
    v_exp_f32 v58, v58
    v_mfma_f32_32x32x16_bf16 v[80:95], v[132:135], v[148:151], v[80:95]
    v_exp_f32 v59, v59
    ds_read_b64_tr_b16 v[138:139], v14 offset:18944
    ds_read_b64_tr_b16 v[140:141], v14 offset:19456
    v_cvt_pk_bf16_f32 v156, v56, v57
    v_exp_f32 v60, v60
    v_exp_f32 v61, v61
    v_mfma_f32_32x32x16_bf16 v[96:111], v[28:31], v[148:151], v[96:111]
    v_cvt_pk_bf16_f32 v157, v58, v59
    ds_read_b64_tr_b16 v[142:143], v14 offset:19968
    v_exp_f32 v62, v62
    v_exp_f32 v63, v63
    v_cvt_pk_bf16_f32 v158, v60, v61
    v_cvt_pk_bf16_f32 v159, v62, v63
    s_waitcnt vmcnt(4) lgkmcnt(0)
    s_barrier
    s_add_u32 m0, s40, 0
    s_nop 0
    buffer_load_dwordx4 v8, s[12:15], s42 offen offset:0 lds
    s_add_u32 m0, s40, 8192
    s_nop 0
    buffer_load_dwordx4 v9, s[16:19], s42 offen offset:0 lds
    s_add_u32 s42, s42, 8192
    buffer_load_dwordx4 v[168:171], v165, s[56:59], s46 offen
    s_waitcnt lgkmcnt(4)
    v_mfma_f32_32x32x16_bf16 v[48:63], v[120:123], v[20:23], v[64:79]
    v_exp_f32 v32, v32
    v_exp_f32 v33, v33
    v_exp_f32 v34, v34
    v_mfma_f32_32x32x16_bf16 v[48:63], v[124:127], v[24:27], v[48:63]
    v_exp_f32 v35, v35
    v_cvt_pk_bf16_f32 v144, v32, v33
    v_exp_f32 v36, v36
    v_exp_f32 v37, v37
    s_waitcnt lgkmcnt(0)
    v_mfma_f32_32x32x16_bf16 v[80:95], v[136:139], v[152:155], v[80:95]
    v_cvt_pk_bf16_f32 v145, v34, v35
    ds_read_b128 v[112:115], v10 offset:32768
    ds_read_b128 v[116:119], v11 offset:32768
    v_exp_f32 v38, v38
    v_exp_f32 v39, v39
    v_cvt_pk_bf16_f32 v146, v36, v37
    v_exp_f32 v40, v40
    v_mfma_f32_32x32x16_bf16 v[96:111], v[28:31], v[152:155], v[96:111]
    v_exp_f32 v41, v41
    ds_read_b64_tr_b16 v[128:129], v14 offset:20480
    v_cvt_pk_bf16_f32 v147, v38, v39
    v_exp_f32 v42, v42
    v_mfma_f32_32x32x16_bf16 v[80:95], v[140:143], v[156:159], v[80:95]
    v_exp_f32 v43, v43
    ds_read_b64_tr_b16 v[130:131], v14 offset:20992
    ds_read_b64_tr_b16 v[132:133], v14 offset:21504
    v_cvt_pk_bf16_f32 v148, v40, v41
    v_exp_f32 v44, v44
    v_exp_f32 v45, v45
    v_mfma_f32_32x32x16_bf16 v[96:111], v[28:31], v[156:159], v[96:111]
    v_cvt_pk_bf16_f32 v149, v42, v43
    ds_read_b64_tr_b16 v[134:135], v14 offset:22016
    v_exp_f32 v46, v46
    v_exp_f32 v47, v47
    v_cvt_pk_bf16_f32 v150, v44, v45
    v_cvt_pk_bf16_f32 v151, v46, v47
    s_waitcnt lgkmcnt(4)
    v_mfma_f32_32x32x16_bf16 v[32:47], v[112:115], v[20:23], v[64:79]
    v_exp_f32 v48, v48
    v_exp_f32 v49, v49
    v_exp_f32 v50, v50
    v_mfma_f32_32x32x16_bf16 v[32:47], v[116:119], v[24:27], v[32:47]
    v_exp_f32 v51, v51
    v_cvt_pk_bf16_f32 v152, v48, v49
    v_exp_f32 v52, v52
    v_exp_f32 v53, v53
    s_waitcnt lgkmcnt(0)
    v_mov_b32 v164, v96
    v_mfma_f32_32x32x16_bf16 v[80:95], v[128:131], v[144:147], v[80:95]
    v_cvt_pk_bf16_f32 v153, v50, v51
    ds_read_b128 v[120:123], v10 offset:34816
    ds_read_b128 v[124:127], v11 offset:34816
    v_exp_f32 v54, v54
    v_exp_f32 v55, v55
    v_cvt_pk_bf16_f32 v154, v52, v53
    v_exp_f32 v56, v56
    v_mfma_f32_32x32x16_bf16 v[96:111], v[28:31], v[144:147], v[96:111]
    v_exp_f32 v57, v57
    ds_read_b64_tr_b16 v[136:137], v14 offset:22528
    v_cvt_pk_bf16_f32 v155, v54, v55
    v_exp_f32 v58, v58
    v_mfma_f32_32x32x16_bf16 v[80:95], v[132:135], v[148:151], v[80:95]
    v_exp_f32 v59, v59
    ds_read_b64_tr_b16 v[138:139], v14 offset:23040
    ds_read_b64_tr_b16 v[140:141], v14 offset:23552
    v_cvt_pk_bf16_f32 v156, v56, v57
    v_exp_f32 v60, v60
    v_exp_f32 v61, v61
    v_mfma_f32_32x32x16_bf16 v[96:111], v[28:31], v[148:151], v[96:111]
    v_cvt_pk_bf16_f32 v157, v58, v59
    ds_read_b64_tr_b16 v[142:143], v14 offset:24064
    v_exp_f32 v62, v62
    v_exp_f32 v63, v63
    v_cvt_pk_bf16_f32 v158, v60, v61
    v_cvt_pk_bf16_f32 v159, v62, v63
    v_cmp_lt_f32 vcc, 0x53800000, v164
    s_cbranch_vccnz attn_kernel_fresc5
attn_kernel_fback6:
    s_waitcnt lgkmcnt(4)
    v_mfma_f32_32x32x16_bf16 v[48:63], v[120:123], v[20:23], v[64:79]
    v_exp_f32 v32, v32
    v_exp_f32 v33, v33
    v_exp_f32 v34, v34
    v_mfma_f32_32x32x16_bf16 v[48:63], v[124:127], v[24:27], v[48:63]
    v_exp_f32 v35, v35
    v_cvt_pk_bf16_f32 v144, v32, v33
    v_exp_f32 v36, v36
    v_exp_f32 v37, v37
    s_waitcnt lgkmcnt(0)
    v_mfma_f32_32x32x16_bf16 v[80:95], v[136:139], v[152:155], v[80:95]
    v_cvt_pk_bf16_f32 v145, v34, v35
    ds_read_b128 v[112:115], v10 offset:36864
    ds_read_b128 v[116:119], v11 offset:36864
    v_exp_f32 v38, v38
    v_exp_f32 v39, v39
    v_cvt_pk_bf16_f32 v146, v36, v37
    v_exp_f32 v40, v40
    v_mfma_f32_32x32x16_bf16 v[96:111], v[28:31], v[152:155], v[96:111]
    v_exp_f32 v41, v41
    ds_read_b64_tr_b16 v[128:129], v14 offset:32768
    v_cvt_pk_bf16_f32 v147, v38, v39
    v_exp_f32 v42, v42
    v_mfma_f32_32x32x16_bf16 v[80:95], v[140:143], v[156:159], v[80:95]
    v_exp_f32 v43, v43
    ds_read_b64_tr_b16 v[130:131], v14 offset:33280
    ds_read_b64_tr_b16 v[132:133], v14 offset:33792
    v_cvt_pk_bf16_f32 v148, v40, v41
    v_exp_f32 v44, v44
    v_exp_f32 v45, v45
    v_mfma_f32_32x32x16_bf16 v[96:111], v[28:31], v[156:159], v[96:111]
    v_cvt_pk_bf16_f32 v149, v42, v43
    ds_read_b64_tr_b16 v[134:135], v14 offset:34304
    v_exp_f32 v46, v46
    v_exp_f32 v47, v47
    v_cvt_pk_bf16_f32 v150, v44, v45
    v_cvt_pk_bf16_f32 v151, v46, v47
    s_waitcnt lgkmcnt(4)
    v_mfma_f32_32x32x16_bf16 v[32:47], v[112:115], v[20:23], v[64:79]
    v_exp_f32 v48, v48
    v_exp_f32 v49, v49
    v_exp_f32 v50, v50
    v_mfma_f32_32x32x16_bf16 v[32:47], v[116:119], v[24:27], v[32:47]
    v_exp_f32 v51, v51
    v_cvt_pk_bf16_f32 v152, v48, v49
    v_exp_f32 v52, v52
    v_exp_f32 v53, v53
    s_waitcnt lgkmcnt(0)
    v_mfma_f32_32x32x16_bf16 v[80:95], v[128:131], v[144:147], v[80:95]
    v_cvt_pk_bf16_f32 v153, v50, v51
    ds_read_b128 v[120:123], v10 offset:38912
    ds_read_b128 v[124:127], v11 offset:38912
    v_exp_f32 v54, v54
    v_exp_f32 v55, v55
    v_cvt_pk_bf16_f32 v154, v52, v53
    v_exp_f32 v56, v56
    v_mfma_f32_32x32x16_bf16 v[96:111], v[28:31], v[144:147], v[96:111]
    v_exp_f32 v57, v57
    ds_read_b64_tr_b16 v[136:137], v14 offset:34816
    v_cvt_pk_bf16_f32 v155, v54, v55
    v_exp_f32 v58, v58
    v_mfma_f32_32x32x16_bf16 v[80:95], v[132:135], v[148:151], v[80:95]
    v_exp_f32 v59, v59
    ds_read_b64_tr_b16 v[138:139], v14 offset:35328
    ds_read_b64_tr_b16 v[140:141], v14 offset:35840
    v_cvt_pk_bf16_f32 v156, v56, v57
    v_exp_f32 v60, v60
    v_exp_f32 v61, v61
    v_mfma_f32_32x32x16_bf16 v[96:111], v[28:31], v[148:151], v[96:111]
    v_cvt_pk_bf16_f32 v157, v58, v59
    ds_read_b64_tr_b16 v[142:143], v14 offset:36352
    v_exp_f32 v62, v62
    v_exp_f32 v63, v63
    v_cvt_pk_bf16_f32 v158, v60, v61
    v_cvt_pk_bf16_f32 v159, v62, v63
    s_waitcnt vmcnt(4) lgkmcnt(0)
    s_barrier
    s_add_u32 m0, s40, 16384
    s_nop 0
    buffer_load_dwordx4 v8, s[12:15], s42 offen offset:0 lds
    s_add_u32 m0, s40, 24576
    s_nop 0
    buffer_load_dwordx4 v9, s[16:19], s42 offen offset:0 lds
    s_add_u32 s42, s42, 8192
    buffer_load_dwordx4 v[168:171], v165, s[80:83], s46 offen
    s_waitcnt lgkmcnt(4)
    v_mfma_f32_32x32x16_bf16 v[48:63], v[120:123], v[20:23], v[64:79]
    v_exp_f32 v32, v32
    v_exp_f32 v33, v33
    v_exp_f32 v34, v34
    v_mfma_f32_32x32x16_bf16 v[48:63], v[124:127], v[24:27], v[48:63]
    v_exp_f32 v35, v35
    v_cvt_pk_bf16_f32 v144, v32, v33
    v_exp_f32 v36, v36
    v_exp_f32 v37, v37
    s_waitcnt lgkmcnt(0)
    v_mfma_f32_32x32x16_bf16 v[80:95], v[136:139], v[152:155], v[80:95]
    v_cvt_pk_bf16_f32 v145, v34, v35
    ds_read_b128 v[112:115], v10 offset:49152
    ds_read_b128 v[116:119], v11 offset:49152
    v_exp_f32 v38, v38
    v_exp_f32 v39, v39
    v_cvt_pk_bf16_f32 v146, v36, v37
    v_exp_f32 v40, v40
    v_mfma_f32_32x32x16_bf16 v[96:111], v[28:31], v[152:155], v[96:111]
    v_exp_f32 v41, v41
    ds_read_b64_tr_b16 v[128:129], v14 offset:36864
    v_cvt_pk_bf16_f32 v147, v38, v39
    v_exp_f32 v42, v42
    v_mfma_f32_32x32x16_bf16 v[80:95], v[140:143], v[156:159], v[80:95]
    v_exp_f32 v43, v43
    ds_read_b64_tr_b16 v[130:131], v14 offset:37376
    ds_read_b64_tr_b16 v[132:133], v14 offset:37888
    v_cvt_pk_bf16_f32 v148, v40, v41
    v_exp_f32 v44, v44
    v_exp_f32 v45, v45
    v_mfma_f32_32x32x16_bf16 v[96:111], v[28:31], v[156:159], v[96:111]
    v_cvt_pk_bf16_f32 v149, v42, v43
    ds_read_b64_tr_b16 v[134:135], v14 offset:38400
    v_exp_f32 v46, v46
    v_exp_f32 v47, v47
    v_cvt_pk_bf16_f32 v150, v44, v45
    v_cvt_pk_bf16_f32 v151, v46, v47
    s_waitcnt lgkmcnt(4)
    v_mfma_f32_32x32x16_bf16 v[32:47], v[112:115], v[20:23], v[64:79]
    v_exp_f32 v48, v48
    v_exp_f32 v49, v49
    v_exp_f32 v50, v50
    v_mfma_f32_32x32x16_bf16 v[32:47], v[116:119], v[24:27], v[32:47]
    v_exp_f32 v51, v51
    v_cvt_pk_bf16_f32 v152, v48, v49
    v_exp_f32 v52, v52
    v_exp_f32 v53, v53
    s_waitcnt lgkmcnt(0)
    v_mov_b32 v164, v96
    v_mfma_f32_32x32x16_bf16 v[80:95], v[128:131], v[144:147], v[80:95]
    v_cvt_pk_bf16_f32 v153, v50, v51
    ds_read_b128 v[120:123], v10 offset:51200
    ds_read_b128 v[124:127], v11 offset:51200
    v_exp_f32 v54, v54
    v_exp_f32 v55, v55
    v_cvt_pk_bf16_f32 v154, v52, v53
    v_exp_f32 v56, v56
    v_mfma_f32_32x32x16_bf16 v[96:111], v[28:31], v[144:147], v[96:111]
    v_exp_f32 v57, v57
    ds_read_b64_tr_b16 v[136:137], v14 offset:38912
    v_cvt_pk_bf16_f32 v155, v54, v55
    v_exp_f32 v58, v58
    v_mfma_f32_32x32x16_bf16 v[80:95], v[132:135], v[148:151], v[80:95]
    v_exp_f32 v59, v59
    ds_read_b64_tr_b16 v[138:139], v14 offset:39424
    ds_read_b64_tr_b16 v[140:141], v14 offset:39936
    v_cvt_pk_bf16_f32 v156, v56, v57
    v_exp_f32 v60, v60
    v_exp_f32 v61, v61
    v_mfma_f32_32x32x16_bf16 v[96:111], v[28:31], v[148:151], v[96:111]
    v_cvt_pk_bf16_f32 v157, v58, v59
    ds_read_b64_tr_b16 v[142:143], v14 offset:40448
    v_exp_f32 v62, v62
    v_exp_f32 v63, v63
    v_cvt_pk_bf16_f32 v158, v60, v61
    v_cvt_pk_bf16_f32 v159, v62, v63
    v_cmp_lt_f32 vcc, 0x53800000, v164
    s_cbranch_vccnz attn_kernel_fresc7
attn_kernel_fback8:
    s_waitcnt lgkmcnt(4)
    v_mfma_f32_32x32x16_bf16 v[48:63], v[120:123], v[20:23], v[64:79]
    v_exp_f32 v32, v32
    v_exp_f32 v33, v33
    v_exp_f32 v34, v34
    v_mfma_f32_32x32x16_bf16 v[48:63], v[124:127], v[24:27], v[48:63]
    v_exp_f32 v35, v35
    v_cvt_pk_bf16_f32 v144, v32, v33
    v_exp_f32 v36, v36
    v_exp_f32 v37, v37
    s_waitcnt lgkmcnt(0)
    v_mfma_f32_32x32x16_bf16 v[80:95], v[136:139], v[152:155], v[80:95]
    v_cvt_pk_bf16_f32 v145, v34, v35
    ds_read_b128 v[112:115], v10 offset:53248
    ds_read_b128 v[116:119], v11 offset:53248
    v_exp_f32 v38, v38
    v_exp_f32 v39, v39
    v_cvt_pk_bf16_f32 v146, v36, v37
    v_exp_f32 v40, v40
    v_mfma_f32_32x32x16_bf16 v[96:111], v[28:31], v[152:155], v[96:111]
    v_exp_f32 v41, v41
    ds_read_b64_tr_b16 v[128:129], v14 offset:49152
    v_cvt_pk_bf16_f32 v147, v38, v39
    v_exp_f32 v42, v42
    v_mfma_f32_32x32x16_bf16 v[80:95], v[140:143], v[156:159], v[80:95]
    v_exp_f32 v43, v43
    ds_read_b64_tr_b16 v[130:131], v14 offset:49664
    ds_read_b64_tr_b16 v[132:133], v14 offset:50176
    v_cvt_pk_bf16_f32 v148, v40, v41
    v_exp_f32 v44, v44
    v_exp_f32 v45, v45
    v_mfma_f32_32x32x16_bf16 v[96:111], v[28:31], v[156:159], v[96:111]
    v_cvt_pk_bf16_f32 v149, v42, v43
    ds_read_b64_tr_b16 v[134:135], v14 offset:50688
    v_exp_f32 v46, v46
    v_exp_f32 v47, v47
    v_cvt_pk_bf16_f32 v150, v44, v45
    v_cvt_pk_bf16_f32 v151, v46, v47
    s_waitcnt lgkmcnt(4)
    v_mfma_f32_32x32x16_bf16 v[32:47], v[112:115], v[20:23], v[64:79]
    v_exp_f32 v48, v48
    v_exp_f32 v49, v49
    v_exp_f32 v50, v50
    v_mfma_f32_32x32x16_bf16 v[32:47], v[116:119], v[24:27], v[32:47]
    v_exp_f32 v51, v51
    v_cvt_pk_bf16_f32 v152, v48, v49
    v_exp_f32 v52, v52
    v_exp_f32 v53, v53
    s_waitcnt lgkmcnt(0)
    v_mfma_f32_32x32x16_bf16 v[80:95], v[128:131], v[144:147], v[80:95]
    v_cvt_pk_bf16_f32 v153, v50, v51
    ds_read_b128 v[120:123], v10 offset:55296
    ds_read_b128 v[124:127], v11 offset:55296
    v_exp_f32 v54, v54
    v_exp_f32 v55, v55
    v_cvt_pk_bf16_f32 v154, v52, v53
    v_exp_f32 v56, v56
    v_mfma_f32_32x32x16_bf16 v[96:111], v[28:31], v[144:147], v[96:111]
    v_exp_f32 v57, v57
    ds_read_b64_tr_b16 v[136:137], v14 offset:51200
    v_cvt_pk_bf16_f32 v155, v54, v55
    v_exp_f32 v58, v58
    v_mfma_f32_32x32x16_bf16 v[80:95], v[132:135], v[148:151], v[80:95]
    v_exp_f32 v59, v59
    ds_read_b64_tr_b16 v[138:139], v14 offset:51712
    ds_read_b64_tr_b16 v[140:141], v14 offset:52224
    v_cvt_pk_bf16_f32 v156, v56, v57
    v_exp_f32 v60, v60
    v_exp_f32 v61, v61
    v_mfma_f32_32x32x16_bf16 v[96:111], v[28:31], v[148:151], v[96:111]
    v_cvt_pk_bf16_f32 v157, v58, v59
    ds_read_b64_tr_b16 v[142:143], v14 offset:52736
    v_exp_f32 v62, v62
    v_exp_f32 v63, v63
    v_cvt_pk_bf16_f32 v158, v60, v61
    v_cvt_pk_bf16_f32 v159, v62, v63
    s_waitcnt vmcnt(4) lgkmcnt(0)
    s_barrier
    s_add_u32 m0, s40, 32768
    s_nop 0
    buffer_load_dwordx4 v8, s[12:15], s42 offen offset:0 lds
    s_add_u32 m0, s40, 40960
    s_nop 0
    buffer_load_dwordx4 v9, s[16:19], s42 offen offset:0 lds
    s_add_u32 s42, s42, 8192
    buffer_load_dwordx4 v[168:171], v165, s[48:51], s46 offen
    s_waitcnt lgkmcnt(4)
    v_mfma_f32_32x32x16_bf16 v[48:63], v[120:123], v[20:23], v[64:79]
    v_exp_f32 v32, v32
    v_exp_f32 v33, v33
    v_exp_f32 v34, v34
    v_mfma_f32_32x32x16_bf16 v[48:63], v[124:127], v[24:27], v[48:63]
    v_exp_f32 v35, v35
    v_cvt_pk_bf16_f32 v144, v32, v33
    v_exp_f32 v36, v36
    v_exp_f32 v37, v37
    s_waitcnt lgkmcnt(0)
    v_mfma_f32_32x32x16_bf16 v[80:95], v[136:139], v[152:155], v[80:95]
    v_cvt_pk_bf16_f32 v145, v34, v35
    ds_read_b128 v[112:115], v10 offset:0
    ds_read_b128 v[116:119], v11 offset:0
    v_exp_f32 v38, v38
    v_exp_f32 v39, v39
    v_cvt_pk_bf16_f32 v146, v36, v37
    v_exp_f32 v40, v40
    v_mfma_f32_32x32x16_bf16 v[96:111], v[28:31], v[152:155], v[96:111]
    v_exp_f32 v41, v41
    ds_read_b64_tr_b16 v[128:129], v14 offset:53248
    v_cvt_pk_bf16_f32 v147, v38, v39
    v_exp_f32 v42, v42
    v_mfma_f32_32x32x16_bf16 v[80:95], v[140:143], v[156:159], v[80:95]
    v_exp_f32 v43, v43
    ds_read_b64_tr_b16 v[130:131], v14 offset:53760
    ds_read_b64_tr_b16 v[132:133], v14 offset:54272
    v_cvt_pk_bf16_f32 v148, v40, v41
    v_exp_f32 v44, v44
    v_exp_f32 v45, v45
    v_mfma_f32_32x32x16_bf16 v[96:111], v[28:31], v[156:159], v[96:111]
    v_cvt_pk_bf16_f32 v149, v42, v43
    ds_read_b64_tr_b16 v[134:135], v14 offset:54784
    v_exp_f32 v46, v46
    v_exp_f32 v47, v47
    v_cvt_pk_bf16_f32 v150, v44, v45
    v_cvt_pk_bf16_f32 v151, v46, v47
    s_waitcnt lgkmcnt(4)
    v_mfma_f32_32x32x16_bf16 v[32:47], v[112:115], v[20:23], v[64:79]
    v_exp_f32 v48, v48
    v_exp_f32 v49, v49
    v_exp_f32 v50, v50
    v_mfma_f32_32x32x16_bf16 v[32:47], v[116:119], v[24:27], v[32:47]
    v_exp_f32 v51, v51
    v_cvt_pk_bf16_f32 v152, v48, v49
    v_exp_f32 v52, v52
    v_exp_f32 v53, v53
    s_waitcnt lgkmcnt(0)
    v_mov_b32 v164, v96
    v_mfma_f32_32x32x16_bf16 v[80:95], v[128:131], v[144:147], v[80:95]
    v_cvt_pk_bf16_f32 v153, v50, v51
    ds_read_b128 v[120:123], v10 offset:2048
    ds_read_b128 v[124:127], v11 offset:2048
    v_exp_f32 v54, v54
    v_exp_f32 v55, v55
    v_cvt_pk_bf16_f32 v154, v52, v53
    v_exp_f32 v56, v56
    v_mfma_f32_32x32x16_bf16 v[96:111], v[28:31], v[144:147], v[96:111]
    v_exp_f32 v57, v57
    ds_read_b64_tr_b16 v[136:137], v14 offset:55296
    v_cvt_pk_bf16_f32 v155, v54, v55
    v_exp_f32 v58, v58
    v_mfma_f32_32x32x16_bf16 v[80:95], v[132:135], v[148:151], v[80:95]
    v_exp_f32 v59, v59
    ds_read_b64_tr_b16 v[138:139], v14 offset:55808
    ds_read_b64_tr_b16 v[140:141], v14 offset:56320
    v_cvt_pk_bf16_f32 v156, v56, v57
    v_exp_f32 v60, v60
    v_exp_f32 v61, v61
    v_mfma_f32_32x32x16_bf16 v[96:111], v[28:31], v[148:151], v[96:111]
    v_cvt_pk_bf16_f32 v157, v58, v59
    ds_read_b64_tr_b16 v[142:143], v14 offset:56832
    v_exp_f32 v62, v62
    v_exp_f32 v63, v63
    v_cvt_pk_bf16_f32 v158, v60, v61
    v_cvt_pk_bf16_f32 v159, v62, v63
    s_add_u32 s46, s46, 2097152
    s_sub_u32 s47, s47, 1
    s_cmp_lg_u32 s47, 0
    s_cbranch_scc1 attn_kernel_loopf
    s_waitcnt lgkmcnt(0)
    v_mfma_f32_32x32x16_bf16 v[80:95], v[136:139], v[152:155], v[80:95]
    v_mfma_f32_32x32x16_bf16 v[96:111], v[28:31], v[152:155], v[96:111]
    v_mfma_f32_32x32x16_bf16 v[80:95], v[140:143], v[156:159], v[80:95]
    v_mfma_f32_32x32x16_bf16 v[96:111], v[28:31], v[156:159], v[96:111]
    s_nop 15
    s_nop 3
    v_rcp_f32 v160, v96
    s_nop 0
    v_mul_f32 v80, v80, v160
    v_mul_f32 v81, v81, v160
    v_mul_f32 v82, v82, v160
    v_mul_f32 v83, v83, v160
    v_mul_f32 v84, v84, v160
    v_mul_f32 v85, v85, v160
    v_mul_f32 v86, v86, v160
    v_mul_f32 v87, v87, v160
    v_mul_f32 v88, v88, v160
    v_mul_f32 v89, v89, v160
    v_mul_f32 v90, v90, v160
    v_mul_f32 v91, v91, v160
    v_mul_f32 v92, v92, v160
    v_mul_f32 v93, v93, v160
    v_mul_f32 v94, v94, v160
    v_mul_f32 v95, v95, v160
    v_mul_f32 v160, 0, v80
    v_fmac_f32 v160, 0, v81
    v_fmac_f32 v160, 0, v82
    v_fmac_f32 v160, 0, v83
    v_fmac_f32 v160, 0, v84
    v_fmac_f32 v160, 0, v85
    v_fmac_f32 v160, 0, v86
    v_fmac_f32 v160, 0, v87
    v_fmac_f32 v160, 0, v88
    v_fmac_f32 v160, 0, v89
    v_fmac_f32 v160, 0, v90
    v_fmac_f32 v160, 0, v91
    v_fmac_f32 v160, 0, v92
    v_fmac_f32 v160, 0, v93
    v_fmac_f32 v160, 0, v94
    v_fmac_f32 v160, 0, v95
    v_add_f32 v160, v160, v96
    v_cmp_ngt_f32 vcc, 0x71800000, v160
    s_cmp_lg_u64 vcc, 0
    s_cselect_b32 s31, 1, 0
    v_mov_b32 v160, s31
    v_mov_b32 v161, 65536
    s_lshl_b32 s31, s30, 2
    v_add_u32 v161, s31, v161
    ds_write_b32 v161, v160
    s_waitcnt vmcnt(0) lgkmcnt(0)
    s_barrier
    v_mov_b32 v161, 65536
    ds_read_b128 v[144:147], v161
    ds_read_b128 v[148:151], v161 offset:16
    s_waitcnt lgkmcnt(0)
    v_or3_b32 v160, v144, v145, v146
    v_or3_b32 v160, v160, v147, v148
    v_or3_b32 v160, v160, v149, v150
    v_or_b32 v160, v160, v151
    s_nop 0
    v_readfirstlane_b32 s31, v160
    s_cmp_eq_u32 s31, 0
    s_cbranch_scc1 attn_kernel_store
    s_barrier
    s_mov_b32 s42, 0
    buffer_load_dwordx4 v[20:23], v16, s[8:11], 0 offen
    buffer_load_dwordx4 v[24:27], v16, s[8:11], 0 offen offset:32
    s_add_u32 m0, s40, 0
    s_nop 0
    buffer_load_dwordx4 v8, s[12:15], s42 offen offset:0 lds
    s_add_u32 m0, s40, 8192
    s_nop 0
    buffer_load_dwordx4 v9, s[16:19], s42 offen offset:0 lds
    s_add_u32 s42, s42, 8192
    s_add_u32 m0, s40, 16384
    s_nop 0
    buffer_load_dwordx4 v8, s[12:15], s42 offen offset:0 lds
    s_add_u32 m0, s40, 24576
    s_nop 0
    buffer_load_dwordx4 v9, s[16:19], s42 offen offset:0 lds
    s_add_u32 s42, s42, 8192
    v_mov_b32 v80, 0
    v_mov_b32 v96, 0
    v_mov_b32 v81, 0
    v_mov_b32 v97, 0
    v_mov_b32 v82, 0
    v_mov_b32 v98, 0
    v_mov_b32 v83, 0
    v_mov_b32 v99, 0
    v_mov_b32 v84, 0
    v_mov_b32 v100, 0
    v_mov_b32 v85, 0
    v_mov_b32 v101, 0
    v_mov_b32 v86, 0
    v_mov_b32 v102, 0
    v_mov_b32 v87, 0
    v_mov_b32 v103, 0
    v_mov_b32 v88, 0
    v_mov_b32 v104, 0
    v_mov_b32 v89, 0
    v_mov_b32 v105, 0
    v_mov_b32 v90, 0
    v_mov_b32 v106, 0
    v_mov_b32 v91, 0
    v_mov_b32 v107, 0
    v_mov_b32 v92, 0
    v_mov_b32 v108, 0
    v_mov_b32 v93, 0
    v_mov_b32 v109, 0
    v_mov_b32 v94, 0
    v_mov_b32 v110, 0
    v_mov_b32 v95, 0
    v_mov_b32 v111, 0
    v_mov_b32 v152, 0
    v_mov_b32 v136, 0
    v_mov_b32 v153, 0
    v_mov_b32 v137, 0
    v_mov_b32 v154, 0
    v_mov_b32 v138, 0
    v_mov_b32 v155, 0
    v_mov_b32 v139, 0
    v_mov_b32 v156, 0
    v_mov_b32 v140, 0
    v_mov_b32 v157, 0
    v_mov_b32 v141, 0
    v_mov_b32 v158, 0
    v_mov_b32 v142, 0
    v_mov_b32 v159, 0
    v_mov_b32 v143, 0
    v_mov_b32 v164, 0
    s_mov_b32 s46, 0
    s_waitcnt vmcnt(2) lgkmcnt(0)
    s_barrier
    s_add_u32 m0, s40, 32768
    s_nop 0
    buffer_load_dwordx4 v8, s[12:15], s42 offen offset:0 lds
    s_add_u32 m0, s40, 40960
    s_nop 0
    buffer_load_dwordx4 v9, s[16:19], s42 offen offset:0 lds
    s_add_u32 s42, s42, 8192
    ds_read_b128 v[112:115], v10 offset:0
    ds_read_b128 v[116:119], v11 offset:0
    ds_read_b128 v[120:123], v10 offset:2048
    ds_read_b128 v[124:127], v11 offset:2048
    s_waitcnt lgkmcnt(2)
    v_mfma_f32_32x32x16_bf16 v[32:47], v[112:115], v[20:23], 0
    v_mfma_f32_32x32x16_bf16 v[32:47], v[116:119], v[24:27], v[32:47]
    s_nop 15
    v_max3_f32 v160, v32, v33, v34
    v_max3_f32 v160, v160, v35, v36
    v_max3_f32 v160, v160, v37, v38
    v_max3_f32 v160, v160, v39, v40
    v_max3_f32 v160, v160, v41, v42
    v_max3_f32 v160, v160, v43, v44
    v_max3_f32 v160, v160, v45, v46
    v_max_f32 v160, v160, v47
    v_mov_b32 v161, v160
    s_nop 1
    v_permlane32_swap_b32 v160, v161
    v_max_f32 v160, v160, v161
    v_sub_f32 v32, v32, v160
    v_sub_f32 v64, 0, v160
    v_sub_f32 v33, v33, v160
    v_sub_f32 v65, 0, v160
    v_sub_f32 v34, v34, v160
    v_sub_f32 v66, 0, v160
    v_sub_f32 v35, v35, v160
    v_sub_f32 v67, 0, v160
    v_sub_f32 v36, v36, v160
    v_sub_f32 v68, 0, v160
    v_sub_f32 v37, v37, v160
    v_sub_f32 v69, 0, v160
    v_sub_f32 v38, v38, v160
    v_sub_f32 v70, 0, v160
    v_sub_f32 v39, v39, v160
    v_sub_f32 v71, 0, v160
    v_sub_f32 v40, v40, v160
    v_sub_f32 v72, 0, v160
    v_sub_f32 v41, v41, v160
    v_sub_f32 v73, 0, v160
    v_sub_f32 v42, v42, v160
    v_sub_f32 v74, 0, v160
    v_sub_f32 v43, v43, v160
    v_sub_f32 v75, 0, v160
    v_sub_f32 v44, v44, v160
    v_sub_f32 v76, 0, v160
    v_sub_f32 v45, v45, v160
    v_sub_f32 v77, 0, v160
    v_sub_f32 v46, v46, v160
    v_sub_f32 v78, 0, v160
    v_sub_f32 v47, v47, v160
    v_sub_f32 v79, 0, v160
    ds_read_b64_tr_b16 v[128:129], v14 offset:0
    ds_read_b64_tr_b16 v[130:131], v14 offset:512
    ds_read_b64_tr_b16 v[132:133], v14 offset:1024
    ds_read_b64_tr_b16 v[134:135], v14 offset:1536
    s_mov_b32 s47, 4
.p2align 6
attn_kernel_loops:
    s_waitcnt lgkmcnt(4)
    v_mfma_f32_32x32x16_bf16 v[48:63], v[120:123], v[20:23], v[64:79]
    v_max3_f32 v160, v32, v33, v34
    v_max3_f32 v160, v160, v35, v36
    v_max3_f32 v160, v160, v37, v38
    v_max3_f32 v160, v160, v39, v40
    v_mfma_f32_32x32x16_bf16 v[48:63], v[124:127], v[24:27], v[48:63]
    v_max3_f32 v160, v160, v41, v42
    v_max3_f32 v160, v160, v43, v44
    v_max3_f32 v160, v160, v45, v46
    v_max_f32 v160, v160, v47
    v_cmp_lt_f32 vcc, 0x42700000, v160
    s_cbranch_vccnz attn_kernel_resc9
attn_kernel_back10:
    s_waitcnt lgkmcnt(0)
    v_mfma_f32_32x32x16_bf16 v[80:95], v[136:139], v[152:155], v[80:95]
    v_exp_f32 v32, v32
    ds_read_b128 v[112:115], v10 offset:4096
    ds_read_b128 v[116:119], v11 offset:4096
    v_exp_f32 v33, v33
    v_exp_f32 v34, v34
    v_exp_f32 v35, v35
    v_cvt_pk_bf16_f32 v144, v32, v33
    v_exp_f32 v36, v36
    v_mfma_f32_32x32x16_bf16 v[96:111], v[28:31], v[152:155], v[96:111]
    v_exp_f32 v37, v37
    ds_read_b64_tr_b16 v[128:129], v14 offset:0
    v_cvt_pk_bf16_f32 v145, v34, v35
    v_exp_f32 v38, v38
    v_exp_f32 v39, v39
    v_cvt_pk_bf16_f32 v146, v36, v37
    v_exp_f32 v40, v40
    v_mfma_f32_32x32x16_bf16 v[80:95], v[140:143], v[156:159], v[80:95]
    v_exp_f32 v41, v41
    ds_read_b64_tr_b16 v[130:131], v14 offset:512
    ds_read_b64_tr_b16 v[132:133], v14 offset:1024
    v_cvt_pk_bf16_f32 v147, v38, v39
    v_exp_f32 v42, v42
    v_exp_f32 v43, v43
    v_cvt_pk_bf16_f32 v148, v40, v41
    v_exp_f32 v44, v44
    v_mfma_f32_32x32x16_bf16 v[96:111], v[28:31], v[156:159], v[96:111]
    v_exp_f32 v45, v45
    ds_read_b64_tr_b16 v[134:135], v14 offset:1536
    v_cvt_pk_bf16_f32 v149, v42, v43
    v_exp_f32 v46, v46
    v_exp_f32 v47, v47
    v_cvt_pk_bf16_f32 v150, v44, v45
    v_cvt_pk_bf16_f32 v151, v46, v47
    s_waitcnt lgkmcnt(4)
    v_mfma_f32_32x32x16_bf16 v[32:47], v[112:115], v[20:23], v[64:79]
    v_max3_f32 v160, v48, v49, v50
    v_max3_f32 v160, v160, v51, v52
    v_max3_f32 v160, v160, v53, v54
    v_max3_f32 v160, v160, v55, v56
    v_mfma_f32_32x32x16_bf16 v[32:47], v[116:119], v[24:27], v[32:47]
    v_max3_f32 v160, v160, v57, v58
    v_max3_f32 v160, v160, v59, v60
    v_max3_f32 v160, v160, v61, v62
    v_max_f32 v160, v160, v63
    v_cmp_lt_f32 vcc, 0x42700000, v160
    s_cbranch_vccnz attn_kernel_resc11
attn_kernel_back12:
    s_waitcnt lgkmcnt(0)
    v_mfma_f32_32x32x16_bf16 v[80:95], v[128:131], v[144:147], v[80:95]
    v_exp_f32 v48, v48
    ds_read_b128 v[120:123], v10 offset:6144
    ds_read_b128 v[124:127], v11 offset:6144
    v_exp_f32 v49, v49
    v_exp_f32 v50, v50
    v_exp_f32 v51, v51
    v_cvt_pk_bf16_f32 v152, v48, v49
    v_exp_f32 v52, v52
    v_mfma_f32_32x32x16_bf16 v[96:111], v[28:31], v[144:147], v[96:111]
    v_exp_f32 v53, v53
    ds_read_b64_tr_b16 v[136:137], v14 offset:2048
    v_cvt_pk_bf16_f32 v153, v50, v51
    v_exp_f32 v54, v54
    v_exp_f32 v55, v55
    v_cvt_pk_bf16_f32 v154, v52, v53
    v_exp_f32 v56, v56
    v_mfma_f32_32x32x16_bf16 v[80:95], v[132:135], v[148:151], v[80:95]
    v_exp_f32 v57, v57
    ds_read_b64_tr_b16 v[138:139], v14 offset:2560
    ds_read_b64_tr_b16 v[140:141], v14 offset:3072
    v_cvt_pk_bf16_f32 v155, v54, v55
    v_exp_f32 v58, v58
    v_exp_f32 v59, v59
    v_cvt_pk_bf16_f32 v156, v56, v57
    v_exp_f32 v60, v60
    v_mfma_f32_32x32x16_bf16 v[96:111], v[28:31], v[148:151], v[96:111]
    v_exp_f32 v61, v61
    ds_read_b64_tr_b16 v[142:143], v14 offset:3584
    v_cvt_pk_bf16_f32 v157, v58, v59
    v_exp_f32 v62, v62
    v_exp_f32 v63, v63
    v_cvt_pk_bf16_f32 v158, v60, v61
    v_cvt_pk_bf16_f32 v159, v62, v63
    s_waitcnt vmcnt(2) lgkmcnt(0)
    s_barrier
    s_add_u32 m0, s40, 49152
    s_nop 0
    buffer_load_dwordx4 v8, s[12:15], s42 offen offset:0 lds
    s_add_u32 m0, s40, 57344
    s_nop 0
    buffer_load_dwordx4 v9, s[16:19], s42 offen offset:0 lds
    s_add_u32 s42, s42, 8192
    s_waitcnt lgkmcnt(4)
    v_mfma_f32_32x32x16_bf16 v[48:63], v[120:123], v[20:23], v[64:79]
    v_max3_f32 v160, v32, v33, v34
    v_max3_f32 v160, v160, v35, v36
    v_max3_f32 v160, v160, v37, v38
    v_max3_f32 v160, v160, v39, v40
    v_mfma_f32_32x32x16_bf16 v[48:63], v[124:127], v[24:27], v[48:63]
    v_max3_f32 v160, v160, v41, v42
    v_max3_f32 v160, v160, v43, v44
    v_max3_f32 v160, v160, v45, v46
    v_max_f32 v160, v160, v47
    v_cmp_lt_f32 vcc, 0x42700000, v160
    s_cbranch_vccnz attn_kernel_resc13
attn_kernel_back14:
    s_waitcnt lgkmcnt(0)
    v_mfma_f32_32x32x16_bf16 v[80:95], v[136:139], v[152:155], v[80:95]
    v_exp_f32 v32, v32
    ds_read_b128 v[112:115], v10 offset:16384
    ds_read_b128 v[116:119], v11 offset:16384
    v_exp_f32 v33, v33
    v_exp_f32 v34, v34
    v_exp_f32 v35, v35
    v_cvt_pk_bf16_f32 v144, v32, v33
    v_exp_f32 v36, v36
    v_mfma_f32_32x32x16_bf16 v[96:111], v[28:31], v[152:155], v[96:111]
    v_exp_f32 v37, v37
    ds_read_b64_tr_b16 v[128:129], v14 offset:4096
    v_cvt_pk_bf16_f32 v145, v34, v35
    v_exp_f32 v38, v38
    v_exp_f32 v39, v39
    v_cvt_pk_bf16_f32 v146, v36, v37
    v_exp_f32 v40, v40
    v_mfma_f32_32x32x16_bf16 v[80:95], v[140:143], v[156:159], v[80:95]
    v_exp_f32 v41, v41
    ds_read_b64_tr_b16 v[130:131], v14 offset:4608
    ds_read_b64_tr_b16 v[132:133], v14 offset:5120
    v_cvt_pk_bf16_f32 v147, v38, v39
    v_exp_f32 v42, v42
    v_exp_f32 v43, v43
    v_cvt_pk_bf16_f32 v148, v40, v41
    v_exp_f32 v44, v44
    v_mfma_f32_32x32x16_bf16 v[96:111], v[28:31], v[156:159], v[96:111]
    v_exp_f32 v45, v45
    ds_read_b64_tr_b16 v[134:135], v14 offset:5632
    v_cvt_pk_bf16_f32 v149, v42, v43
    v_exp_f32 v46, v46
    v_exp_f32 v47, v47
    v_cvt_pk_bf16_f32 v150, v44, v45
    v_cvt_pk_bf16_f32 v151, v46, v47
    s_waitcnt lgkmcnt(4)
    v_mfma_f32_32x32x16_bf16 v[32:47], v[112:115], v[20:23], v[64:79]
    v_max3_f32 v160, v48, v49, v50
    v_max3_f32 v160, v160, v51, v52
    v_max3_f32 v160, v160, v53, v54
    v_max3_f32 v160, v160, v55, v56
    v_mfma_f32_32x32x16_bf16 v[32:47], v[116:119], v[24:27], v[32:47]
    v_max3_f32 v160, v160, v57, v58
    v_max3_f32 v160, v160, v59, v60
    v_max3_f32 v160, v160, v61, v62
    v_max_f32 v160, v160, v63
    v_cmp_lt_f32 vcc, 0x42700000, v160
    s_cbranch_vccnz attn_kernel_resc15
attn_kernel_back16:
    s_waitcnt lgkmcnt(0)
    v_mfma_f32_32x32x16_bf16 v[80:95], v[128:131], v[144:147], v[80:95]
    v_exp_f32 v48, v48
    ds_read_b128 v[120:123], v10 offset:18432
    ds_read_b128 v[124:127], v11 offset:18432
    v_exp_f32 v49, v49
    v_exp_f32 v50, v50
    v_exp_f32 v51, v51
    v_cvt_pk_bf16_f32 v152, v48, v49
    v_exp_f32 v52, v52
    v_mfma_f32_32x32x16_bf16 v[96:111], v[28:31], v[144:147], v[96:111]
    v_exp_f32 v53, v53
    ds_read_b64_tr_b16 v[136:137], v14 offset:6144
    v_cvt_pk_bf16_f32 v153, v50, v51
    v_exp_f32 v54, v54
    v_exp_f32 v55, v55
    v_cvt_pk_bf16_f32 v154, v52, v53
    v_exp_f32 v56, v56
    v_mfma_f32_32x32x16_bf16 v[80:95], v[132:135], v[148:151], v[80:95]
    v_exp_f32 v57, v57
    ds_read_b64_tr_b16 v[138:139], v14 offset:6656
    ds_read_b64_tr_b16 v[140:141], v14 offset:7168
    v_cvt_pk_bf16_f32 v155, v54, v55
    v_exp_f32 v58, v58
    v_exp_f32 v59, v59
    v_cvt_pk_bf16_f32 v156, v56, v57
    v_exp_f32 v60, v60
    v_mfma_f32_32x32x16_bf16 v[96:111], v[28:31], v[148:151], v[96:111]
    v_exp_f32 v61, v61
    ds_read_b64_tr_b16 v[142:143], v14 offset:7680
    v_cvt_pk_bf16_f32 v157, v58, v59
    v_exp_f32 v62, v62
    v_exp_f32 v63, v63
    v_cvt_pk_bf16_f32 v158, v60, v61
    v_cvt_pk_bf16_f32 v159, v62, v63
    s_waitcnt lgkmcnt(4)
    v_mfma_f32_32x32x16_bf16 v[48:63], v[120:123], v[20:23], v[64:79]
    v_max3_f32 v160, v32, v33, v34
    v_max3_f32 v160, v160, v35, v36
    v_max3_f32 v160, v160, v37, v38
    v_max3_f32 v160, v160, v39, v40
    v_mfma_f32_32x32x16_bf16 v[48:63], v[124:127], v[24:27], v[48:63]
    v_max3_f32 v160, v160, v41, v42
    v_max3_f32 v160, v160, v43, v44
    v_max3_f32 v160, v160, v45, v46
    v_max_f32 v160, v160, v47
    v_cmp_lt_f32 vcc, 0x42700000, v160
    s_cbranch_vccnz attn_kernel_resc17
attn_kernel_back18:
    s_waitcnt lgkmcnt(0)
    v_mfma_f32_32x32x16_bf16 v[80:95], v[136:139], v[152:155], v[80:95]
    v_exp_f32 v32, v32
    ds_read_b128 v[112:115], v10 offset:20480
    ds_read_b128 v[116:119], v11 offset:20480
    v_exp_f32 v33, v33
    v_exp_f32 v34, v34
    v_exp_f32 v35, v35
    v_cvt_pk_bf16_f32 v144, v32, v33
    v_exp_f32 v36, v36
    v_mfma_f32_32x32x16_bf16 v[96:111], v[28:31], v[152:155], v[96:111]
    v_exp_f32 v37, v37
    ds_read_b64_tr_b16 v[128:129], v14 offset:16384
    v_cvt_pk_bf16_f32 v145, v34, v35
    v_exp_f32 v38, v38
    v_exp_f32 v39, v39
    v_cvt_pk_bf16_f32 v146, v36, v37
    v_exp_f32 v40, v40
    v_mfma_f32_32x32x16_bf16 v[80:95], v[140:143], v[156:159], v[80:95]
    v_exp_f32 v41, v41
    ds_read_b64_tr_b16 v[130:131], v14 offset:16896
    ds_read_b64_tr_b16 v[132:133], v14 offset:17408
    v_cvt_pk_bf16_f32 v147, v38, v39
    v_exp_f32 v42, v42
    v_exp_f32 v43, v43
    v_cvt_pk_bf16_f32 v148, v40, v41
    v_exp_f32 v44, v44
    v_mfma_f32_32x32x16_bf16 v[96:111], v[28:31], v[156:159], v[96:111]
    v_exp_f32 v45, v45
    ds_read_b64_tr_b16 v[134:135], v14 offset:17920
    v_cvt_pk_bf16_f32 v149, v42, v43
    v_exp_f32 v46, v46
    v_exp_f32 v47, v47
    v_cvt_pk_bf16_f32 v150, v44, v45
    v_cvt_pk_bf16_f32 v151, v46, v47
    s_waitcnt lgkmcnt(4)
    v_mfma_f32_32x32x16_bf16 v[32:47], v[112:115], v[20:23], v[64:79]
    v_max3_f32 v160, v48, v49, v50
    v_max3_f32 v160, v160, v51, v52
    v_max3_f32 v160, v160, v53, v54
    v_max3_f32 v160, v160, v55, v56
    v_mfma_f32_32x32x16_bf16 v[32:47], v[116:119], v[24:27], v[32:47]
    v_max3_f32 v160, v160, v57, v58
    v_max3_f32 v160, v160, v59, v60
    v_max3_f32 v160, v160, v61, v62
    v_max_f32 v160, v160, v63
    v_cmp_lt_f32 vcc, 0x42700000, v160
    s_cbranch_vccnz attn_kernel_resc19
attn_kernel_back20:
    s_waitcnt lgkmcnt(0)
    v_mfma_f32_32x32x16_bf16 v[80:95], v[128:131], v[144:147], v[80:95]
    v_exp_f32 v48, v48
    ds_read_b128 v[120:123], v10 offset:22528
    ds_read_b128 v[124:127], v11 offset:22528
    v_exp_f32 v49, v49
    v_exp_f32 v50, v50
    v_exp_f32 v51, v51
    v_cvt_pk_bf16_f32 v152, v48, v49
    v_exp_f32 v52, v52
    v_mfma_f32_32x32x16_bf16 v[96:111], v[28:31], v[144:147], v[96:111]
    v_exp_f32 v53, v53
    ds_read_b64_tr_b16 v[136:137], v14 offset:18432
    v_cvt_pk_bf16_f32 v153, v50, v51
    v_exp_f32 v54, v54
    v_exp_f32 v55, v55
    v_cvt_pk_bf16_f32 v154, v52, v53
    v_exp_f32 v56, v56
    v_mfma_f32_32x32x16_bf16 v[80:95], v[132:135], v[148:151], v[80:95]
    v_exp_f32 v57, v57
    ds_read_b64_tr_b16 v[138:139], v14 offset:18944
    ds_read_b64_tr_b16 v[140:141], v14 offset:19456
    v_cvt_pk_bf16_f32 v155, v54, v55
    v_exp_f32 v58, v58
    v_exp_f32 v59, v59
    v_cvt_pk_bf16_f32 v156, v56, v57
    v_exp_f32 v60, v60
    v_mfma_f32_32x32x16_bf16 v[96:111], v[28:31], v[148:151], v[96:111]
    v_exp_f32 v61, v61
    ds_read_b64_tr_b16 v[142:143], v14 offset:19968
    v_cvt_pk_bf16_f32 v157, v58, v59
    v_exp_f32 v62, v62
    v_exp_f32 v63, v63
    v_cvt_pk_bf16_f32 v158, v60, v61
    v_cvt_pk_bf16_f32 v159, v62, v63
    s_waitcnt vmcnt(2) lgkmcnt(0)
    s_barrier
    s_add_u32 m0, s40, 0
    s_nop 0
    buffer_load_dwordx4 v8, s[12:15], s42 offen offset:0 lds
    s_add_u32 m0, s40, 8192
    s_nop 0
    buffer_load_dwordx4 v9, s[16:19], s42 offen offset:0 lds
    s_add_u32 s42, s42, 8192
    s_waitcnt lgkmcnt(4)
    v_mfma_f32_32x32x16_bf16 v[48:63], v[120:123], v[20:23], v[64:79]
    v_max3_f32 v160, v32, v33, v34
    v_max3_f32 v160, v160, v35, v36
    v_max3_f32 v160, v160, v37, v38
    v_max3_f32 v160, v160, v39, v40
    v_mfma_f32_32x32x16_bf16 v[48:63], v[124:127], v[24:27], v[48:63]
    v_max3_f32 v160, v160, v41, v42
    v_max3_f32 v160, v160, v43, v44
    v_max3_f32 v160, v160, v45, v46
    v_max_f32 v160, v160, v47
    v_cmp_lt_f32 vcc, 0x42700000, v160
    s_cbranch_vccnz attn_kernel_resc21
attn_kernel_back22:
    s_waitcnt lgkmcnt(0)
    v_mfma_f32_32x32x16_bf16 v[80:95], v[136:139], v[152:155], v[80:95]
    v_exp_f32 v32, v32
    ds_read_b128 v[112:115], v10 offset:32768
    ds_read_b128 v[116:119], v11 offset:32768
    v_exp_f32 v33, v33
    v_exp_f32 v34, v34
    v_exp_f32 v35, v35
    v_cvt_pk_bf16_f32 v144, v32, v33
    v_exp_f32 v36, v36
    v_mfma_f32_32x32x16_bf16 v[96:111], v[28:31], v[152:155], v[96:111]
    v_exp_f32 v37, v37
    ds_read_b64_tr_b16 v[128:129], v14 offset:20480
    v_cvt_pk_bf16_f32 v145, v34, v35
    v_exp_f32 v38, v38
    v_exp_f32 v39, v39
    v_cvt_pk_bf16_f32 v146, v36, v37
    v_exp_f32 v40, v40
    v_mfma_f32_32x32x16_bf16 v[80:95], v[140:143], v[156:159], v[80:95]
    v_exp_f32 v41, v41
    ds_read_b64_tr_b16 v[130:131], v14 offset:20992
    ds_read_b64_tr_b16 v[132:133], v14 offset:21504
    v_cvt_pk_bf16_f32 v147, v38, v39
    v_exp_f32 v42, v42
    v_exp_f32 v43, v43
    v_cvt_pk_bf16_f32 v148, v40, v41
    v_exp_f32 v44, v44
    v_mfma_f32_32x32x16_bf16 v[96:111], v[28:31], v[156:159], v[96:111]
    v_exp_f32 v45, v45
    ds_read_b64_tr_b16 v[134:135], v14 offset:22016
    v_cvt_pk_bf16_f32 v149, v42, v43
    v_exp_f32 v46, v46
    v_exp_f32 v47, v47
    v_cvt_pk_bf16_f32 v150, v44, v45
    v_cvt_pk_bf16_f32 v151, v46, v47
    s_waitcnt lgkmcnt(4)
    v_mfma_f32_32x32x16_bf16 v[32:47], v[112:115], v[20:23], v[64:79]
    v_max3_f32 v160, v48, v49, v50
    v_max3_f32 v160, v160, v51, v52
    v_max3_f32 v160, v160, v53, v54
    v_max3_f32 v160, v160, v55, v56
    v_mfma_f32_32x32x16_bf16 v[32:47], v[116:119], v[24:27], v[32:47]
    v_max3_f32 v160, v160, v57, v58
    v_max3_f32 v160, v160, v59, v60
    v_max3_f32 v160, v160, v61, v62
    v_max_f32 v160, v160, v63
    v_cmp_lt_f32 vcc, 0x42700000, v160
    s_cbranch_vccnz attn_kernel_resc23
attn_kernel_back24:
    s_waitcnt lgkmcnt(0)
    v_mfma_f32_32x32x16_bf16 v[80:95], v[128:131], v[144:147], v[80:95]
    v_exp_f32 v48, v48
    ds_read_b128 v[120:123], v10 offset:34816
    ds_read_b128 v[124:127], v11 offset:34816
    v_exp_f32 v49, v49
    v_exp_f32 v50, v50
    v_exp_f32 v51, v51
    v_cvt_pk_bf16_f32 v152, v48, v49
    v_exp_f32 v52, v52
    v_mfma_f32_32x32x16_bf16 v[96:111], v[28:31], v[144:147], v[96:111]
    v_exp_f32 v53, v53
    ds_read_b64_tr_b16 v[136:137], v14 offset:22528
    v_cvt_pk_bf16_f32 v153, v50, v51
    v_exp_f32 v54, v54
    v_exp_f32 v55, v55
    v_cvt_pk_bf16_f32 v154, v52, v53
    v_exp_f32 v56, v56
    v_mfma_f32_32x32x16_bf16 v[80:95], v[132:135], v[148:151], v[80:95]
    v_exp_f32 v57, v57
    ds_read_b64_tr_b16 v[138:139], v14 offset:23040
    ds_read_b64_tr_b16 v[140:141], v14 offset:23552
    v_cvt_pk_bf16_f32 v155, v54, v55
    v_exp_f32 v58, v58
    v_exp_f32 v59, v59
    v_cvt_pk_bf16_f32 v156, v56, v57
    v_exp_f32 v60, v60
    v_mfma_f32_32x32x16_bf16 v[96:111], v[28:31], v[148:151], v[96:111]
    v_exp_f32 v61, v61
    ds_read_b64_tr_b16 v[142:143], v14 offset:24064
    v_cvt_pk_bf16_f32 v157, v58, v59
    v_exp_f32 v62, v62
    v_exp_f32 v63, v63
    v_cvt_pk_bf16_f32 v158, v60, v61
    v_cvt_pk_bf16_f32 v159, v62, v63
    s_waitcnt lgkmcnt(4)
    v_mfma_f32_32x32x16_bf16 v[48:63], v[120:123], v[20:23], v[64:79]
    v_max3_f32 v160, v32, v33, v34
    v_max3_f32 v160, v160, v35, v36
    v_max3_f32 v160, v160, v37, v38
    v_max3_f32 v160, v160, v39, v40
    v_mfma_f32_32x32x16_bf16 v[48:63], v[124:127], v[24:27], v[48:63]
    v_max3_f32 v160, v160, v41, v42
    v_max3_f32 v160, v160, v43, v44
    v_max3_f32 v160, v160, v45, v46
    v_max_f32 v160, v160, v47
    v_cmp_lt_f32 vcc, 0x42700000, v160
    s_cbranch_vccnz attn_kernel_resc25
attn_kernel_back26:
    s_waitcnt lgkmcnt(0)
    v_mfma_f32_32x32x16_bf16 v[80:95], v[136:139], v[152:155], v[80:95]
    v_exp_f32 v32, v32
    ds_read_b128 v[112:115], v10 offset:36864
    ds_read_b128 v[116:119], v11 offset:36864
    v_exp_f32 v33, v33
    v_exp_f32 v34, v34
    v_exp_f32 v35, v35
    v_cvt_pk_bf16_f32 v144, v32, v33
    v_exp_f32 v36, v36
    v_mfma_f32_32x32x16_bf16 v[96:111], v[28:31], v[152:155], v[96:111]
    v_exp_f32 v37, v37
    ds_read_b64_tr_b16 v[128:129], v14 offset:32768
    v_cvt_pk_bf16_f32 v145, v34, v35
    v_exp_f32 v38, v38
    v_exp_f32 v39, v39
    v_cvt_pk_bf16_f32 v146, v36, v37
    v_exp_f32 v40, v40
    v_mfma_f32_32x32x16_bf16 v[80:95], v[140:143], v[156:159], v[80:95]
    v_exp_f32 v41, v41
    ds_read_b64_tr_b16 v[130:131], v14 offset:33280
    ds_read_b64_tr_b16 v[132:133], v14 offset:33792
    v_cvt_pk_bf16_f32 v147, v38, v39
    v_exp_f32 v42, v42
    v_exp_f32 v43, v43
    v_cvt_pk_bf16_f32 v148, v40, v41
    v_exp_f32 v44, v44
    v_mfma_f32_32x32x16_bf16 v[96:111], v[28:31], v[156:159], v[96:111]
    v_exp_f32 v45, v45
    ds_read_b64_tr_b16 v[134:135], v14 offset:34304
    v_cvt_pk_bf16_f32 v149, v42, v43
    v_exp_f32 v46, v46
    v_exp_f32 v47, v47
    v_cvt_pk_bf16_f32 v150, v44, v45
    v_cvt_pk_bf16_f32 v151, v46, v47
    s_waitcnt lgkmcnt(4)
    v_mfma_f32_32x32x16_bf16 v[32:47], v[112:115], v[20:23], v[64:79]
    v_max3_f32 v160, v48, v49, v50
    v_max3_f32 v160, v160, v51, v52
    v_max3_f32 v160, v160, v53, v54
    v_max3_f32 v160, v160, v55, v56
    v_mfma_f32_32x32x16_bf16 v[32:47], v[116:119], v[24:27], v[32:47]
    v_max3_f32 v160, v160, v57, v58
    v_max3_f32 v160, v160, v59, v60
    v_max3_f32 v160, v160, v61, v62
    v_max_f32 v160, v160, v63
    v_cmp_lt_f32 vcc, 0x42700000, v160
    s_cbranch_vccnz attn_kernel_resc27
attn_kernel_back28:
    s_waitcnt lgkmcnt(0)
    v_mfma_f32_32x32x16_bf16 v[80:95], v[128:131], v[144:147], v[80:95]
    v_exp_f32 v48, v48
    ds_read_b128 v[120:123], v10 offset:38912
    ds_read_b128 v[124:127], v11 offset:38912
    v_exp_f32 v49, v49
    v_exp_f32 v50, v50
    v_exp_f32 v51, v51
    v_cvt_pk_bf16_f32 v152, v48, v49
    v_exp_f32 v52, v52
    v_mfma_f32_32x32x16_bf16 v[96:111], v[28:31], v[144:147], v[96:111]
    v_exp_f32 v53, v53
    ds_read_b64_tr_b16 v[136:137], v14 offset:34816
    v_cvt_pk_bf16_f32 v153, v50, v51
    v_exp_f32 v54, v54
    v_exp_f32 v55, v55
    v_cvt_pk_bf16_f32 v154, v52, v53
    v_exp_f32 v56, v56
    v_mfma_f32_32x32x16_bf16 v[80:95], v[132:135], v[148:151], v[80:95]
    v_exp_f32 v57, v57
    ds_read_b64_tr_b16 v[138:139], v14 offset:35328
    ds_read_b64_tr_b16 v[140:141], v14 offset:35840
    v_cvt_pk_bf16_f32 v155, v54, v55
    v_exp_f32 v58, v58
    v_exp_f32 v59, v59
    v_cvt_pk_bf16_f32 v156, v56, v57
    v_exp_f32 v60, v60
    v_mfma_f32_32x32x16_bf16 v[96:111], v[28:31], v[148:151], v[96:111]
    v_exp_f32 v61, v61
    ds_read_b64_tr_b16 v[142:143], v14 offset:36352
    v_cvt_pk_bf16_f32 v157, v58, v59
    v_exp_f32 v62, v62
    v_exp_f32 v63, v63
    v_cvt_pk_bf16_f32 v158, v60, v61
    v_cvt_pk_bf16_f32 v159, v62, v63
    s_waitcnt vmcnt(2) lgkmcnt(0)
    s_barrier
    s_add_u32 m0, s40, 16384
    s_nop 0
    buffer_load_dwordx4 v8, s[12:15], s42 offen offset:0 lds
    s_add_u32 m0, s40, 24576
    s_nop 0
    buffer_load_dwordx4 v9, s[16:19], s42 offen offset:0 lds
    s_add_u32 s42, s42, 8192
    s_waitcnt lgkmcnt(4)
    v_mfma_f32_32x32x16_bf16 v[48:63], v[120:123], v[20:23], v[64:79]
    v_max3_f32 v160, v32, v33, v34
    v_max3_f32 v160, v160, v35, v36
    v_max3_f32 v160, v160, v37, v38
    v_max3_f32 v160, v160, v39, v40
    v_mfma_f32_32x32x16_bf16 v[48:63], v[124:127], v[24:27], v[48:63]
    v_max3_f32 v160, v160, v41, v42
    v_max3_f32 v160, v160, v43, v44
    v_max3_f32 v160, v160, v45, v46
    v_max_f32 v160, v160, v47
    v_cmp_lt_f32 vcc, 0x42700000, v160
    s_cbranch_vccnz attn_kernel_resc29
attn_kernel_back30:
    s_waitcnt lgkmcnt(0)
    v_mfma_f32_32x32x16_bf16 v[80:95], v[136:139], v[152:155], v[80:95]
    v_exp_f32 v32, v32
    ds_read_b128 v[112:115], v10 offset:49152
    ds_read_b128 v[116:119], v11 offset:49152
    v_exp_f32 v33, v33
    v_exp_f32 v34, v34
    v_exp_f32 v35, v35
    v_cvt_pk_bf16_f32 v144, v32, v33
    v_exp_f32 v36, v36
    v_mfma_f32_32x32x16_bf16 v[96:111], v[28:31], v[152:155], v[96:111]
    v_exp_f32 v37, v37
    ds_read_b64_tr_b16 v[128:129], v14 offset:36864
    v_cvt_pk_bf16_f32 v145, v34, v35
    v_exp_f32 v38, v38
    v_exp_f32 v39, v39
    v_cvt_pk_bf16_f32 v146, v36, v37
    v_exp_f32 v40, v40
    v_mfma_f32_32x32x16_bf16 v[80:95], v[140:143], v[156:159], v[80:95]
    v_exp_f32 v41, v41
    ds_read_b64_tr_b16 v[130:131], v14 offset:37376
    ds_read_b64_tr_b16 v[132:133], v14 offset:37888
    v_cvt_pk_bf16_f32 v147, v38, v39
    v_exp_f32 v42, v42
    v_exp_f32 v43, v43
    v_cvt_pk_bf16_f32 v148, v40, v41
    v_exp_f32 v44, v44
    v_mfma_f32_32x32x16_bf16 v[96:111], v[28:31], v[156:159], v[96:111]
    v_exp_f32 v45, v45
    ds_read_b64_tr_b16 v[134:135], v14 offset:38400
    v_cvt_pk_bf16_f32 v149, v42, v43
    v_exp_f32 v46, v46
    v_exp_f32 v47, v47
    v_cvt_pk_bf16_f32 v150, v44, v45
    v_cvt_pk_bf16_f32 v151, v46, v47
    s_waitcnt lgkmcnt(4)
    v_mfma_f32_32x32x16_bf16 v[32:47], v[112:115], v[20:23], v[64:79]
    v_max3_f32 v160, v48, v49, v50
    v_max3_f32 v160, v160, v51, v52
    v_max3_f32 v160, v160, v53, v54
    v_max3_f32 v160, v160, v55, v56
    v_mfma_f32_32x32x16_bf16 v[32:47], v[116:119], v[24:27], v[32:47]
    v_max3_f32 v160, v160, v57, v58
    v_max3_f32 v160, v160, v59, v60
    v_max3_f32 v160, v160, v61, v62
    v_max_f32 v160, v160, v63
    v_cmp_lt_f32 vcc, 0x42700000, v160
    s_cbranch_vccnz attn_kernel_resc31
attn_kernel_back32:
    s_waitcnt lgkmcnt(0)
    v_mfma_f32_32x32x16_bf16 v[80:95], v[128:131], v[144:147], v[80:95]
    v_exp_f32 v48, v48
    ds_read_b128 v[120:123], v10 offset:51200
    ds_read_b128 v[124:127], v11 offset:51200
    v_exp_f32 v49, v49
    v_exp_f32 v50, v50
    v_exp_f32 v51, v51
    v_cvt_pk_bf16_f32 v152, v48, v49
    v_exp_f32 v52, v52
    v_mfma_f32_32x32x16_bf16 v[96:111], v[28:31], v[144:147], v[96:111]
    v_exp_f32 v53, v53
    ds_read_b64_tr_b16 v[136:137], v14 offset:38912
    v_cvt_pk_bf16_f32 v153, v50, v51
    v_exp_f32 v54, v54
    v_exp_f32 v55, v55
    v_cvt_pk_bf16_f32 v154, v52, v53
    v_exp_f32 v56, v56
    v_mfma_f32_32x32x16_bf16 v[80:95], v[132:135], v[148:151], v[80:95]
    v_exp_f32 v57, v57
    ds_read_b64_tr_b16 v[138:139], v14 offset:39424
    ds_read_b64_tr_b16 v[140:141], v14 offset:39936
    v_cvt_pk_bf16_f32 v155, v54, v55
    v_exp_f32 v58, v58
    v_exp_f32 v59, v59
    v_cvt_pk_bf16_f32 v156, v56, v57
    v_exp_f32 v60, v60
    v_mfma_f32_32x32x16_bf16 v[96:111], v[28:31], v[148:151], v[96:111]
    v_exp_f32 v61, v61
    ds_read_b64_tr_b16 v[142:143], v14 offset:40448
    v_cvt_pk_bf16_f32 v157, v58, v59
    v_exp_f32 v62, v62
    v_exp_f32 v63, v63
    v_cvt_pk_bf16_f32 v158, v60, v61
    v_cvt_pk_bf16_f32 v159, v62, v63
    s_waitcnt lgkmcnt(4)
    v_mfma_f32_32x32x16_bf16 v[48:63], v[120:123], v[20:23], v[64:79]
    v_max3_f32 v160, v32, v33, v34
    v_max3_f32 v160, v160, v35, v36
    v_max3_f32 v160, v160, v37, v38
    v_max3_f32 v160, v160, v39, v40
    v_mfma_f32_32x32x16_bf16 v[48:63], v[124:127], v[24:27], v[48:63]
    v_max3_f32 v160, v160, v41, v42
    v_max3_f32 v160, v160, v43, v44
    v_max3_f32 v160, v160, v45, v46
    v_max_f32 v160, v160, v47
    v_cmp_lt_f32 vcc, 0x42700000, v160
    s_cbranch_vccnz attn_kernel_resc33
attn_kernel_back34:
    s_waitcnt lgkmcnt(0)
    v_mfma_f32_32x32x16_bf16 v[80:95], v[136:139], v[152:155], v[80:95]
    v_exp_f32 v32, v32
    ds_read_b128 v[112:115], v10 offset:53248
    ds_read_b128 v[116:119], v11 offset:53248
    v_exp_f32 v33, v33
    v_exp_f32 v34, v34
    v_exp_f32 v35, v35
    v_cvt_pk_bf16_f32 v144, v32, v33
    v_exp_f32 v36, v36
    v_mfma_f32_32x32x16_bf16 v[96:111], v[28:31], v[152:155], v[96:111]
    v_exp_f32 v37, v37
    ds_read_b64_tr_b16 v[128:129], v14 offset:49152
    v_cvt_pk_bf16_f32 v145, v34, v35
    v_exp_f32 v38, v38
    v_exp_f32 v39, v39
    v_cvt_pk_bf16_f32 v146, v36, v37
    v_exp_f32 v40, v40
    v_mfma_f32_32x32x16_bf16 v[80:95], v[140:143], v[156:159], v[80:95]
    v_exp_f32 v41, v41
    ds_read_b64_tr_b16 v[130:131], v14 offset:49664
    ds_read_b64_tr_b16 v[132:133], v14 offset:50176
    v_cvt_pk_bf16_f32 v147, v38, v39
    v_exp_f32 v42, v42
    v_exp_f32 v43, v43
    v_cvt_pk_bf16_f32 v148, v40, v41
    v_exp_f32 v44, v44
    v_mfma_f32_32x32x16_bf16 v[96:111], v[28:31], v[156:159], v[96:111]
    v_exp_f32 v45, v45
    ds_read_b64_tr_b16 v[134:135], v14 offset:50688
    v_cvt_pk_bf16_f32 v149, v42, v43
    v_exp_f32 v46, v46
    v_exp_f32 v47, v47
    v_cvt_pk_bf16_f32 v150, v44, v45
    v_cvt_pk_bf16_f32 v151, v46, v47
    s_waitcnt lgkmcnt(4)
    v_mfma_f32_32x32x16_bf16 v[32:47], v[112:115], v[20:23], v[64:79]
    v_max3_f32 v160, v48, v49, v50
    v_max3_f32 v160, v160, v51, v52
    v_max3_f32 v160, v160, v53, v54
    v_max3_f32 v160, v160, v55, v56
    v_mfma_f32_32x32x16_bf16 v[32:47], v[116:119], v[24:27], v[32:47]
    v_max3_f32 v160, v160, v57, v58
    v_max3_f32 v160, v160, v59, v60
    v_max3_f32 v160, v160, v61, v62
    v_max_f32 v160, v160, v63
    v_cmp_lt_f32 vcc, 0x42700000, v160
    s_cbranch_vccnz attn_kernel_resc35
attn_kernel_back36:
    s_waitcnt lgkmcnt(0)
    v_mfma_f32_32x32x16_bf16 v[80:95], v[128:131], v[144:147], v[80:95]
    v_exp_f32 v48, v48
    ds_read_b128 v[120:123], v10 offset:55296
    ds_read_b128 v[124:127], v11 offset:55296
    v_exp_f32 v49, v49
    v_exp_f32 v50, v50
    v_exp_f32 v51, v51
    v_cvt_pk_bf16_f32 v152, v48, v49
    v_exp_f32 v52, v52
    v_mfma_f32_32x32x16_bf16 v[96:111], v[28:31], v[144:147], v[96:111]
    v_exp_f32 v53, v53
    ds_read_b64_tr_b16 v[136:137], v14 offset:51200
    v_cvt_pk_bf16_f32 v153, v50, v51
    v_exp_f32 v54, v54
    v_exp_f32 v55, v55
    v_cvt_pk_bf16_f32 v154, v52, v53
    v_exp_f32 v56, v56
    v_mfma_f32_32x32x16_bf16 v[80:95], v[132:135], v[148:151], v[80:95]
    v_exp_f32 v57, v57
    ds_read_b64_tr_b16 v[138:139], v14 offset:51712
    ds_read_b64_tr_b16 v[140:141], v14 offset:52224
    v_cvt_pk_bf16_f32 v155, v54, v55
    v_exp_f32 v58, v58
    v_exp_f32 v59, v59
    v_cvt_pk_bf16_f32 v156, v56, v57
    v_exp_f32 v60, v60
    v_mfma_f32_32x32x16_bf16 v[96:111], v[28:31], v[148:151], v[96:111]
    v_exp_f32 v61, v61
    ds_read_b64_tr_b16 v[142:143], v14 offset:52736
    v_cvt_pk_bf16_f32 v157, v58, v59
    v_exp_f32 v62, v62
    v_exp_f32 v63, v63
    v_cvt_pk_bf16_f32 v158, v60, v61
    v_cvt_pk_bf16_f32 v159, v62, v63
    s_waitcnt vmcnt(2) lgkmcnt(0)
    s_barrier
    s_add_u32 m0, s40, 32768
    s_nop 0
    buffer_load_dwordx4 v8, s[12:15], s42 offen offset:0 lds
    s_add_u32 m0, s40, 40960
    s_nop 0
    buffer_load_dwordx4 v9, s[16:19], s42 offen offset:0 lds
    s_add_u32 s42, s42, 8192
    s_waitcnt lgkmcnt(4)
    v_mfma_f32_32x32x16_bf16 v[48:63], v[120:123], v[20:23], v[64:79]
    v_max3_f32 v160, v32, v33, v34
    v_max3_f32 v160, v160, v35, v36
    v_max3_f32 v160, v160, v37, v38
    v_max3_f32 v160, v160, v39, v40
    v_mfma_f32_32x32x16_bf16 v[48:63], v[124:127], v[24:27], v[48:63]
    v_max3_f32 v160, v160, v41, v42
    v_max3_f32 v160, v160, v43, v44
    v_max3_f32 v160, v160, v45, v46
    v_max_f32 v160, v160, v47
    v_cmp_lt_f32 vcc, 0x42700000, v160
    s_cbranch_vccnz attn_kernel_resc37
attn_kernel_back38:
    s_waitcnt lgkmcnt(0)
    v_mfma_f32_32x32x16_bf16 v[80:95], v[136:139], v[152:155], v[80:95]
    v_exp_f32 v32, v32
    ds_read_b128 v[112:115], v10 offset:0
    ds_read_b128 v[116:119], v11 offset:0
    v_exp_f32 v33, v33
    v_exp_f32 v34, v34
    v_exp_f32 v35, v35
    v_cvt_pk_bf16_f32 v144, v32, v33
    v_exp_f32 v36, v36
    v_mfma_f32_32x32x16_bf16 v[96:111], v[28:31], v[152:155], v[96:111]
    v_exp_f32 v37, v37
    ds_read_b64_tr_b16 v[128:129], v14 offset:53248
    v_cvt_pk_bf16_f32 v145, v34, v35
    v_exp_f32 v38, v38
    v_exp_f32 v39, v39
    v_cvt_pk_bf16_f32 v146, v36, v37
    v_exp_f32 v40, v40
    v_mfma_f32_32x32x16_bf16 v[80:95], v[140:143], v[156:159], v[80:95]
    v_exp_f32 v41, v41
    ds_read_b64_tr_b16 v[130:131], v14 offset:53760
    ds_read_b64_tr_b16 v[132:133], v14 offset:54272
    v_cvt_pk_bf16_f32 v147, v38, v39
    v_exp_f32 v42, v42
    v_exp_f32 v43, v43
    v_cvt_pk_bf16_f32 v148, v40, v41
    v_exp_f32 v44, v44
    v_mfma_f32_32x32x16_bf16 v[96:111], v[28:31], v[156:159], v[96:111]
    v_exp_f32 v45, v45
    ds_read_b64_tr_b16 v[134:135], v14 offset:54784
    v_cvt_pk_bf16_f32 v149, v42, v43
    v_exp_f32 v46, v46
    v_exp_f32 v47, v47
    v_cvt_pk_bf16_f32 v150, v44, v45
    v_cvt_pk_bf16_f32 v151, v46, v47
    s_waitcnt lgkmcnt(4)
    v_mfma_f32_32x32x16_bf16 v[32:47], v[112:115], v[20:23], v[64:79]
    v_max3_f32 v160, v48, v49, v50
    v_max3_f32 v160, v160, v51, v52
    v_max3_f32 v160, v160, v53, v54
    v_max3_f32 v160, v160, v55, v56
    v_mfma_f32_32x32x16_bf16 v[32:47], v[116:119], v[24:27], v[32:47]
    v_max3_f32 v160, v160, v57, v58
    v_max3_f32 v160, v160, v59, v60
    v_max3_f32 v160, v160, v61, v62
    v_max_f32 v160, v160, v63
    v_cmp_lt_f32 vcc, 0x42700000, v160
    s_cbranch_vccnz attn_kernel_resc39
attn_kernel_back40:
    s_waitcnt lgkmcnt(0)
    v_mfma_f32_32x32x16_bf16 v[80:95], v[128:131], v[144:147], v[80:95]
    v_exp_f32 v48, v48
    ds_read_b128 v[120:123], v10 offset:2048
    ds_read_b128 v[124:127], v11 offset:2048
    v_exp_f32 v49, v49
    v_exp_f32 v50, v50
    v_exp_f32 v51, v51
    v_cvt_pk_bf16_f32 v152, v48, v49
    v_exp_f32 v52, v52
    v_mfma_f32_32x32x16_bf16 v[96:111], v[28:31], v[144:147], v[96:111]
    v_exp_f32 v53, v53
    ds_read_b64_tr_b16 v[136:137], v14 offset:55296
    v_cvt_pk_bf16_f32 v153, v50, v51
    v_exp_f32 v54, v54
    v_exp_f32 v55, v55
    v_cvt_pk_bf16_f32 v154, v52, v53
    v_exp_f32 v56, v56
    v_mfma_f32_32x32x16_bf16 v[80:95], v[132:135], v[148:151], v[80:95]
    v_exp_f32 v57, v57
    ds_read_b64_tr_b16 v[138:139], v14 offset:55808
    ds_read_b64_tr_b16 v[140:141], v14 offset:56320
    v_cvt_pk_bf16_f32 v155, v54, v55
    v_exp_f32 v58, v58
    v_exp_f32 v59, v59
    v_cvt_pk_bf16_f32 v156, v56, v57
    v_exp_f32 v60, v60
    v_mfma_f32_32x32x16_bf16 v[96:111], v[28:31], v[148:151], v[96:111]
    v_exp_f32 v61, v61
    ds_read_b64_tr_b16 v[142:143], v14 offset:56832
    v_cvt_pk_bf16_f32 v157, v58, v59
    v_exp_f32 v62, v62
    v_exp_f32 v63, v63
    v_cvt_pk_bf16_f32 v158, v60, v61
    v_cvt_pk_bf16_f32 v159, v62, v63
    s_sub_u32 s47, s47, 1
    s_cmp_lg_u32 s47, 0
    s_cbranch_scc1 attn_kernel_loops
    s_waitcnt lgkmcnt(0)
    v_mfma_f32_32x32x16_bf16 v[80:95], v[136:139], v[152:155], v[80:95]
    v_mfma_f32_32x32x16_bf16 v[96:111], v[28:31], v[152:155], v[96:111]
    v_mfma_f32_32x32x16_bf16 v[80:95], v[140:143], v[156:159], v[80:95]
    v_mfma_f32_32x32x16_bf16 v[96:111], v[28:31], v[156:159], v[96:111]
    s_nop 15
    s_nop 3
    v_rcp_f32 v160, v96
    s_nop 0
    v_mul_f32 v80, v80, v160
    v_mul_f32 v81, v81, v160
    v_mul_f32 v82, v82, v160
    v_mul_f32 v83, v83, v160
    v_mul_f32 v84, v84, v160
    v_mul_f32 v85, v85, v160
    v_mul_f32 v86, v86, v160
    v_mul_f32 v87, v87, v160
    v_mul_f32 v88, v88, v160
    v_mul_f32 v89, v89, v160
    v_mul_f32 v90, v90, v160
    v_mul_f32 v91, v91, v160
    v_mul_f32 v92, v92, v160
    v_mul_f32 v93, v93, v160
    v_mul_f32 v94, v94, v160
    v_mul_f32 v95, v95, v160
attn_kernel_store:
    v_cvt_pk_bf16_f32 v32, v80, v81
    v_cvt_pk_bf16_f32 v33, v82, v83
    v_cvt_pk_bf16_f32 v34, v84, v85
    v_cvt_pk_bf16_f32 v35, v86, v87
    v_cvt_pk_bf16_f32 v36, v88, v89
    v_cvt_pk_bf16_f32 v37, v90, v91
    v_cvt_pk_bf16_f32 v38, v92, v93
    v_cvt_pk_bf16_f32 v39, v94, v95
    s_nop 1
    v_permlane32_swap_b32 v32, v34
    v_permlane32_swap_b32 v33, v35
    v_permlane32_swap_b32 v36, v38
    v_permlane32_swap_b32 v37, v39
    buffer_store_dwordx4 v[32:35], v5, s[20:23], 0 offen offset:0
    buffer_store_dwordx4 v[36:39], v5, s[20:23], 0 offen offset:32
    s_endpgm
attn_kernel_resc9:
    v_mov_b32 v161, v160
    s_nop 1
    v_permlane32_swap_b32 v160, v161
    v_max_f32 v160, v160, v161
    v_max_f32 v160, 0, v160
    v_ceil_f32 v160, v160
    s_nop 15
    s_nop 15
    v_cvt_i32_f32 v162, v160
    v_sub_u32 v162, 0, v162
    v_ldexp_f32 v161, 1.0, v162
    v_sub_f32 v32, v32, v160
    v_sub_f32 v64, v64, v160
    v_sub_f32 v48, v48, v160
    v_mul_f32 v80, v80, v161
    v_mul_f32 v96, v96, v161
    v_sub_f32 v33, v33, v160
    v_sub_f32 v65, v65, v160
    v_sub_f32 v49, v49, v160
    v_mul_f32 v81, v81, v161
    v_mul_f32 v97, v97, v161
    v_sub_f32 v34, v34, v160
    v_sub_f32 v66, v66, v160
    v_sub_f32 v50, v50, v160
    v_mul_f32 v82, v82, v161
    v_mul_f32 v98, v98, v161
    v_sub_f32 v35, v35, v160
    v_sub_f32 v67, v67, v160
    v_sub_f32 v51, v51, v160
    v_mul_f32 v83, v83, v161
    v_mul_f32 v99, v99, v161
    v_sub_f32 v36, v36, v160
    v_sub_f32 v68, v68, v160
    v_sub_f32 v52, v52, v160
    v_mul_f32 v84, v84, v161
    v_mul_f32 v100, v100, v161
    v_sub_f32 v37, v37, v160
    v_sub_f32 v69, v69, v160
    v_sub_f32 v53, v53, v160
    v_mul_f32 v85, v85, v161
    v_mul_f32 v101, v101, v161
    v_sub_f32 v38, v38, v160
    v_sub_f32 v70, v70, v160
    v_sub_f32 v54, v54, v160
    v_mul_f32 v86, v86, v161
    v_mul_f32 v102, v102, v161
    v_sub_f32 v39, v39, v160
    v_sub_f32 v71, v71, v160
    v_sub_f32 v55, v55, v160
    v_mul_f32 v87, v87, v161
    v_mul_f32 v103, v103, v161
    v_sub_f32 v40, v40, v160
    v_sub_f32 v72, v72, v160
    v_sub_f32 v56, v56, v160
    v_mul_f32 v88, v88, v161
    v_mul_f32 v104, v104, v161
    v_sub_f32 v41, v41, v160
    v_sub_f32 v73, v73, v160
    v_sub_f32 v57, v57, v160
    v_mul_f32 v89, v89, v161
    v_mul_f32 v105, v105, v161
    v_sub_f32 v42, v42, v160
    v_sub_f32 v74, v74, v160
    v_sub_f32 v58, v58, v160
    v_mul_f32 v90, v90, v161
    v_mul_f32 v106, v106, v161
    v_sub_f32 v43, v43, v160
    v_sub_f32 v75, v75, v160
    v_sub_f32 v59, v59, v160
    v_mul_f32 v91, v91, v161
    v_mul_f32 v107, v107, v161
    v_sub_f32 v44, v44, v160
    v_sub_f32 v76, v76, v160
    v_sub_f32 v60, v60, v160
    v_mul_f32 v92, v92, v161
    v_mul_f32 v108, v108, v161
    v_sub_f32 v45, v45, v160
    v_sub_f32 v77, v77, v160
    v_sub_f32 v61, v61, v160
    v_mul_f32 v93, v93, v161
    v_mul_f32 v109, v109, v161
    v_sub_f32 v46, v46, v160
    v_sub_f32 v78, v78, v160
    v_sub_f32 v62, v62, v160
    v_mul_f32 v94, v94, v161
    v_mul_f32 v110, v110, v161
    v_sub_f32 v47, v47, v160
    v_sub_f32 v79, v79, v160
    v_sub_f32 v63, v63, v160
    v_mul_f32 v95, v95, v161
    v_mul_f32 v111, v111, v161
    v_lshlrev_b32 v162, 16, v152
    v_and_b32 v163, 0xffff0000, v152
    v_mul_f32 v162, v162, v161
    v_mul_f32 v163, v163, v161
    v_cvt_pk_bf16_f32 v152, v162, v163
    v_lshlrev_b32 v162, 16, v153
    v_and_b32 v163, 0xffff0000, v153
    v_mul_f32 v162, v162, v161
    v_mul_f32 v163, v163, v161
    v_cvt_pk_bf16_f32 v153, v162, v163
    v_lshlrev_b32 v162, 16, v154
    v_and_b32 v163, 0xffff0000, v154
    v_mul_f32 v162, v162, v161
    v_mul_f32 v163, v163, v161
    v_cvt_pk_bf16_f32 v154, v162, v163
    v_lshlrev_b32 v162, 16, v155
    v_and_b32 v163, 0xffff0000, v155
    v_mul_f32 v162, v162, v161
    v_mul_f32 v163, v163, v161
    v_cvt_pk_bf16_f32 v155, v162, v163
    v_lshlrev_b32 v162, 16, v156
    v_and_b32 v163, 0xffff0000, v156
    v_mul_f32 v162, v162, v161
    v_mul_f32 v163, v163, v161
    v_cvt_pk_bf16_f32 v156, v162, v163
    v_lshlrev_b32 v162, 16, v157
    v_and_b32 v163, 0xffff0000, v157
    v_mul_f32 v162, v162, v161
    v_mul_f32 v163, v163, v161
    v_cvt_pk_bf16_f32 v157, v162, v163
    v_lshlrev_b32 v162, 16, v158
    v_and_b32 v163, 0xffff0000, v158
    v_mul_f32 v162, v162, v161
    v_mul_f32 v163, v163, v161
    v_cvt_pk_bf16_f32 v158, v162, v163
    v_lshlrev_b32 v162, 16, v159
    v_and_b32 v163, 0xffff0000, v159
    v_mul_f32 v162, v162, v161
    v_mul_f32 v163, v163, v161
    v_cvt_pk_bf16_f32 v159, v162, v163
    s_nop 1
    s_branch attn_kernel_back10
attn_kernel_resc11:
    v_mov_b32 v161, v160
    s_nop 1
    v_permlane32_swap_b32 v160, v161
    v_max_f32 v160, v160, v161
    v_max_f32 v160, 0, v160
    v_ceil_f32 v160, v160
    s_nop 15
    s_nop 15
    v_cvt_i32_f32 v162, v160
    v_sub_u32 v162, 0, v162
    v_ldexp_f32 v161, 1.0, v162
    v_sub_f32 v48, v48, v160
    v_sub_f32 v64, v64, v160
    v_sub_f32 v32, v32, v160
    v_mul_f32 v80, v80, v161
    v_mul_f32 v96, v96, v161
    v_sub_f32 v49, v49, v160
    v_sub_f32 v65, v65, v160
    v_sub_f32 v33, v33, v160
    v_mul_f32 v81, v81, v161
    v_mul_f32 v97, v97, v161
    v_sub_f32 v50, v50, v160
    v_sub_f32 v66, v66, v160
    v_sub_f32 v34, v34, v160
    v_mul_f32 v82, v82, v161
    v_mul_f32 v98, v98, v161
    v_sub_f32 v51, v51, v160
    v_sub_f32 v67, v67, v160
    v_sub_f32 v35, v35, v160
    v_mul_f32 v83, v83, v161
    v_mul_f32 v99, v99, v161
    v_sub_f32 v52, v52, v160
    v_sub_f32 v68, v68, v160
    v_sub_f32 v36, v36, v160
    v_mul_f32 v84, v84, v161
    v_mul_f32 v100, v100, v161
    v_sub_f32 v53, v53, v160
    v_sub_f32 v69, v69, v160
    v_sub_f32 v37, v37, v160
    v_mul_f32 v85, v85, v161
    v_mul_f32 v101, v101, v161
    v_sub_f32 v54, v54, v160
    v_sub_f32 v70, v70, v160
    v_sub_f32 v38, v38, v160
    v_mul_f32 v86, v86, v161
    v_mul_f32 v102, v102, v161
    v_sub_f32 v55, v55, v160
    v_sub_f32 v71, v71, v160
    v_sub_f32 v39, v39, v160
    v_mul_f32 v87, v87, v161
    v_mul_f32 v103, v103, v161
    v_sub_f32 v56, v56, v160
    v_sub_f32 v72, v72, v160
    v_sub_f32 v40, v40, v160
    v_mul_f32 v88, v88, v161
    v_mul_f32 v104, v104, v161
    v_sub_f32 v57, v57, v160
    v_sub_f32 v73, v73, v160
    v_sub_f32 v41, v41, v160
    v_mul_f32 v89, v89, v161
    v_mul_f32 v105, v105, v161
    v_sub_f32 v58, v58, v160
    v_sub_f32 v74, v74, v160
    v_sub_f32 v42, v42, v160
    v_mul_f32 v90, v90, v161
    v_mul_f32 v106, v106, v161
    v_sub_f32 v59, v59, v160
    v_sub_f32 v75, v75, v160
    v_sub_f32 v43, v43, v160
    v_mul_f32 v91, v91, v161
    v_mul_f32 v107, v107, v161
    v_sub_f32 v60, v60, v160
    v_sub_f32 v76, v76, v160
    v_sub_f32 v44, v44, v160
    v_mul_f32 v92, v92, v161
    v_mul_f32 v108, v108, v161
    v_sub_f32 v61, v61, v160
    v_sub_f32 v77, v77, v160
    v_sub_f32 v45, v45, v160
    v_mul_f32 v93, v93, v161
    v_mul_f32 v109, v109, v161
    v_sub_f32 v62, v62, v160
    v_sub_f32 v78, v78, v160
    v_sub_f32 v46, v46, v160
    v_mul_f32 v94, v94, v161
    v_mul_f32 v110, v110, v161
    v_sub_f32 v63, v63, v160
    v_sub_f32 v79, v79, v160
    v_sub_f32 v47, v47, v160
    v_mul_f32 v95, v95, v161
    v_mul_f32 v111, v111, v161
    v_lshlrev_b32 v162, 16, v144
    v_and_b32 v163, 0xffff0000, v144
    v_mul_f32 v162, v162, v161
    v_mul_f32 v163, v163, v161
    v_cvt_pk_bf16_f32 v144, v162, v163
    v_lshlrev_b32 v162, 16, v145
    v_and_b32 v163, 0xffff0000, v145
    v_mul_f32 v162, v162, v161
    v_mul_f32 v163, v163, v161
    v_cvt_pk_bf16_f32 v145, v162, v163
    v_lshlrev_b32 v162, 16, v146
    v_and_b32 v163, 0xffff0000, v146
    v_mul_f32 v162, v162, v161
    v_mul_f32 v163, v163, v161
    v_cvt_pk_bf16_f32 v146, v162, v163
    v_lshlrev_b32 v162, 16, v147
    v_and_b32 v163, 0xffff0000, v147
    v_mul_f32 v162, v162, v161
    v_mul_f32 v163, v163, v161
    v_cvt_pk_bf16_f32 v147, v162, v163
    v_lshlrev_b32 v162, 16, v148
    v_and_b32 v163, 0xffff0000, v148
    v_mul_f32 v162, v162, v161
    v_mul_f32 v163, v163, v161
    v_cvt_pk_bf16_f32 v148, v162, v163
    v_lshlrev_b32 v162, 16, v149
    v_and_b32 v163, 0xffff0000, v149
    v_mul_f32 v162, v162, v161
    v_mul_f32 v163, v163, v161
    v_cvt_pk_bf16_f32 v149, v162, v163
    v_lshlrev_b32 v162, 16, v150
    v_and_b32 v163, 0xffff0000, v150
    v_mul_f32 v162, v162, v161
    v_mul_f32 v163, v163, v161
    v_cvt_pk_bf16_f32 v150, v162, v163
    v_lshlrev_b32 v162, 16, v151
    v_and_b32 v163, 0xffff0000, v151
    v_mul_f32 v162, v162, v161
    v_mul_f32 v163, v163, v161
    v_cvt_pk_bf16_f32 v151, v162, v163
    s_nop 1
    s_branch attn_kernel_back12
attn_kernel_resc13:
    v_mov_b32 v161, v160
    s_nop 1
    v_permlane32_swap_b32 v160, v161
    v_max_f32 v160, v160, v161
    v_max_f32 v160, 0, v160
    v_ceil_f32 v160, v160
    s_nop 15
    s_nop 15
    v_cvt_i32_f32 v162, v160
    v_sub_u32 v162, 0, v162
    v_ldexp_f32 v161, 1.0, v162
    v_sub_f32 v32, v32, v160
    v_sub_f32 v64, v64, v160
    v_sub_f32 v48, v48, v160
    v_mul_f32 v80, v80, v161
    v_mul_f32 v96, v96, v161
    v_sub_f32 v33, v33, v160
    v_sub_f32 v65, v65, v160
    v_sub_f32 v49, v49, v160
    v_mul_f32 v81, v81, v161
    v_mul_f32 v97, v97, v161
    v_sub_f32 v34, v34, v160
    v_sub_f32 v66, v66, v160
    v_sub_f32 v50, v50, v160
    v_mul_f32 v82, v82, v161
    v_mul_f32 v98, v98, v161
    v_sub_f32 v35, v35, v160
    v_sub_f32 v67, v67, v160
    v_sub_f32 v51, v51, v160
    v_mul_f32 v83, v83, v161
    v_mul_f32 v99, v99, v161
    v_sub_f32 v36, v36, v160
    v_sub_f32 v68, v68, v160
    v_sub_f32 v52, v52, v160
    v_mul_f32 v84, v84, v161
    v_mul_f32 v100, v100, v161
    v_sub_f32 v37, v37, v160
    v_sub_f32 v69, v69, v160
    v_sub_f32 v53, v53, v160
    v_mul_f32 v85, v85, v161
    v_mul_f32 v101, v101, v161
    v_sub_f32 v38, v38, v160
    v_sub_f32 v70, v70, v160
    v_sub_f32 v54, v54, v160
    v_mul_f32 v86, v86, v161
    v_mul_f32 v102, v102, v161
    v_sub_f32 v39, v39, v160
    v_sub_f32 v71, v71, v160
    v_sub_f32 v55, v55, v160
    v_mul_f32 v87, v87, v161
    v_mul_f32 v103, v103, v161
    v_sub_f32 v40, v40, v160
    v_sub_f32 v72, v72, v160
    v_sub_f32 v56, v56, v160
    v_mul_f32 v88, v88, v161
    v_mul_f32 v104, v104, v161
    v_sub_f32 v41, v41, v160
    v_sub_f32 v73, v73, v160
    v_sub_f32 v57, v57, v160
    v_mul_f32 v89, v89, v161
    v_mul_f32 v105, v105, v161
    v_sub_f32 v42, v42, v160
    v_sub_f32 v74, v74, v160
    v_sub_f32 v58, v58, v160
    v_mul_f32 v90, v90, v161
    v_mul_f32 v106, v106, v161
    v_sub_f32 v43, v43, v160
    v_sub_f32 v75, v75, v160
    v_sub_f32 v59, v59, v160
    v_mul_f32 v91, v91, v161
    v_mul_f32 v107, v107, v161
    v_sub_f32 v44, v44, v160
    v_sub_f32 v76, v76, v160
    v_sub_f32 v60, v60, v160
    v_mul_f32 v92, v92, v161
    v_mul_f32 v108, v108, v161
    v_sub_f32 v45, v45, v160
    v_sub_f32 v77, v77, v160
    v_sub_f32 v61, v61, v160
    v_mul_f32 v93, v93, v161
    v_mul_f32 v109, v109, v161
    v_sub_f32 v46, v46, v160
    v_sub_f32 v78, v78, v160
    v_sub_f32 v62, v62, v160
    v_mul_f32 v94, v94, v161
    v_mul_f32 v110, v110, v161
    v_sub_f32 v47, v47, v160
    v_sub_f32 v79, v79, v160
    v_sub_f32 v63, v63, v160
    v_mul_f32 v95, v95, v161
    v_mul_f32 v111, v111, v161
    v_lshlrev_b32 v162, 16, v152
    v_and_b32 v163, 0xffff0000, v152
    v_mul_f32 v162, v162, v161
    v_mul_f32 v163, v163, v161
    v_cvt_pk_bf16_f32 v152, v162, v163
    v_lshlrev_b32 v162, 16, v153
    v_and_b32 v163, 0xffff0000, v153
    v_mul_f32 v162, v162, v161
    v_mul_f32 v163, v163, v161
    v_cvt_pk_bf16_f32 v153, v162, v163
    v_lshlrev_b32 v162, 16, v154
    v_and_b32 v163, 0xffff0000, v154
    v_mul_f32 v162, v162, v161
    v_mul_f32 v163, v163, v161
    v_cvt_pk_bf16_f32 v154, v162, v163
    v_lshlrev_b32 v162, 16, v155
    v_and_b32 v163, 0xffff0000, v155
    v_mul_f32 v162, v162, v161
    v_mul_f32 v163, v163, v161
    v_cvt_pk_bf16_f32 v155, v162, v163
    v_lshlrev_b32 v162, 16, v156
    v_and_b32 v163, 0xffff0000, v156
    v_mul_f32 v162, v162, v161
    v_mul_f32 v163, v163, v161
    v_cvt_pk_bf16_f32 v156, v162, v163
    v_lshlrev_b32 v162, 16, v157
    v_and_b32 v163, 0xffff0000, v157
    v_mul_f32 v162, v162, v161
    v_mul_f32 v163, v163, v161
    v_cvt_pk_bf16_f32 v157, v162, v163
    v_lshlrev_b32 v162, 16, v158
    v_and_b32 v163, 0xffff0000, v158
    v_mul_f32 v162, v162, v161
    v_mul_f32 v163, v163, v161
    v_cvt_pk_bf16_f32 v158, v162, v163
    v_lshlrev_b32 v162, 16, v159
    v_and_b32 v163, 0xffff0000, v159
    v_mul_f32 v162, v162, v161
    v_mul_f32 v163, v163, v161
    v_cvt_pk_bf16_f32 v159, v162, v163
    s_nop 1
    s_branch attn_kernel_back14
attn_kernel_resc15:
    v_mov_b32 v161, v160
    s_nop 1
    v_permlane32_swap_b32 v160, v161
    v_max_f32 v160, v160, v161
    v_max_f32 v160, 0, v160
    v_ceil_f32 v160, v160
    s_nop 15
    s_nop 15
    v_cvt_i32_f32 v162, v160
    v_sub_u32 v162, 0, v162
    v_ldexp_f32 v161, 1.0, v162
    v_sub_f32 v48, v48, v160
    v_sub_f32 v64, v64, v160
    v_sub_f32 v32, v32, v160
    v_mul_f32 v80, v80, v161
    v_mul_f32 v96, v96, v161
    v_sub_f32 v49, v49, v160
    v_sub_f32 v65, v65, v160
    v_sub_f32 v33, v33, v160
    v_mul_f32 v81, v81, v161
    v_mul_f32 v97, v97, v161
    v_sub_f32 v50, v50, v160
    v_sub_f32 v66, v66, v160
    v_sub_f32 v34, v34, v160
    v_mul_f32 v82, v82, v161
    v_mul_f32 v98, v98, v161
    v_sub_f32 v51, v51, v160
    v_sub_f32 v67, v67, v160
    v_sub_f32 v35, v35, v160
    v_mul_f32 v83, v83, v161
    v_mul_f32 v99, v99, v161
    v_sub_f32 v52, v52, v160
    v_sub_f32 v68, v68, v160
    v_sub_f32 v36, v36, v160
    v_mul_f32 v84, v84, v161
    v_mul_f32 v100, v100, v161
    v_sub_f32 v53, v53, v160
    v_sub_f32 v69, v69, v160
    v_sub_f32 v37, v37, v160
    v_mul_f32 v85, v85, v161
    v_mul_f32 v101, v101, v161
    v_sub_f32 v54, v54, v160
    v_sub_f32 v70, v70, v160
    v_sub_f32 v38, v38, v160
    v_mul_f32 v86, v86, v161
    v_mul_f32 v102, v102, v161
    v_sub_f32 v55, v55, v160
    v_sub_f32 v71, v71, v160
    v_sub_f32 v39, v39, v160
    v_mul_f32 v87, v87, v161
    v_mul_f32 v103, v103, v161
    v_sub_f32 v56, v56, v160
    v_sub_f32 v72, v72, v160
    v_sub_f32 v40, v40, v160
    v_mul_f32 v88, v88, v161
    v_mul_f32 v104, v104, v161
    v_sub_f32 v57, v57, v160
    v_sub_f32 v73, v73, v160
    v_sub_f32 v41, v41, v160
    v_mul_f32 v89, v89, v161
    v_mul_f32 v105, v105, v161
    v_sub_f32 v58, v58, v160
    v_sub_f32 v74, v74, v160
    v_sub_f32 v42, v42, v160
    v_mul_f32 v90, v90, v161
    v_mul_f32 v106, v106, v161
    v_sub_f32 v59, v59, v160
    v_sub_f32 v75, v75, v160
    v_sub_f32 v43, v43, v160
    v_mul_f32 v91, v91, v161
    v_mul_f32 v107, v107, v161
    v_sub_f32 v60, v60, v160
    v_sub_f32 v76, v76, v160
    v_sub_f32 v44, v44, v160
    v_mul_f32 v92, v92, v161
    v_mul_f32 v108, v108, v161
    v_sub_f32 v61, v61, v160
    v_sub_f32 v77, v77, v160
    v_sub_f32 v45, v45, v160
    v_mul_f32 v93, v93, v161
    v_mul_f32 v109, v109, v161
    v_sub_f32 v62, v62, v160
    v_sub_f32 v78, v78, v160
    v_sub_f32 v46, v46, v160
    v_mul_f32 v94, v94, v161
    v_mul_f32 v110, v110, v161
    v_sub_f32 v63, v63, v160
    v_sub_f32 v79, v79, v160
    v_sub_f32 v47, v47, v160
    v_mul_f32 v95, v95, v161
    v_mul_f32 v111, v111, v161
    v_lshlrev_b32 v162, 16, v144
    v_and_b32 v163, 0xffff0000, v144
    v_mul_f32 v162, v162, v161
    v_mul_f32 v163, v163, v161
    v_cvt_pk_bf16_f32 v144, v162, v163
    v_lshlrev_b32 v162, 16, v145
    v_and_b32 v163, 0xffff0000, v145
    v_mul_f32 v162, v162, v161
    v_mul_f32 v163, v163, v161
    v_cvt_pk_bf16_f32 v145, v162, v163
    v_lshlrev_b32 v162, 16, v146
    v_and_b32 v163, 0xffff0000, v146
    v_mul_f32 v162, v162, v161
    v_mul_f32 v163, v163, v161
    v_cvt_pk_bf16_f32 v146, v162, v163
    v_lshlrev_b32 v162, 16, v147
    v_and_b32 v163, 0xffff0000, v147
    v_mul_f32 v162, v162, v161
    v_mul_f32 v163, v163, v161
    v_cvt_pk_bf16_f32 v147, v162, v163
    v_lshlrev_b32 v162, 16, v148
    v_and_b32 v163, 0xffff0000, v148
    v_mul_f32 v162, v162, v161
    v_mul_f32 v163, v163, v161
    v_cvt_pk_bf16_f32 v148, v162, v163
    v_lshlrev_b32 v162, 16, v149
    v_and_b32 v163, 0xffff0000, v149
    v_mul_f32 v162, v162, v161
    v_mul_f32 v163, v163, v161
    v_cvt_pk_bf16_f32 v149, v162, v163
    v_lshlrev_b32 v162, 16, v150
    v_and_b32 v163, 0xffff0000, v150
    v_mul_f32 v162, v162, v161
    v_mul_f32 v163, v163, v161
    v_cvt_pk_bf16_f32 v150, v162, v163
    v_lshlrev_b32 v162, 16, v151
    v_and_b32 v163, 0xffff0000, v151
    v_mul_f32 v162, v162, v161
    v_mul_f32 v163, v163, v161
    v_cvt_pk_bf16_f32 v151, v162, v163
    s_nop 1
    s_branch attn_kernel_back16
attn_kernel_resc17:
    v_mov_b32 v161, v160
    s_nop 1
    v_permlane32_swap_b32 v160, v161
    v_max_f32 v160, v160, v161
    v_max_f32 v160, 0, v160
    v_ceil_f32 v160, v160
    s_nop 15
    s_nop 15
    v_cvt_i32_f32 v162, v160
    v_sub_u32 v162, 0, v162
    v_ldexp_f32 v161, 1.0, v162
    v_sub_f32 v32, v32, v160
    v_sub_f32 v64, v64, v160
    v_sub_f32 v48, v48, v160
    v_mul_f32 v80, v80, v161
    v_mul_f32 v96, v96, v161
    v_sub_f32 v33, v33, v160
    v_sub_f32 v65, v65, v160
    v_sub_f32 v49, v49, v160
    v_mul_f32 v81, v81, v161
    v_mul_f32 v97, v97, v161
    v_sub_f32 v34, v34, v160
    v_sub_f32 v66, v66, v160
    v_sub_f32 v50, v50, v160
    v_mul_f32 v82, v82, v161
    v_mul_f32 v98, v98, v161
    v_sub_f32 v35, v35, v160
    v_sub_f32 v67, v67, v160
    v_sub_f32 v51, v51, v160
    v_mul_f32 v83, v83, v161
    v_mul_f32 v99, v99, v161
    v_sub_f32 v36, v36, v160
    v_sub_f32 v68, v68, v160
    v_sub_f32 v52, v52, v160
    v_mul_f32 v84, v84, v161
    v_mul_f32 v100, v100, v161
    v_sub_f32 v37, v37, v160
    v_sub_f32 v69, v69, v160
    v_sub_f32 v53, v53, v160
    v_mul_f32 v85, v85, v161
    v_mul_f32 v101, v101, v161
    v_sub_f32 v38, v38, v160
    v_sub_f32 v70, v70, v160
    v_sub_f32 v54, v54, v160
    v_mul_f32 v86, v86, v161
    v_mul_f32 v102, v102, v161
    v_sub_f32 v39, v39, v160
    v_sub_f32 v71, v71, v160
    v_sub_f32 v55, v55, v160
    v_mul_f32 v87, v87, v161
    v_mul_f32 v103, v103, v161
    v_sub_f32 v40, v40, v160
    v_sub_f32 v72, v72, v160
    v_sub_f32 v56, v56, v160
    v_mul_f32 v88, v88, v161
    v_mul_f32 v104, v104, v161
    v_sub_f32 v41, v41, v160
    v_sub_f32 v73, v73, v160
    v_sub_f32 v57, v57, v160
    v_mul_f32 v89, v89, v161
    v_mul_f32 v105, v105, v161
    v_sub_f32 v42, v42, v160
    v_sub_f32 v74, v74, v160
    v_sub_f32 v58, v58, v160
    v_mul_f32 v90, v90, v161
    v_mul_f32 v106, v106, v161
    v_sub_f32 v43, v43, v160
    v_sub_f32 v75, v75, v160
    v_sub_f32 v59, v59, v160
    v_mul_f32 v91, v91, v161
    v_mul_f32 v107, v107, v161
    v_sub_f32 v44, v44, v160
    v_sub_f32 v76, v76, v160
    v_sub_f32 v60, v60, v160
    v_mul_f32 v92, v92, v161
    v_mul_f32 v108, v108, v161
    v_sub_f32 v45, v45, v160
    v_sub_f32 v77, v77, v160
    v_sub_f32 v61, v61, v160
    v_mul_f32 v93, v93, v161
    v_mul_f32 v109, v109, v161
    v_sub_f32 v46, v46, v160
    v_sub_f32 v78, v78, v160
    v_sub_f32 v62, v62, v160
    v_mul_f32 v94, v94, v161
    v_mul_f32 v110, v110, v161
    v_sub_f32 v47, v47, v160
    v_sub_f32 v79, v79, v160
    v_sub_f32 v63, v63, v160
    v_mul_f32 v95, v95, v161
    v_mul_f32 v111, v111, v161
    v_lshlrev_b32 v162, 16, v152
    v_and_b32 v163, 0xffff0000, v152
    v_mul_f32 v162, v162, v161
    v_mul_f32 v163, v163, v161
    v_cvt_pk_bf16_f32 v152, v162, v163
    v_lshlrev_b32 v162, 16, v153
    v_and_b32 v163, 0xffff0000, v153
    v_mul_f32 v162, v162, v161
    v_mul_f32 v163, v163, v161
    v_cvt_pk_bf16_f32 v153, v162, v163
    v_lshlrev_b32 v162, 16, v154
    v_and_b32 v163, 0xffff0000, v154
    v_mul_f32 v162, v162, v161
    v_mul_f32 v163, v163, v161
    v_cvt_pk_bf16_f32 v154, v162, v163
    v_lshlrev_b32 v162, 16, v155
    v_and_b32 v163, 0xffff0000, v155
    v_mul_f32 v162, v162, v161
    v_mul_f32 v163, v163, v161
    v_cvt_pk_bf16_f32 v155, v162, v163
    v_lshlrev_b32 v162, 16, v156
    v_and_b32 v163, 0xffff0000, v156
    v_mul_f32 v162, v162, v161
    v_mul_f32 v163, v163, v161
    v_cvt_pk_bf16_f32 v156, v162, v163
    v_lshlrev_b32 v162, 16, v157
    v_and_b32 v163, 0xffff0000, v157
    v_mul_f32 v162, v162, v161
    v_mul_f32 v163, v163, v161
    v_cvt_pk_bf16_f32 v157, v162, v163
    v_lshlrev_b32 v162, 16, v158
    v_and_b32 v163, 0xffff0000, v158
    v_mul_f32 v162, v162, v161
    v_mul_f32 v163, v163, v161
    v_cvt_pk_bf16_f32 v158, v162, v163
    v_lshlrev_b32 v162, 16, v159
    v_and_b32 v163, 0xffff0000, v159
    v_mul_f32 v162, v162, v161
    v_mul_f32 v163, v163, v161
    v_cvt_pk_bf16_f32 v159, v162, v163
    s_nop 1
    s_branch attn_kernel_back18
attn_kernel_resc19:
    v_mov_b32 v161, v160
    s_nop 1
    v_permlane32_swap_b32 v160, v161
    v_max_f32 v160, v160, v161
    v_max_f32 v160, 0, v160
    v_ceil_f32 v160, v160
    s_nop 15
    s_nop 15
    v_cvt_i32_f32 v162, v160
    v_sub_u32 v162, 0, v162
    v_ldexp_f32 v161, 1.0, v162
    v_sub_f32 v48, v48, v160
    v_sub_f32 v64, v64, v160
    v_sub_f32 v32, v32, v160
    v_mul_f32 v80, v80, v161
    v_mul_f32 v96, v96, v161
    v_sub_f32 v49, v49, v160
    v_sub_f32 v65, v65, v160
    v_sub_f32 v33, v33, v160
    v_mul_f32 v81, v81, v161
    v_mul_f32 v97, v97, v161
    v_sub_f32 v50, v50, v160
    v_sub_f32 v66, v66, v160
    v_sub_f32 v34, v34, v160
    v_mul_f32 v82, v82, v161
    v_mul_f32 v98, v98, v161
    v_sub_f32 v51, v51, v160
    v_sub_f32 v67, v67, v160
    v_sub_f32 v35, v35, v160
    v_mul_f32 v83, v83, v161
    v_mul_f32 v99, v99, v161
    v_sub_f32 v52, v52, v160
    v_sub_f32 v68, v68, v160
    v_sub_f32 v36, v36, v160
    v_mul_f32 v84, v84, v161
    v_mul_f32 v100, v100, v161
    v_sub_f32 v53, v53, v160
    v_sub_f32 v69, v69, v160
    v_sub_f32 v37, v37, v160
    v_mul_f32 v85, v85, v161
    v_mul_f32 v101, v101, v161
    v_sub_f32 v54, v54, v160
    v_sub_f32 v70, v70, v160
    v_sub_f32 v38, v38, v160
    v_mul_f32 v86, v86, v161
    v_mul_f32 v102, v102, v161
    v_sub_f32 v55, v55, v160
    v_sub_f32 v71, v71, v160
    v_sub_f32 v39, v39, v160
    v_mul_f32 v87, v87, v161
    v_mul_f32 v103, v103, v161
    v_sub_f32 v56, v56, v160
    v_sub_f32 v72, v72, v160
    v_sub_f32 v40, v40, v160
    v_mul_f32 v88, v88, v161
    v_mul_f32 v104, v104, v161
    v_sub_f32 v57, v57, v160
    v_sub_f32 v73, v73, v160
    v_sub_f32 v41, v41, v160
    v_mul_f32 v89, v89, v161
    v_mul_f32 v105, v105, v161
    v_sub_f32 v58, v58, v160
    v_sub_f32 v74, v74, v160
    v_sub_f32 v42, v42, v160
    v_mul_f32 v90, v90, v161
    v_mul_f32 v106, v106, v161
    v_sub_f32 v59, v59, v160
    v_sub_f32 v75, v75, v160
    v_sub_f32 v43, v43, v160
    v_mul_f32 v91, v91, v161
    v_mul_f32 v107, v107, v161
    v_sub_f32 v60, v60, v160
    v_sub_f32 v76, v76, v160
    v_sub_f32 v44, v44, v160
    v_mul_f32 v92, v92, v161
    v_mul_f32 v108, v108, v161
    v_sub_f32 v61, v61, v160
    v_sub_f32 v77, v77, v160
    v_sub_f32 v45, v45, v160
    v_mul_f32 v93, v93, v161
    v_mul_f32 v109, v109, v161
    v_sub_f32 v62, v62, v160
    v_sub_f32 v78, v78, v160
    v_sub_f32 v46, v46, v160
    v_mul_f32 v94, v94, v161
    v_mul_f32 v110, v110, v161
    v_sub_f32 v63, v63, v160
    v_sub_f32 v79, v79, v160
    v_sub_f32 v47, v47, v160
    v_mul_f32 v95, v95, v161
    v_mul_f32 v111, v111, v161
    v_lshlrev_b32 v162, 16, v144
    v_and_b32 v163, 0xffff0000, v144
    v_mul_f32 v162, v162, v161
    v_mul_f32 v163, v163, v161
    v_cvt_pk_bf16_f32 v144, v162, v163
    v_lshlrev_b32 v162, 16, v145
    v_and_b32 v163, 0xffff0000, v145
    v_mul_f32 v162, v162, v161
    v_mul_f32 v163, v163, v161
    v_cvt_pk_bf16_f32 v145, v162, v163
    v_lshlrev_b32 v162, 16, v146
    v_and_b32 v163, 0xffff0000, v146
    v_mul_f32 v162, v162, v161
    v_mul_f32 v163, v163, v161
    v_cvt_pk_bf16_f32 v146, v162, v163
    v_lshlrev_b32 v162, 16, v147
    v_and_b32 v163, 0xffff0000, v147
    v_mul_f32 v162, v162, v161
    v_mul_f32 v163, v163, v161
    v_cvt_pk_bf16_f32 v147, v162, v163
    v_lshlrev_b32 v162, 16, v148
    v_and_b32 v163, 0xffff0000, v148
    v_mul_f32 v162, v162, v161
    v_mul_f32 v163, v163, v161
    v_cvt_pk_bf16_f32 v148, v162, v163
    v_lshlrev_b32 v162, 16, v149
    v_and_b32 v163, 0xffff0000, v149
    v_mul_f32 v162, v162, v161
    v_mul_f32 v163, v163, v161
    v_cvt_pk_bf16_f32 v149, v162, v163
    v_lshlrev_b32 v162, 16, v150
    v_and_b32 v163, 0xffff0000, v150
    v_mul_f32 v162, v162, v161
    v_mul_f32 v163, v163, v161
    v_cvt_pk_bf16_f32 v150, v162, v163
    v_lshlrev_b32 v162, 16, v151
    v_and_b32 v163, 0xffff0000, v151
    v_mul_f32 v162, v162, v161
    v_mul_f32 v163, v163, v161
    v_cvt_pk_bf16_f32 v151, v162, v163
    s_nop 1
    s_branch attn_kernel_back20
attn_kernel_resc21:
    v_mov_b32 v161, v160
    s_nop 1
    v_permlane32_swap_b32 v160, v161
    v_max_f32 v160, v160, v161
    v_max_f32 v160, 0, v160
    v_ceil_f32 v160, v160
    s_nop 15
    s_nop 15
    v_cvt_i32_f32 v162, v160
    v_sub_u32 v162, 0, v162
    v_ldexp_f32 v161, 1.0, v162
    v_sub_f32 v32, v32, v160
    v_sub_f32 v64, v64, v160
    v_sub_f32 v48, v48, v160
    v_mul_f32 v80, v80, v161
    v_mul_f32 v96, v96, v161
    v_sub_f32 v33, v33, v160
    v_sub_f32 v65, v65, v160
    v_sub_f32 v49, v49, v160
    v_mul_f32 v81, v81, v161
    v_mul_f32 v97, v97, v161
    v_sub_f32 v34, v34, v160
    v_sub_f32 v66, v66, v160
    v_sub_f32 v50, v50, v160
    v_mul_f32 v82, v82, v161
    v_mul_f32 v98, v98, v161
    v_sub_f32 v35, v35, v160
    v_sub_f32 v67, v67, v160
    v_sub_f32 v51, v51, v160
    v_mul_f32 v83, v83, v161
    v_mul_f32 v99, v99, v161
    v_sub_f32 v36, v36, v160
    v_sub_f32 v68, v68, v160
    v_sub_f32 v52, v52, v160
    v_mul_f32 v84, v84, v161
    v_mul_f32 v100, v100, v161
    v_sub_f32 v37, v37, v160
    v_sub_f32 v69, v69, v160
    v_sub_f32 v53, v53, v160
    v_mul_f32 v85, v85, v161
    v_mul_f32 v101, v101, v161
    v_sub_f32 v38, v38, v160
    v_sub_f32 v70, v70, v160
    v_sub_f32 v54, v54, v160
    v_mul_f32 v86, v86, v161
    v_mul_f32 v102, v102, v161
    v_sub_f32 v39, v39, v160
    v_sub_f32 v71, v71, v160
    v_sub_f32 v55, v55, v160
    v_mul_f32 v87, v87, v161
    v_mul_f32 v103, v103, v161
    v_sub_f32 v40, v40, v160
    v_sub_f32 v72, v72, v160
    v_sub_f32 v56, v56, v160
    v_mul_f32 v88, v88, v161
    v_mul_f32 v104, v104, v161
    v_sub_f32 v41, v41, v160
    v_sub_f32 v73, v73, v160
    v_sub_f32 v57, v57, v160
    v_mul_f32 v89, v89, v161
    v_mul_f32 v105, v105, v161
    v_sub_f32 v42, v42, v160
    v_sub_f32 v74, v74, v160
    v_sub_f32 v58, v58, v160
    v_mul_f32 v90, v90, v161
    v_mul_f32 v106, v106, v161
    v_sub_f32 v43, v43, v160
    v_sub_f32 v75, v75, v160
    v_sub_f32 v59, v59, v160
    v_mul_f32 v91, v91, v161
    v_mul_f32 v107, v107, v161
    v_sub_f32 v44, v44, v160
    v_sub_f32 v76, v76, v160
    v_sub_f32 v60, v60, v160
    v_mul_f32 v92, v92, v161
    v_mul_f32 v108, v108, v161
    v_sub_f32 v45, v45, v160
    v_sub_f32 v77, v77, v160
    v_sub_f32 v61, v61, v160
    v_mul_f32 v93, v93, v161
    v_mul_f32 v109, v109, v161
    v_sub_f32 v46, v46, v160
    v_sub_f32 v78, v78, v160
    v_sub_f32 v62, v62, v160
    v_mul_f32 v94, v94, v161
    v_mul_f32 v110, v110, v161
    v_sub_f32 v47, v47, v160
    v_sub_f32 v79, v79, v160
    v_sub_f32 v63, v63, v160
    v_mul_f32 v95, v95, v161
    v_mul_f32 v111, v111, v161
    v_lshlrev_b32 v162, 16, v152
    v_and_b32 v163, 0xffff0000, v152
    v_mul_f32 v162, v162, v161
    v_mul_f32 v163, v163, v161
    v_cvt_pk_bf16_f32 v152, v162, v163
    v_lshlrev_b32 v162, 16, v153
    v_and_b32 v163, 0xffff0000, v153
    v_mul_f32 v162, v162, v161
    v_mul_f32 v163, v163, v161
    v_cvt_pk_bf16_f32 v153, v162, v163
    v_lshlrev_b32 v162, 16, v154
    v_and_b32 v163, 0xffff0000, v154
    v_mul_f32 v162, v162, v161
    v_mul_f32 v163, v163, v161
    v_cvt_pk_bf16_f32 v154, v162, v163
    v_lshlrev_b32 v162, 16, v155
    v_and_b32 v163, 0xffff0000, v155
    v_mul_f32 v162, v162, v161
    v_mul_f32 v163, v163, v161
    v_cvt_pk_bf16_f32 v155, v162, v163
    v_lshlrev_b32 v162, 16, v156
    v_and_b32 v163, 0xffff0000, v156
    v_mul_f32 v162, v162, v161
    v_mul_f32 v163, v163, v161
    v_cvt_pk_bf16_f32 v156, v162, v163
    v_lshlrev_b32 v162, 16, v157
    v_and_b32 v163, 0xffff0000, v157
    v_mul_f32 v162, v162, v161
    v_mul_f32 v163, v163, v161
    v_cvt_pk_bf16_f32 v157, v162, v163
    v_lshlrev_b32 v162, 16, v158
    v_and_b32 v163, 0xffff0000, v158
    v_mul_f32 v162, v162, v161
    v_mul_f32 v163, v163, v161
    v_cvt_pk_bf16_f32 v158, v162, v163
    v_lshlrev_b32 v162, 16, v159
    v_and_b32 v163, 0xffff0000, v159
    v_mul_f32 v162, v162, v161
    v_mul_f32 v163, v163, v161
    v_cvt_pk_bf16_f32 v159, v162, v163
    s_nop 1
    s_branch attn_kernel_back22
attn_kernel_resc23:
    v_mov_b32 v161, v160
    s_nop 1
    v_permlane32_swap_b32 v160, v161
    v_max_f32 v160, v160, v161
    v_max_f32 v160, 0, v160
    v_ceil_f32 v160, v160
    s_nop 15
    s_nop 15
    v_cvt_i32_f32 v162, v160
    v_sub_u32 v162, 0, v162
    v_ldexp_f32 v161, 1.0, v162
    v_sub_f32 v48, v48, v160
    v_sub_f32 v64, v64, v160
    v_sub_f32 v32, v32, v160
    v_mul_f32 v80, v80, v161
    v_mul_f32 v96, v96, v161
    v_sub_f32 v49, v49, v160
    v_sub_f32 v65, v65, v160
    v_sub_f32 v33, v33, v160
    v_mul_f32 v81, v81, v161
    v_mul_f32 v97, v97, v161
    v_sub_f32 v50, v50, v160
    v_sub_f32 v66, v66, v160
    v_sub_f32 v34, v34, v160
    v_mul_f32 v82, v82, v161
    v_mul_f32 v98, v98, v161
    v_sub_f32 v51, v51, v160
    v_sub_f32 v67, v67, v160
    v_sub_f32 v35, v35, v160
    v_mul_f32 v83, v83, v161
    v_mul_f32 v99, v99, v161
    v_sub_f32 v52, v52, v160
    v_sub_f32 v68, v68, v160
    v_sub_f32 v36, v36, v160
    v_mul_f32 v84, v84, v161
    v_mul_f32 v100, v100, v161
    v_sub_f32 v53, v53, v160
    v_sub_f32 v69, v69, v160
    v_sub_f32 v37, v37, v160
    v_mul_f32 v85, v85, v161
    v_mul_f32 v101, v101, v161
    v_sub_f32 v54, v54, v160
    v_sub_f32 v70, v70, v160
    v_sub_f32 v38, v38, v160
    v_mul_f32 v86, v86, v161
    v_mul_f32 v102, v102, v161
    v_sub_f32 v55, v55, v160
    v_sub_f32 v71, v71, v160
    v_sub_f32 v39, v39, v160
    v_mul_f32 v87, v87, v161
    v_mul_f32 v103, v103, v161
    v_sub_f32 v56, v56, v160
    v_sub_f32 v72, v72, v160
    v_sub_f32 v40, v40, v160
    v_mul_f32 v88, v88, v161
    v_mul_f32 v104, v104, v161
    v_sub_f32 v57, v57, v160
    v_sub_f32 v73, v73, v160
    v_sub_f32 v41, v41, v160
    v_mul_f32 v89, v89, v161
    v_mul_f32 v105, v105, v161
    v_sub_f32 v58, v58, v160
    v_sub_f32 v74, v74, v160
    v_sub_f32 v42, v42, v160
    v_mul_f32 v90, v90, v161
    v_mul_f32 v106, v106, v161
    v_sub_f32 v59, v59, v160
    v_sub_f32 v75, v75, v160
    v_sub_f32 v43, v43, v160
    v_mul_f32 v91, v91, v161
    v_mul_f32 v107, v107, v161
    v_sub_f32 v60, v60, v160
    v_sub_f32 v76, v76, v160
    v_sub_f32 v44, v44, v160
    v_mul_f32 v92, v92, v161
    v_mul_f32 v108, v108, v161
    v_sub_f32 v61, v61, v160
    v_sub_f32 v77, v77, v160
    v_sub_f32 v45, v45, v160
    v_mul_f32 v93, v93, v161
    v_mul_f32 v109, v109, v161
    v_sub_f32 v62, v62, v160
    v_sub_f32 v78, v78, v160
    v_sub_f32 v46, v46, v160
    v_mul_f32 v94, v94, v161
    v_mul_f32 v110, v110, v161
    v_sub_f32 v63, v63, v160
    v_sub_f32 v79, v79, v160
    v_sub_f32 v47, v47, v160
    v_mul_f32 v95, v95, v161
    v_mul_f32 v111, v111, v161
    v_lshlrev_b32 v162, 16, v144
    v_and_b32 v163, 0xffff0000, v144
    v_mul_f32 v162, v162, v161
    v_mul_f32 v163, v163, v161
    v_cvt_pk_bf16_f32 v144, v162, v163
    v_lshlrev_b32 v162, 16, v145
    v_and_b32 v163, 0xffff0000, v145
    v_mul_f32 v162, v162, v161
    v_mul_f32 v163, v163, v161
    v_cvt_pk_bf16_f32 v145, v162, v163
    v_lshlrev_b32 v162, 16, v146
    v_and_b32 v163, 0xffff0000, v146
    v_mul_f32 v162, v162, v161
    v_mul_f32 v163, v163, v161
    v_cvt_pk_bf16_f32 v146, v162, v163
    v_lshlrev_b32 v162, 16, v147
    v_and_b32 v163, 0xffff0000, v147
    v_mul_f32 v162, v162, v161
    v_mul_f32 v163, v163, v161
    v_cvt_pk_bf16_f32 v147, v162, v163
    v_lshlrev_b32 v162, 16, v148
    v_and_b32 v163, 0xffff0000, v148
    v_mul_f32 v162, v162, v161
    v_mul_f32 v163, v163, v161
    v_cvt_pk_bf16_f32 v148, v162, v163
    v_lshlrev_b32 v162, 16, v149
    v_and_b32 v163, 0xffff0000, v149
    v_mul_f32 v162, v162, v161
    v_mul_f32 v163, v163, v161
    v_cvt_pk_bf16_f32 v149, v162, v163
    v_lshlrev_b32 v162, 16, v150
    v_and_b32 v163, 0xffff0000, v150
    v_mul_f32 v162, v162, v161
    v_mul_f32 v163, v163, v161
    v_cvt_pk_bf16_f32 v150, v162, v163
    v_lshlrev_b32 v162, 16, v151
    v_and_b32 v163, 0xffff0000, v151
    v_mul_f32 v162, v162, v161
    v_mul_f32 v163, v163, v161
    v_cvt_pk_bf16_f32 v151, v162, v163
    s_nop 1
    s_branch attn_kernel_back24
attn_kernel_resc25:
    v_mov_b32 v161, v160
    s_nop 1
    v_permlane32_swap_b32 v160, v161
    v_max_f32 v160, v160, v161
    v_max_f32 v160, 0, v160
    v_ceil_f32 v160, v160
    s_nop 15
    s_nop 15
    v_cvt_i32_f32 v162, v160
    v_sub_u32 v162, 0, v162
    v_ldexp_f32 v161, 1.0, v162
    v_sub_f32 v32, v32, v160
    v_sub_f32 v64, v64, v160
    v_sub_f32 v48, v48, v160
    v_mul_f32 v80, v80, v161
    v_mul_f32 v96, v96, v161
    v_sub_f32 v33, v33, v160
    v_sub_f32 v65, v65, v160
    v_sub_f32 v49, v49, v160
    v_mul_f32 v81, v81, v161
    v_mul_f32 v97, v97, v161
    v_sub_f32 v34, v34, v160
    v_sub_f32 v66, v66, v160
    v_sub_f32 v50, v50, v160
    v_mul_f32 v82, v82, v161
    v_mul_f32 v98, v98, v161
    v_sub_f32 v35, v35, v160
    v_sub_f32 v67, v67, v160
    v_sub_f32 v51, v51, v160
    v_mul_f32 v83, v83, v161
    v_mul_f32 v99, v99, v161
    v_sub_f32 v36, v36, v160
    v_sub_f32 v68, v68, v160
    v_sub_f32 v52, v52, v160
    v_mul_f32 v84, v84, v161
    v_mul_f32 v100, v100, v161
    v_sub_f32 v37, v37, v160
    v_sub_f32 v69, v69, v160
    v_sub_f32 v53, v53, v160
    v_mul_f32 v85, v85, v161
    v_mul_f32 v101, v101, v161
    v_sub_f32 v38, v38, v160
    v_sub_f32 v70, v70, v160
    v_sub_f32 v54, v54, v160
    v_mul_f32 v86, v86, v161
    v_mul_f32 v102, v102, v161
    v_sub_f32 v39, v39, v160
    v_sub_f32 v71, v71, v160
    v_sub_f32 v55, v55, v160
    v_mul_f32 v87, v87, v161
    v_mul_f32 v103, v103, v161
    v_sub_f32 v40, v40, v160
    v_sub_f32 v72, v72, v160
    v_sub_f32 v56, v56, v160
    v_mul_f32 v88, v88, v161
    v_mul_f32 v104, v104, v161
    v_sub_f32 v41, v41, v160
    v_sub_f32 v73, v73, v160
    v_sub_f32 v57, v57, v160
    v_mul_f32 v89, v89, v161
    v_mul_f32 v105, v105, v161
    v_sub_f32 v42, v42, v160
    v_sub_f32 v74, v74, v160
    v_sub_f32 v58, v58, v160
    v_mul_f32 v90, v90, v161
    v_mul_f32 v106, v106, v161
    v_sub_f32 v43, v43, v160
    v_sub_f32 v75, v75, v160
    v_sub_f32 v59, v59, v160
    v_mul_f32 v91, v91, v161
    v_mul_f32 v107, v107, v161
    v_sub_f32 v44, v44, v160
    v_sub_f32 v76, v76, v160
    v_sub_f32 v60, v60, v160
    v_mul_f32 v92, v92, v161
    v_mul_f32 v108, v108, v161
    v_sub_f32 v45, v45, v160
    v_sub_f32 v77, v77, v160
    v_sub_f32 v61, v61, v160
    v_mul_f32 v93, v93, v161
    v_mul_f32 v109, v109, v161
    v_sub_f32 v46, v46, v160
    v_sub_f32 v78, v78, v160
    v_sub_f32 v62, v62, v160
    v_mul_f32 v94, v94, v161
    v_mul_f32 v110, v110, v161
    v_sub_f32 v47, v47, v160
    v_sub_f32 v79, v79, v160
    v_sub_f32 v63, v63, v160
    v_mul_f32 v95, v95, v161
    v_mul_f32 v111, v111, v161
    v_lshlrev_b32 v162, 16, v152
    v_and_b32 v163, 0xffff0000, v152
    v_mul_f32 v162, v162, v161
    v_mul_f32 v163, v163, v161
    v_cvt_pk_bf16_f32 v152, v162, v163
    v_lshlrev_b32 v162, 16, v153
    v_and_b32 v163, 0xffff0000, v153
    v_mul_f32 v162, v162, v161
    v_mul_f32 v163, v163, v161
    v_cvt_pk_bf16_f32 v153, v162, v163
    v_lshlrev_b32 v162, 16, v154
    v_and_b32 v163, 0xffff0000, v154
    v_mul_f32 v162, v162, v161
    v_mul_f32 v163, v163, v161
    v_cvt_pk_bf16_f32 v154, v162, v163
    v_lshlrev_b32 v162, 16, v155
    v_and_b32 v163, 0xffff0000, v155
    v_mul_f32 v162, v162, v161
    v_mul_f32 v163, v163, v161
    v_cvt_pk_bf16_f32 v155, v162, v163
    v_lshlrev_b32 v162, 16, v156
    v_and_b32 v163, 0xffff0000, v156
    v_mul_f32 v162, v162, v161
    v_mul_f32 v163, v163, v161
    v_cvt_pk_bf16_f32 v156, v162, v163
    v_lshlrev_b32 v162, 16, v157
    v_and_b32 v163, 0xffff0000, v157
    v_mul_f32 v162, v162, v161
    v_mul_f32 v163, v163, v161
    v_cvt_pk_bf16_f32 v157, v162, v163
    v_lshlrev_b32 v162, 16, v158
    v_and_b32 v163, 0xffff0000, v158
    v_mul_f32 v162, v162, v161
    v_mul_f32 v163, v163, v161
    v_cvt_pk_bf16_f32 v158, v162, v163
    v_lshlrev_b32 v162, 16, v159
    v_and_b32 v163, 0xffff0000, v159
    v_mul_f32 v162, v162, v161
    v_mul_f32 v163, v163, v161
    v_cvt_pk_bf16_f32 v159, v162, v163
    s_nop 1
    s_branch attn_kernel_back26
attn_kernel_resc27:
    v_mov_b32 v161, v160
    s_nop 1
    v_permlane32_swap_b32 v160, v161
    v_max_f32 v160, v160, v161
    v_max_f32 v160, 0, v160
    v_ceil_f32 v160, v160
    s_nop 15
    s_nop 15
    v_cvt_i32_f32 v162, v160
    v_sub_u32 v162, 0, v162
    v_ldexp_f32 v161, 1.0, v162
    v_sub_f32 v48, v48, v160
    v_sub_f32 v64, v64, v160
    v_sub_f32 v32, v32, v160
    v_mul_f32 v80, v80, v161
    v_mul_f32 v96, v96, v161
    v_sub_f32 v49, v49, v160
    v_sub_f32 v65, v65, v160
    v_sub_f32 v33, v33, v160
    v_mul_f32 v81, v81, v161
    v_mul_f32 v97, v97, v161
    v_sub_f32 v50, v50, v160
    v_sub_f32 v66, v66, v160
    v_sub_f32 v34, v34, v160
    v_mul_f32 v82, v82, v161
    v_mul_f32 v98, v98, v161
    v_sub_f32 v51, v51, v160
    v_sub_f32 v67, v67, v160
    v_sub_f32 v35, v35, v160
    v_mul_f32 v83, v83, v161
    v_mul_f32 v99, v99, v161
    v_sub_f32 v52, v52, v160
    v_sub_f32 v68, v68, v160
    v_sub_f32 v36, v36, v160
    v_mul_f32 v84, v84, v161
    v_mul_f32 v100, v100, v161
    v_sub_f32 v53, v53, v160
    v_sub_f32 v69, v69, v160
    v_sub_f32 v37, v37, v160
    v_mul_f32 v85, v85, v161
    v_mul_f32 v101, v101, v161
    v_sub_f32 v54, v54, v160
    v_sub_f32 v70, v70, v160
    v_sub_f32 v38, v38, v160
    v_mul_f32 v86, v86, v161
    v_mul_f32 v102, v102, v161
    v_sub_f32 v55, v55, v160
    v_sub_f32 v71, v71, v160
    v_sub_f32 v39, v39, v160
    v_mul_f32 v87, v87, v161
    v_mul_f32 v103, v103, v161
    v_sub_f32 v56, v56, v160
    v_sub_f32 v72, v72, v160
    v_sub_f32 v40, v40, v160
    v_mul_f32 v88, v88, v161
    v_mul_f32 v104, v104, v161
    v_sub_f32 v57, v57, v160
    v_sub_f32 v73, v73, v160
    v_sub_f32 v41, v41, v160
    v_mul_f32 v89, v89, v161
    v_mul_f32 v105, v105, v161
    v_sub_f32 v58, v58, v160
    v_sub_f32 v74, v74, v160
    v_sub_f32 v42, v42, v160
    v_mul_f32 v90, v90, v161
    v_mul_f32 v106, v106, v161
    v_sub_f32 v59, v59, v160
    v_sub_f32 v75, v75, v160
    v_sub_f32 v43, v43, v160
    v_mul_f32 v91, v91, v161
    v_mul_f32 v107, v107, v161
    v_sub_f32 v60, v60, v160
    v_sub_f32 v76, v76, v160
    v_sub_f32 v44, v44, v160
    v_mul_f32 v92, v92, v161
    v_mul_f32 v108, v108, v161
    v_sub_f32 v61, v61, v160
    v_sub_f32 v77, v77, v160
    v_sub_f32 v45, v45, v160
    v_mul_f32 v93, v93, v161
    v_mul_f32 v109, v109, v161
    v_sub_f32 v62, v62, v160
    v_sub_f32 v78, v78, v160
    v_sub_f32 v46, v46, v160
    v_mul_f32 v94, v94, v161
    v_mul_f32 v110, v110, v161
    v_sub_f32 v63, v63, v160
    v_sub_f32 v79, v79, v160
    v_sub_f32 v47, v47, v160
    v_mul_f32 v95, v95, v161
    v_mul_f32 v111, v111, v161
    v_lshlrev_b32 v162, 16, v144
    v_and_b32 v163, 0xffff0000, v144
    v_mul_f32 v162, v162, v161
    v_mul_f32 v163, v163, v161
    v_cvt_pk_bf16_f32 v144, v162, v163
    v_lshlrev_b32 v162, 16, v145
    v_and_b32 v163, 0xffff0000, v145
    v_mul_f32 v162, v162, v161
    v_mul_f32 v163, v163, v161
    v_cvt_pk_bf16_f32 v145, v162, v163
    v_lshlrev_b32 v162, 16, v146
    v_and_b32 v163, 0xffff0000, v146
    v_mul_f32 v162, v162, v161
    v_mul_f32 v163, v163, v161
    v_cvt_pk_bf16_f32 v146, v162, v163
    v_lshlrev_b32 v162, 16, v147
    v_and_b32 v163, 0xffff0000, v147
    v_mul_f32 v162, v162, v161
    v_mul_f32 v163, v163, v161
    v_cvt_pk_bf16_f32 v147, v162, v163
    v_lshlrev_b32 v162, 16, v148
    v_and_b32 v163, 0xffff0000, v148
    v_mul_f32 v162, v162, v161
    v_mul_f32 v163, v163, v161
    v_cvt_pk_bf16_f32 v148, v162, v163
    v_lshlrev_b32 v162, 16, v149
    v_and_b32 v163, 0xffff0000, v149
    v_mul_f32 v162, v162, v161
    v_mul_f32 v163, v163, v161
    v_cvt_pk_bf16_f32 v149, v162, v163
    v_lshlrev_b32 v162, 16, v150
    v_and_b32 v163, 0xffff0000, v150
    v_mul_f32 v162, v162, v161
    v_mul_f32 v163, v163, v161
    v_cvt_pk_bf16_f32 v150, v162, v163
    v_lshlrev_b32 v162, 16, v151
    v_and_b32 v163, 0xffff0000, v151
    v_mul_f32 v162, v162, v161
    v_mul_f32 v163, v163, v161
    v_cvt_pk_bf16_f32 v151, v162, v163
    s_nop 1
    s_branch attn_kernel_back28
attn_kernel_resc29:
    v_mov_b32 v161, v160
    s_nop 1
    v_permlane32_swap_b32 v160, v161
    v_max_f32 v160, v160, v161
    v_max_f32 v160, 0, v160
    v_ceil_f32 v160, v160
    s_nop 15
    s_nop 15
    v_cvt_i32_f32 v162, v160
    v_sub_u32 v162, 0, v162
    v_ldexp_f32 v161, 1.0, v162
    v_sub_f32 v32, v32, v160
    v_sub_f32 v64, v64, v160
    v_sub_f32 v48, v48, v160
    v_mul_f32 v80, v80, v161
    v_mul_f32 v96, v96, v161
    v_sub_f32 v33, v33, v160
    v_sub_f32 v65, v65, v160
    v_sub_f32 v49, v49, v160
    v_mul_f32 v81, v81, v161
    v_mul_f32 v97, v97, v161
    v_sub_f32 v34, v34, v160
    v_sub_f32 v66, v66, v160
    v_sub_f32 v50, v50, v160
    v_mul_f32 v82, v82, v161
    v_mul_f32 v98, v98, v161
    v_sub_f32 v35, v35, v160
    v_sub_f32 v67, v67, v160
    v_sub_f32 v51, v51, v160
    v_mul_f32 v83, v83, v161
    v_mul_f32 v99, v99, v161
    v_sub_f32 v36, v36, v160
    v_sub_f32 v68, v68, v160
    v_sub_f32 v52, v52, v160
    v_mul_f32 v84, v84, v161
    v_mul_f32 v100, v100, v161
    v_sub_f32 v37, v37, v160
    v_sub_f32 v69, v69, v160
    v_sub_f32 v53, v53, v160
    v_mul_f32 v85, v85, v161
    v_mul_f32 v101, v101, v161
    v_sub_f32 v38, v38, v160
    v_sub_f32 v70, v70, v160
    v_sub_f32 v54, v54, v160
    v_mul_f32 v86, v86, v161
    v_mul_f32 v102, v102, v161
    v_sub_f32 v39, v39, v160
    v_sub_f32 v71, v71, v160
    v_sub_f32 v55, v55, v160
    v_mul_f32 v87, v87, v161
    v_mul_f32 v103, v103, v161
    v_sub_f32 v40, v40, v160
    v_sub_f32 v72, v72, v160
    v_sub_f32 v56, v56, v160
    v_mul_f32 v88, v88, v161
    v_mul_f32 v104, v104, v161
    v_sub_f32 v41, v41, v160
    v_sub_f32 v73, v73, v160
    v_sub_f32 v57, v57, v160
    v_mul_f32 v89, v89, v161
    v_mul_f32 v105, v105, v161
    v_sub_f32 v42, v42, v160
    v_sub_f32 v74, v74, v160
    v_sub_f32 v58, v58, v160
    v_mul_f32 v90, v90, v161
    v_mul_f32 v106, v106, v161
    v_sub_f32 v43, v43, v160
    v_sub_f32 v75, v75, v160
    v_sub_f32 v59, v59, v160
    v_mul_f32 v91, v91, v161
    v_mul_f32 v107, v107, v161
    v_sub_f32 v44, v44, v160
    v_sub_f32 v76, v76, v160
    v_sub_f32 v60, v60, v160
    v_mul_f32 v92, v92, v161
    v_mul_f32 v108, v108, v161
    v_sub_f32 v45, v45, v160
    v_sub_f32 v77, v77, v160
    v_sub_f32 v61, v61, v160
    v_mul_f32 v93, v93, v161
    v_mul_f32 v109, v109, v161
    v_sub_f32 v46, v46, v160
    v_sub_f32 v78, v78, v160
    v_sub_f32 v62, v62, v160
    v_mul_f32 v94, v94, v161
    v_mul_f32 v110, v110, v161
    v_sub_f32 v47, v47, v160
    v_sub_f32 v79, v79, v160
    v_sub_f32 v63, v63, v160
    v_mul_f32 v95, v95, v161
    v_mul_f32 v111, v111, v161
    v_lshlrev_b32 v162, 16, v152
    v_and_b32 v163, 0xffff0000, v152
    v_mul_f32 v162, v162, v161
    v_mul_f32 v163, v163, v161
    v_cvt_pk_bf16_f32 v152, v162, v163
    v_lshlrev_b32 v162, 16, v153
    v_and_b32 v163, 0xffff0000, v153
    v_mul_f32 v162, v162, v161
    v_mul_f32 v163, v163, v161
    v_cvt_pk_bf16_f32 v153, v162, v163
    v_lshlrev_b32 v162, 16, v154
    v_and_b32 v163, 0xffff0000, v154
    v_mul_f32 v162, v162, v161
    v_mul_f32 v163, v163, v161
    v_cvt_pk_bf16_f32 v154, v162, v163
    v_lshlrev_b32 v162, 16, v155
    v_and_b32 v163, 0xffff0000, v155
    v_mul_f32 v162, v162, v161
    v_mul_f32 v163, v163, v161
    v_cvt_pk_bf16_f32 v155, v162, v163
    v_lshlrev_b32 v162, 16, v156
    v_and_b32 v163, 0xffff0000, v156
    v_mul_f32 v162, v162, v161
    v_mul_f32 v163, v163, v161
    v_cvt_pk_bf16_f32 v156, v162, v163
    v_lshlrev_b32 v162, 16, v157
    v_and_b32 v163, 0xffff0000, v157
    v_mul_f32 v162, v162, v161
    v_mul_f32 v163, v163, v161
    v_cvt_pk_bf16_f32 v157, v162, v163
    v_lshlrev_b32 v162, 16, v158
    v_and_b32 v163, 0xffff0000, v158
    v_mul_f32 v162, v162, v161
    v_mul_f32 v163, v163, v161
    v_cvt_pk_bf16_f32 v158, v162, v163
    v_lshlrev_b32 v162, 16, v159
    v_and_b32 v163, 0xffff0000, v159
    v_mul_f32 v162, v162, v161
    v_mul_f32 v163, v163, v161
    v_cvt_pk_bf16_f32 v159, v162, v163
    s_nop 1
    s_branch attn_kernel_back30
attn_kernel_resc31:
    v_mov_b32 v161, v160
    s_nop 1
    v_permlane32_swap_b32 v160, v161
    v_max_f32 v160, v160, v161
    v_max_f32 v160, 0, v160
    v_ceil_f32 v160, v160
    s_nop 15
    s_nop 15
    v_cvt_i32_f32 v162, v160
    v_sub_u32 v162, 0, v162
    v_ldexp_f32 v161, 1.0, v162
    v_sub_f32 v48, v48, v160
    v_sub_f32 v64, v64, v160
    v_sub_f32 v32, v32, v160
    v_mul_f32 v80, v80, v161
    v_mul_f32 v96, v96, v161
    v_sub_f32 v49, v49, v160
    v_sub_f32 v65, v65, v160
    v_sub_f32 v33, v33, v160
    v_mul_f32 v81, v81, v161
    v_mul_f32 v97, v97, v161
    v_sub_f32 v50, v50, v160
    v_sub_f32 v66, v66, v160
    v_sub_f32 v34, v34, v160
    v_mul_f32 v82, v82, v161
    v_mul_f32 v98, v98, v161
    v_sub_f32 v51, v51, v160
    v_sub_f32 v67, v67, v160
    v_sub_f32 v35, v35, v160
    v_mul_f32 v83, v83, v161
    v_mul_f32 v99, v99, v161
    v_sub_f32 v52, v52, v160
    v_sub_f32 v68, v68, v160
    v_sub_f32 v36, v36, v160
    v_mul_f32 v84, v84, v161
    v_mul_f32 v100, v100, v161
    v_sub_f32 v53, v53, v160
    v_sub_f32 v69, v69, v160
    v_sub_f32 v37, v37, v160
    v_mul_f32 v85, v85, v161
    v_mul_f32 v101, v101, v161
    v_sub_f32 v54, v54, v160
    v_sub_f32 v70, v70, v160
    v_sub_f32 v38, v38, v160
    v_mul_f32 v86, v86, v161
    v_mul_f32 v102, v102, v161
    v_sub_f32 v55, v55, v160
    v_sub_f32 v71, v71, v160
    v_sub_f32 v39, v39, v160
    v_mul_f32 v87, v87, v161
    v_mul_f32 v103, v103, v161
    v_sub_f32 v56, v56, v160
    v_sub_f32 v72, v72, v160
    v_sub_f32 v40, v40, v160
    v_mul_f32 v88, v88, v161
    v_mul_f32 v104, v104, v161
    v_sub_f32 v57, v57, v160
    v_sub_f32 v73, v73, v160
    v_sub_f32 v41, v41, v160
    v_mul_f32 v89, v89, v161
    v_mul_f32 v105, v105, v161
    v_sub_f32 v58, v58, v160
    v_sub_f32 v74, v74, v160
    v_sub_f32 v42, v42, v160
    v_mul_f32 v90, v90, v161
    v_mul_f32 v106, v106, v161
    v_sub_f32 v59, v59, v160
    v_sub_f32 v75, v75, v160
    v_sub_f32 v43, v43, v160
    v_mul_f32 v91, v91, v161
    v_mul_f32 v107, v107, v161
    v_sub_f32 v60, v60, v160
    v_sub_f32 v76, v76, v160
    v_sub_f32 v44, v44, v160
    v_mul_f32 v92, v92, v161
    v_mul_f32 v108, v108, v161
    v_sub_f32 v61, v61, v160
    v_sub_f32 v77, v77, v160
    v_sub_f32 v45, v45, v160
    v_mul_f32 v93, v93, v161
    v_mul_f32 v109, v109, v161
    v_sub_f32 v62, v62, v160
    v_sub_f32 v78, v78, v160
    v_sub_f32 v46, v46, v160
    v_mul_f32 v94, v94, v161
    v_mul_f32 v110, v110, v161
    v_sub_f32 v63, v63, v160
    v_sub_f32 v79, v79, v160
    v_sub_f32 v47, v47, v160
    v_mul_f32 v95, v95, v161
    v_mul_f32 v111, v111, v161
    v_lshlrev_b32 v162, 16, v144
    v_and_b32 v163, 0xffff0000, v144
    v_mul_f32 v162, v162, v161
    v_mul_f32 v163, v163, v161
    v_cvt_pk_bf16_f32 v144, v162, v163
    v_lshlrev_b32 v162, 16, v145
    v_and_b32 v163, 0xffff0000, v145
    v_mul_f32 v162, v162, v161
    v_mul_f32 v163, v163, v161
    v_cvt_pk_bf16_f32 v145, v162, v163
    v_lshlrev_b32 v162, 16, v146
    v_and_b32 v163, 0xffff0000, v146
    v_mul_f32 v162, v162, v161
    v_mul_f32 v163, v163, v161
    v_cvt_pk_bf16_f32 v146, v162, v163
    v_lshlrev_b32 v162, 16, v147
    v_and_b32 v163, 0xffff0000, v147
    v_mul_f32 v162, v162, v161
    v_mul_f32 v163, v163, v161
    v_cvt_pk_bf16_f32 v147, v162, v163
    v_lshlrev_b32 v162, 16, v148
    v_and_b32 v163, 0xffff0000, v148
    v_mul_f32 v162, v162, v161
    v_mul_f32 v163, v163, v161
    v_cvt_pk_bf16_f32 v148, v162, v163
    v_lshlrev_b32 v162, 16, v149
    v_and_b32 v163, 0xffff0000, v149
    v_mul_f32 v162, v162, v161
    v_mul_f32 v163, v163, v161
    v_cvt_pk_bf16_f32 v149, v162, v163
    v_lshlrev_b32 v162, 16, v150
    v_and_b32 v163, 0xffff0000, v150
    v_mul_f32 v162, v162, v161
    v_mul_f32 v163, v163, v161
    v_cvt_pk_bf16_f32 v150, v162, v163
    v_lshlrev_b32 v162, 16, v151
    v_and_b32 v163, 0xffff0000, v151
    v_mul_f32 v162, v162, v161
    v_mul_f32 v163, v163, v161
    v_cvt_pk_bf16_f32 v151, v162, v163
    s_nop 1
    s_branch attn_kernel_back32
attn_kernel_resc33:
    v_mov_b32 v161, v160
    s_nop 1
    v_permlane32_swap_b32 v160, v161
    v_max_f32 v160, v160, v161
    v_max_f32 v160, 0, v160
    v_ceil_f32 v160, v160
    s_nop 15
    s_nop 15
    v_cvt_i32_f32 v162, v160
    v_sub_u32 v162, 0, v162
    v_ldexp_f32 v161, 1.0, v162
    v_sub_f32 v32, v32, v160
    v_sub_f32 v64, v64, v160
    v_sub_f32 v48, v48, v160
    v_mul_f32 v80, v80, v161
    v_mul_f32 v96, v96, v161
    v_sub_f32 v33, v33, v160
    v_sub_f32 v65, v65, v160
    v_sub_f32 v49, v49, v160
    v_mul_f32 v81, v81, v161
    v_mul_f32 v97, v97, v161
    v_sub_f32 v34, v34, v160
    v_sub_f32 v66, v66, v160
    v_sub_f32 v50, v50, v160
    v_mul_f32 v82, v82, v161
    v_mul_f32 v98, v98, v161
    v_sub_f32 v35, v35, v160
    v_sub_f32 v67, v67, v160
    v_sub_f32 v51, v51, v160
    v_mul_f32 v83, v83, v161
    v_mul_f32 v99, v99, v161
    v_sub_f32 v36, v36, v160
    v_sub_f32 v68, v68, v160
    v_sub_f32 v52, v52, v160
    v_mul_f32 v84, v84, v161
    v_mul_f32 v100, v100, v161
    v_sub_f32 v37, v37, v160
    v_sub_f32 v69, v69, v160
    v_sub_f32 v53, v53, v160
    v_mul_f32 v85, v85, v161
    v_mul_f32 v101, v101, v161
    v_sub_f32 v38, v38, v160
    v_sub_f32 v70, v70, v160
    v_sub_f32 v54, v54, v160
    v_mul_f32 v86, v86, v161
    v_mul_f32 v102, v102, v161
    v_sub_f32 v39, v39, v160
    v_sub_f32 v71, v71, v160
    v_sub_f32 v55, v55, v160
    v_mul_f32 v87, v87, v161
    v_mul_f32 v103, v103, v161
    v_sub_f32 v40, v40, v160
    v_sub_f32 v72, v72, v160
    v_sub_f32 v56, v56, v160
    v_mul_f32 v88, v88, v161
    v_mul_f32 v104, v104, v161
    v_sub_f32 v41, v41, v160
    v_sub_f32 v73, v73, v160
    v_sub_f32 v57, v57, v160
    v_mul_f32 v89, v89, v161
    v_mul_f32 v105, v105, v161
    v_sub_f32 v42, v42, v160
    v_sub_f32 v74, v74, v160
    v_sub_f32 v58, v58, v160
    v_mul_f32 v90, v90, v161
    v_mul_f32 v106, v106, v161
    v_sub_f32 v43, v43, v160
    v_sub_f32 v75, v75, v160
    v_sub_f32 v59, v59, v160
    v_mul_f32 v91, v91, v161
    v_mul_f32 v107, v107, v161
    v_sub_f32 v44, v44, v160
    v_sub_f32 v76, v76, v160
    v_sub_f32 v60, v60, v160
    v_mul_f32 v92, v92, v161
    v_mul_f32 v108, v108, v161
    v_sub_f32 v45, v45, v160
    v_sub_f32 v77, v77, v160
    v_sub_f32 v61, v61, v160
    v_mul_f32 v93, v93, v161
    v_mul_f32 v109, v109, v161
    v_sub_f32 v46, v46, v160
    v_sub_f32 v78, v78, v160
    v_sub_f32 v62, v62, v160
    v_mul_f32 v94, v94, v161
    v_mul_f32 v110, v110, v161
    v_sub_f32 v47, v47, v160
    v_sub_f32 v79, v79, v160
    v_sub_f32 v63, v63, v160
    v_mul_f32 v95, v95, v161
    v_mul_f32 v111, v111, v161
    v_lshlrev_b32 v162, 16, v152
    v_and_b32 v163, 0xffff0000, v152
    v_mul_f32 v162, v162, v161
    v_mul_f32 v163, v163, v161
    v_cvt_pk_bf16_f32 v152, v162, v163
    v_lshlrev_b32 v162, 16, v153
    v_and_b32 v163, 0xffff0000, v153
    v_mul_f32 v162, v162, v161
    v_mul_f32 v163, v163, v161
    v_cvt_pk_bf16_f32 v153, v162, v163
    v_lshlrev_b32 v162, 16, v154
    v_and_b32 v163, 0xffff0000, v154
    v_mul_f32 v162, v162, v161
    v_mul_f32 v163, v163, v161
    v_cvt_pk_bf16_f32 v154, v162, v163
    v_lshlrev_b32 v162, 16, v155
    v_and_b32 v163, 0xffff0000, v155
    v_mul_f32 v162, v162, v161
    v_mul_f32 v163, v163, v161
    v_cvt_pk_bf16_f32 v155, v162, v163
    v_lshlrev_b32 v162, 16, v156
    v_and_b32 v163, 0xffff0000, v156
    v_mul_f32 v162, v162, v161
    v_mul_f32 v163, v163, v161
    v_cvt_pk_bf16_f32 v156, v162, v163
    v_lshlrev_b32 v162, 16, v157
    v_and_b32 v163, 0xffff0000, v157
    v_mul_f32 v162, v162, v161
    v_mul_f32 v163, v163, v161
    v_cvt_pk_bf16_f32 v157, v162, v163
    v_lshlrev_b32 v162, 16, v158
    v_and_b32 v163, 0xffff0000, v158
    v_mul_f32 v162, v162, v161
    v_mul_f32 v163, v163, v161
    v_cvt_pk_bf16_f32 v158, v162, v163
    v_lshlrev_b32 v162, 16, v159
    v_and_b32 v163, 0xffff0000, v159
    v_mul_f32 v162, v162, v161
    v_mul_f32 v163, v163, v161
    v_cvt_pk_bf16_f32 v159, v162, v163
    s_nop 1
    s_branch attn_kernel_back34
attn_kernel_resc35:
    v_mov_b32 v161, v160
    s_nop 1
    v_permlane32_swap_b32 v160, v161
    v_max_f32 v160, v160, v161
    v_max_f32 v160, 0, v160
    v_ceil_f32 v160, v160
    s_nop 15
    s_nop 15
    v_cvt_i32_f32 v162, v160
    v_sub_u32 v162, 0, v162
    v_ldexp_f32 v161, 1.0, v162
    v_sub_f32 v48, v48, v160
    v_sub_f32 v64, v64, v160
    v_sub_f32 v32, v32, v160
    v_mul_f32 v80, v80, v161
    v_mul_f32 v96, v96, v161
    v_sub_f32 v49, v49, v160
    v_sub_f32 v65, v65, v160
    v_sub_f32 v33, v33, v160
    v_mul_f32 v81, v81, v161
    v_mul_f32 v97, v97, v161
    v_sub_f32 v50, v50, v160
    v_sub_f32 v66, v66, v160
    v_sub_f32 v34, v34, v160
    v_mul_f32 v82, v82, v161
    v_mul_f32 v98, v98, v161
    v_sub_f32 v51, v51, v160
    v_sub_f32 v67, v67, v160
    v_sub_f32 v35, v35, v160
    v_mul_f32 v83, v83, v161
    v_mul_f32 v99, v99, v161
    v_sub_f32 v52, v52, v160
    v_sub_f32 v68, v68, v160
    v_sub_f32 v36, v36, v160
    v_mul_f32 v84, v84, v161
    v_mul_f32 v100, v100, v161
    v_sub_f32 v53, v53, v160
    v_sub_f32 v69, v69, v160
    v_sub_f32 v37, v37, v160
    v_mul_f32 v85, v85, v161
    v_mul_f32 v101, v101, v161
    v_sub_f32 v54, v54, v160
    v_sub_f32 v70, v70, v160
    v_sub_f32 v38, v38, v160
    v_mul_f32 v86, v86, v161
    v_mul_f32 v102, v102, v161
    v_sub_f32 v55, v55, v160
    v_sub_f32 v71, v71, v160
    v_sub_f32 v39, v39, v160
    v_mul_f32 v87, v87, v161
    v_mul_f32 v103, v103, v161
    v_sub_f32 v56, v56, v160
    v_sub_f32 v72, v72, v160
    v_sub_f32 v40, v40, v160
    v_mul_f32 v88, v88, v161
    v_mul_f32 v104, v104, v161
    v_sub_f32 v57, v57, v160
    v_sub_f32 v73, v73, v160
    v_sub_f32 v41, v41, v160
    v_mul_f32 v89, v89, v161
    v_mul_f32 v105, v105, v161
    v_sub_f32 v58, v58, v160
    v_sub_f32 v74, v74, v160
    v_sub_f32 v42, v42, v160
    v_mul_f32 v90, v90, v161
    v_mul_f32 v106, v106, v161
    v_sub_f32 v59, v59, v160
    v_sub_f32 v75, v75, v160
    v_sub_f32 v43, v43, v160
    v_mul_f32 v91, v91, v161
    v_mul_f32 v107, v107, v161
    v_sub_f32 v60, v60, v160
    v_sub_f32 v76, v76, v160
    v_sub_f32 v44, v44, v160
    v_mul_f32 v92, v92, v161
    v_mul_f32 v108, v108, v161
    v_sub_f32 v61, v61, v160
    v_sub_f32 v77, v77, v160
    v_sub_f32 v45, v45, v160
    v_mul_f32 v93, v93, v161
    v_mul_f32 v109, v109, v161
    v_sub_f32 v62, v62, v160
    v_sub_f32 v78, v78, v160
    v_sub_f32 v46, v46, v160
    v_mul_f32 v94, v94, v161
    v_mul_f32 v110, v110, v161
    v_sub_f32 v63, v63, v160
    v_sub_f32 v79, v79, v160
    v_sub_f32 v47, v47, v160
    v_mul_f32 v95, v95, v161
    v_mul_f32 v111, v111, v161
    v_lshlrev_b32 v162, 16, v144
    v_and_b32 v163, 0xffff0000, v144
    v_mul_f32 v162, v162, v161
    v_mul_f32 v163, v163, v161
    v_cvt_pk_bf16_f32 v144, v162, v163
    v_lshlrev_b32 v162, 16, v145
    v_and_b32 v163, 0xffff0000, v145
    v_mul_f32 v162, v162, v161
    v_mul_f32 v163, v163, v161
    v_cvt_pk_bf16_f32 v145, v162, v163
    v_lshlrev_b32 v162, 16, v146
    v_and_b32 v163, 0xffff0000, v146
    v_mul_f32 v162, v162, v161
    v_mul_f32 v163, v163, v161
    v_cvt_pk_bf16_f32 v146, v162, v163
    v_lshlrev_b32 v162, 16, v147
    v_and_b32 v163, 0xffff0000, v147
    v_mul_f32 v162, v162, v161
    v_mul_f32 v163, v163, v161
    v_cvt_pk_bf16_f32 v147, v162, v163
    v_lshlrev_b32 v162, 16, v148
    v_and_b32 v163, 0xffff0000, v148
    v_mul_f32 v162, v162, v161
    v_mul_f32 v163, v163, v161
    v_cvt_pk_bf16_f32 v148, v162, v163
    v_lshlrev_b32 v162, 16, v149
    v_and_b32 v163, 0xffff0000, v149
    v_mul_f32 v162, v162, v161
    v_mul_f32 v163, v163, v161
    v_cvt_pk_bf16_f32 v149, v162, v163
    v_lshlrev_b32 v162, 16, v150
    v_and_b32 v163, 0xffff0000, v150
    v_mul_f32 v162, v162, v161
    v_mul_f32 v163, v163, v161
    v_cvt_pk_bf16_f32 v150, v162, v163
    v_lshlrev_b32 v162, 16, v151
    v_and_b32 v163, 0xffff0000, v151
    v_mul_f32 v162, v162, v161
    v_mul_f32 v163, v163, v161
    v_cvt_pk_bf16_f32 v151, v162, v163
    s_nop 1
    s_branch attn_kernel_back36
attn_kernel_resc37:
    v_mov_b32 v161, v160
    s_nop 1
    v_permlane32_swap_b32 v160, v161
    v_max_f32 v160, v160, v161
    v_max_f32 v160, 0, v160
    v_ceil_f32 v160, v160
    s_nop 15
    s_nop 15
    v_cvt_i32_f32 v162, v160
    v_sub_u32 v162, 0, v162
    v_ldexp_f32 v161, 1.0, v162
    v_sub_f32 v32, v32, v160
    v_sub_f32 v64, v64, v160
    v_sub_f32 v48, v48, v160
    v_mul_f32 v80, v80, v161
    v_mul_f32 v96, v96, v161
    v_sub_f32 v33, v33, v160
    v_sub_f32 v65, v65, v160
    v_sub_f32 v49, v49, v160
    v_mul_f32 v81, v81, v161
    v_mul_f32 v97, v97, v161
    v_sub_f32 v34, v34, v160
    v_sub_f32 v66, v66, v160
    v_sub_f32 v50, v50, v160
    v_mul_f32 v82, v82, v161
    v_mul_f32 v98, v98, v161
    v_sub_f32 v35, v35, v160
    v_sub_f32 v67, v67, v160
    v_sub_f32 v51, v51, v160
    v_mul_f32 v83, v83, v161
    v_mul_f32 v99, v99, v161
    v_sub_f32 v36, v36, v160
    v_sub_f32 v68, v68, v160
    v_sub_f32 v52, v52, v160
    v_mul_f32 v84, v84, v161
    v_mul_f32 v100, v100, v161
    v_sub_f32 v37, v37, v160
    v_sub_f32 v69, v69, v160
    v_sub_f32 v53, v53, v160
    v_mul_f32 v85, v85, v161
    v_mul_f32 v101, v101, v161
    v_sub_f32 v38, v38, v160
    v_sub_f32 v70, v70, v160
    v_sub_f32 v54, v54, v160
    v_mul_f32 v86, v86, v161
    v_mul_f32 v102, v102, v161
    v_sub_f32 v39, v39, v160
    v_sub_f32 v71, v71, v160
    v_sub_f32 v55, v55, v160
    v_mul_f32 v87, v87, v161
    v_mul_f32 v103, v103, v161
    v_sub_f32 v40, v40, v160
    v_sub_f32 v72, v72, v160
    v_sub_f32 v56, v56, v160
    v_mul_f32 v88, v88, v161
    v_mul_f32 v104, v104, v161
    v_sub_f32 v41, v41, v160
    v_sub_f32 v73, v73, v160
    v_sub_f32 v57, v57, v160
    v_mul_f32 v89, v89, v161
    v_mul_f32 v105, v105, v161
    v_sub_f32 v42, v42, v160
    v_sub_f32 v74, v74, v160
    v_sub_f32 v58, v58, v160
    v_mul_f32 v90, v90, v161
    v_mul_f32 v106, v106, v161
    v_sub_f32 v43, v43, v160
    v_sub_f32 v75, v75, v160
    v_sub_f32 v59, v59, v160
    v_mul_f32 v91, v91, v161
    v_mul_f32 v107, v107, v161
    v_sub_f32 v44, v44, v160
    v_sub_f32 v76, v76, v160
    v_sub_f32 v60, v60, v160
    v_mul_f32 v92, v92, v161
    v_mul_f32 v108, v108, v161
    v_sub_f32 v45, v45, v160
    v_sub_f32 v77, v77, v160
    v_sub_f32 v61, v61, v160
    v_mul_f32 v93, v93, v161
    v_mul_f32 v109, v109, v161
    v_sub_f32 v46, v46, v160
    v_sub_f32 v78, v78, v160
    v_sub_f32 v62, v62, v160
    v_mul_f32 v94, v94, v161
    v_mul_f32 v110, v110, v161
    v_sub_f32 v47, v47, v160
    v_sub_f32 v79, v79, v160
    v_sub_f32 v63, v63, v160
    v_mul_f32 v95, v95, v161
    v_mul_f32 v111, v111, v161
    v_lshlrev_b32 v162, 16, v152
    v_and_b32 v163, 0xffff0000, v152
    v_mul_f32 v162, v162, v161
    v_mul_f32 v163, v163, v161
    v_cvt_pk_bf16_f32 v152, v162, v163
    v_lshlrev_b32 v162, 16, v153
    v_and_b32 v163, 0xffff0000, v153
    v_mul_f32 v162, v162, v161
    v_mul_f32 v163, v163, v161
    v_cvt_pk_bf16_f32 v153, v162, v163
    v_lshlrev_b32 v162, 16, v154
    v_and_b32 v163, 0xffff0000, v154
    v_mul_f32 v162, v162, v161
    v_mul_f32 v163, v163, v161
    v_cvt_pk_bf16_f32 v154, v162, v163
    v_lshlrev_b32 v162, 16, v155
    v_and_b32 v163, 0xffff0000, v155
    v_mul_f32 v162, v162, v161
    v_mul_f32 v163, v163, v161
    v_cvt_pk_bf16_f32 v155, v162, v163
    v_lshlrev_b32 v162, 16, v156
    v_and_b32 v163, 0xffff0000, v156
    v_mul_f32 v162, v162, v161
    v_mul_f32 v163, v163, v161
    v_cvt_pk_bf16_f32 v156, v162, v163
    v_lshlrev_b32 v162, 16, v157
    v_and_b32 v163, 0xffff0000, v157
    v_mul_f32 v162, v162, v161
    v_mul_f32 v163, v163, v161
    v_cvt_pk_bf16_f32 v157, v162, v163
    v_lshlrev_b32 v162, 16, v158
    v_and_b32 v163, 0xffff0000, v158
    v_mul_f32 v162, v162, v161
    v_mul_f32 v163, v163, v161
    v_cvt_pk_bf16_f32 v158, v162, v163
    v_lshlrev_b32 v162, 16, v159
    v_and_b32 v163, 0xffff0000, v159
    v_mul_f32 v162, v162, v161
    v_mul_f32 v163, v163, v161
    v_cvt_pk_bf16_f32 v159, v162, v163
    s_nop 1
    s_branch attn_kernel_back38
attn_kernel_resc39:
    v_mov_b32 v161, v160
    s_nop 1
    v_permlane32_swap_b32 v160, v161
    v_max_f32 v160, v160, v161
    v_max_f32 v160, 0, v160
    v_ceil_f32 v160, v160
    s_nop 15
    s_nop 15
    v_cvt_i32_f32 v162, v160
    v_sub_u32 v162, 0, v162
    v_ldexp_f32 v161, 1.0, v162
    v_sub_f32 v48, v48, v160
    v_sub_f32 v64, v64, v160
    v_sub_f32 v32, v32, v160
    v_mul_f32 v80, v80, v161
    v_mul_f32 v96, v96, v161
    v_sub_f32 v49, v49, v160
    v_sub_f32 v65, v65, v160
    v_sub_f32 v33, v33, v160
    v_mul_f32 v81, v81, v161
    v_mul_f32 v97, v97, v161
    v_sub_f32 v50, v50, v160
    v_sub_f32 v66, v66, v160
    v_sub_f32 v34, v34, v160
    v_mul_f32 v82, v82, v161
    v_mul_f32 v98, v98, v161
    v_sub_f32 v51, v51, v160
    v_sub_f32 v67, v67, v160
    v_sub_f32 v35, v35, v160
    v_mul_f32 v83, v83, v161
    v_mul_f32 v99, v99, v161
    v_sub_f32 v52, v52, v160
    v_sub_f32 v68, v68, v160
    v_sub_f32 v36, v36, v160
    v_mul_f32 v84, v84, v161
    v_mul_f32 v100, v100, v161
    v_sub_f32 v53, v53, v160
    v_sub_f32 v69, v69, v160
    v_sub_f32 v37, v37, v160
    v_mul_f32 v85, v85, v161
    v_mul_f32 v101, v101, v161
    v_sub_f32 v54, v54, v160
    v_sub_f32 v70, v70, v160
    v_sub_f32 v38, v38, v160
    v_mul_f32 v86, v86, v161
    v_mul_f32 v102, v102, v161
    v_sub_f32 v55, v55, v160
    v_sub_f32 v71, v71, v160
    v_sub_f32 v39, v39, v160
    v_mul_f32 v87, v87, v161
    v_mul_f32 v103, v103, v161
    v_sub_f32 v56, v56, v160
    v_sub_f32 v72, v72, v160
    v_sub_f32 v40, v40, v160
    v_mul_f32 v88, v88, v161
    v_mul_f32 v104, v104, v161
    v_sub_f32 v57, v57, v160
    v_sub_f32 v73, v73, v160
    v_sub_f32 v41, v41, v160
    v_mul_f32 v89, v89, v161
    v_mul_f32 v105, v105, v161
    v_sub_f32 v58, v58, v160
    v_sub_f32 v74, v74, v160
    v_sub_f32 v42, v42, v160
    v_mul_f32 v90, v90, v161
    v_mul_f32 v106, v106, v161
    v_sub_f32 v59, v59, v160
    v_sub_f32 v75, v75, v160
    v_sub_f32 v43, v43, v160
    v_mul_f32 v91, v91, v161
    v_mul_f32 v107, v107, v161
    v_sub_f32 v60, v60, v160
    v_sub_f32 v76, v76, v160
    v_sub_f32 v44, v44, v160
    v_mul_f32 v92, v92, v161
    v_mul_f32 v108, v108, v161
    v_sub_f32 v61, v61, v160
    v_sub_f32 v77, v77, v160
    v_sub_f32 v45, v45, v160
    v_mul_f32 v93, v93, v161
    v_mul_f32 v109, v109, v161
    v_sub_f32 v62, v62, v160
    v_sub_f32 v78, v78, v160
    v_sub_f32 v46, v46, v160
    v_mul_f32 v94, v94, v161
    v_mul_f32 v110, v110, v161
    v_sub_f32 v63, v63, v160
    v_sub_f32 v79, v79, v160
    v_sub_f32 v47, v47, v160
    v_mul_f32 v95, v95, v161
    v_mul_f32 v111, v111, v161
    v_lshlrev_b32 v162, 16, v144
    v_and_b32 v163, 0xffff0000, v144
    v_mul_f32 v162, v162, v161
    v_mul_f32 v163, v163, v161
    v_cvt_pk_bf16_f32 v144, v162, v163
    v_lshlrev_b32 v162, 16, v145
    v_and_b32 v163, 0xffff0000, v145
    v_mul_f32 v162, v162, v161
    v_mul_f32 v163, v163, v161
    v_cvt_pk_bf16_f32 v145, v162, v163
    v_lshlrev_b32 v162, 16, v146
    v_and_b32 v163, 0xffff0000, v146
    v_mul_f32 v162, v162, v161
    v_mul_f32 v163, v163, v161
    v_cvt_pk_bf16_f32 v146, v162, v163
    v_lshlrev_b32 v162, 16, v147
    v_and_b32 v163, 0xffff0000, v147
    v_mul_f32 v162, v162, v161
    v_mul_f32 v163, v163, v161
    v_cvt_pk_bf16_f32 v147, v162, v163
    v_lshlrev_b32 v162, 16, v148
    v_and_b32 v163, 0xffff0000, v148
    v_mul_f32 v162, v162, v161
    v_mul_f32 v163, v163, v161
    v_cvt_pk_bf16_f32 v148, v162, v163
    v_lshlrev_b32 v162, 16, v149
    v_and_b32 v163, 0xffff0000, v149
    v_mul_f32 v162, v162, v161
    v_mul_f32 v163, v163, v161
    v_cvt_pk_bf16_f32 v149, v162, v163
    v_lshlrev_b32 v162, 16, v150
    v_and_b32 v163, 0xffff0000, v150
    v_mul_f32 v162, v162, v161
    v_mul_f32 v163, v163, v161
    v_cvt_pk_bf16_f32 v150, v162, v163
    v_lshlrev_b32 v162, 16, v151
    v_and_b32 v163, 0xffff0000, v151
    v_mul_f32 v162, v162, v161
    v_mul_f32 v163, v163, v161
    v_cvt_pk_bf16_f32 v151, v162, v163
    s_nop 1
    s_branch attn_kernel_back40
attn_kernel_fresc1:
    v_frexp_exp_i32_f32 v162, v164
    v_max_i32 v162, 0, v162
    s_nop 15
    s_nop 15
    v_cvt_f32_i32 v160, v162
    v_sub_u32 v162, 0, v162
    v_ldexp_f32 v161, 1.0, v162
    v_sub_f32 v32, v32, v160
    v_sub_f32 v64, v64, v160
    v_mul_f32 v80, v80, v161
    v_mul_f32 v96, v96, v161
    v_sub_f32 v33, v33, v160
    v_sub_f32 v65, v65, v160
    v_mul_f32 v81, v81, v161
    v_mul_f32 v97, v97, v161
    v_sub_f32 v34, v34, v160
    v_sub_f32 v66, v66, v160
    v_mul_f32 v82, v82, v161
    v_mul_f32 v98, v98, v161
    v_sub_f32 v35, v35, v160
    v_sub_f32 v67, v67, v160
    v_mul_f32 v83, v83, v161
    v_mul_f32 v99, v99, v161
    v_sub_f32 v36, v36, v160
    v_sub_f32 v68, v68, v160
    v_mul_f32 v84, v84, v161
    v_mul_f32 v100, v100, v161
    v_sub_f32 v37, v37, v160
    v_sub_f32 v69, v69, v160
    v_mul_f32 v85, v85, v161
    v_mul_f32 v101, v101, v161
    v_sub_f32 v38, v38, v160
    v_sub_f32 v70, v70, v160
    v_mul_f32 v86, v86, v161
    v_mul_f32 v102, v102, v161
    v_sub_f32 v39, v39, v160
    v_sub_f32 v71, v71, v160
    v_mul_f32 v87, v87, v161
    v_mul_f32 v103, v103, v161
    v_sub_f32 v40, v40, v160
    v_sub_f32 v72, v72, v160
    v_mul_f32 v88, v88, v161
    v_mul_f32 v104, v104, v161
    v_sub_f32 v41, v41, v160
    v_sub_f32 v73, v73, v160
    v_mul_f32 v89, v89, v161
    v_mul_f32 v105, v105, v161
    v_sub_f32 v42, v42, v160
    v_sub_f32 v74, v74, v160
    v_mul_f32 v90, v90, v161
    v_mul_f32 v106, v106, v161
    v_sub_f32 v43, v43, v160
    v_sub_f32 v75, v75, v160
    v_mul_f32 v91, v91, v161
    v_mul_f32 v107, v107, v161
    v_sub_f32 v44, v44, v160
    v_sub_f32 v76, v76, v160
    v_mul_f32 v92, v92, v161
    v_mul_f32 v108, v108, v161
    v_sub_f32 v45, v45, v160
    v_sub_f32 v77, v77, v160
    v_mul_f32 v93, v93, v161
    v_mul_f32 v109, v109, v161
    v_sub_f32 v46, v46, v160
    v_sub_f32 v78, v78, v160
    v_mul_f32 v94, v94, v161
    v_mul_f32 v110, v110, v161
    v_sub_f32 v47, v47, v160
    v_sub_f32 v79, v79, v160
    v_mul_f32 v95, v95, v161
    v_mul_f32 v111, v111, v161
    v_lshlrev_b32 v162, 16, v152
    v_and_b32 v163, 0xffff0000, v152
    v_mul_f32 v162, v162, v161
    v_mul_f32 v163, v163, v161
    v_cvt_pk_bf16_f32 v152, v162, v163
    v_lshlrev_b32 v162, 16, v153
    v_and_b32 v163, 0xffff0000, v153
    v_mul_f32 v162, v162, v161
    v_mul_f32 v163, v163, v161
    v_cvt_pk_bf16_f32 v153, v162, v163
    v_lshlrev_b32 v162, 16, v154
    v_and_b32 v163, 0xffff0000, v154
    v_mul_f32 v162, v162, v161
    v_mul_f32 v163, v163, v161
    v_cvt_pk_bf16_f32 v154, v162, v163
    v_lshlrev_b32 v162, 16, v155
    v_and_b32 v163, 0xffff0000, v155
    v_mul_f32 v162, v162, v161
    v_mul_f32 v163, v163, v161
    v_cvt_pk_bf16_f32 v155, v162, v163
    v_lshlrev_b32 v162, 16, v156
    v_and_b32 v163, 0xffff0000, v156
    v_mul_f32 v162, v162, v161
    v_mul_f32 v163, v163, v161
    v_cvt_pk_bf16_f32 v156, v162, v163
    v_lshlrev_b32 v162, 16, v157
    v_and_b32 v163, 0xffff0000, v157
    v_mul_f32 v162, v162, v161
    v_mul_f32 v163, v163, v161
    v_cvt_pk_bf16_f32 v157, v162, v163
    v_lshlrev_b32 v162, 16, v158
    v_and_b32 v163, 0xffff0000, v158
    v_mul_f32 v162, v162, v161
    v_mul_f32 v163, v163, v161
    v_cvt_pk_bf16_f32 v158, v162, v163
    v_lshlrev_b32 v162, 16, v159
    v_and_b32 v163, 0xffff0000, v159
    v_mul_f32 v162, v162, v161
    v_mul_f32 v163, v163, v161
    v_cvt_pk_bf16_f32 v159, v162, v163
    v_mov_b32 v164, 0
    s_nop 1
    s_branch attn_kernel_fback2
attn_kernel_fresc3:
    v_frexp_exp_i32_f32 v162, v164
    v_max_i32 v162, 0, v162
    s_nop 15
    s_nop 15
    v_cvt_f32_i32 v160, v162
    v_sub_u32 v162, 0, v162
    v_ldexp_f32 v161, 1.0, v162
    v_sub_f32 v32, v32, v160
    v_sub_f32 v64, v64, v160
    v_mul_f32 v80, v80, v161
    v_mul_f32 v96, v96, v161
    v_sub_f32 v33, v33, v160
    v_sub_f32 v65, v65, v160
    v_mul_f32 v81, v81, v161
    v_mul_f32 v97, v97, v161
    v_sub_f32 v34, v34, v160
    v_sub_f32 v66, v66, v160
    v_mul_f32 v82, v82, v161
    v_mul_f32 v98, v98, v161
    v_sub_f32 v35, v35, v160
    v_sub_f32 v67, v67, v160
    v_mul_f32 v83, v83, v161
    v_mul_f32 v99, v99, v161
    v_sub_f32 v36, v36, v160
    v_sub_f32 v68, v68, v160
    v_mul_f32 v84, v84, v161
    v_mul_f32 v100, v100, v161
    v_sub_f32 v37, v37, v160
    v_sub_f32 v69, v69, v160
    v_mul_f32 v85, v85, v161
    v_mul_f32 v101, v101, v161
    v_sub_f32 v38, v38, v160
    v_sub_f32 v70, v70, v160
    v_mul_f32 v86, v86, v161
    v_mul_f32 v102, v102, v161
    v_sub_f32 v39, v39, v160
    v_sub_f32 v71, v71, v160
    v_mul_f32 v87, v87, v161
    v_mul_f32 v103, v103, v161
    v_sub_f32 v40, v40, v160
    v_sub_f32 v72, v72, v160
    v_mul_f32 v88, v88, v161
    v_mul_f32 v104, v104, v161
    v_sub_f32 v41, v41, v160
    v_sub_f32 v73, v73, v160
    v_mul_f32 v89, v89, v161
    v_mul_f32 v105, v105, v161
    v_sub_f32 v42, v42, v160
    v_sub_f32 v74, v74, v160
    v_mul_f32 v90, v90, v161
    v_mul_f32 v106, v106, v161
    v_sub_f32 v43, v43, v160
    v_sub_f32 v75, v75, v160
    v_mul_f32 v91, v91, v161
    v_mul_f32 v107, v107, v161
    v_sub_f32 v44, v44, v160
    v_sub_f32 v76, v76, v160
    v_mul_f32 v92, v92, v161
    v_mul_f32 v108, v108, v161
    v_sub_f32 v45, v45, v160
    v_sub_f32 v77, v77, v160
    v_mul_f32 v93, v93, v161
    v_mul_f32 v109, v109, v161
    v_sub_f32 v46, v46, v160
    v_sub_f32 v78, v78, v160
    v_mul_f32 v94, v94, v161
    v_mul_f32 v110, v110, v161
    v_sub_f32 v47, v47, v160
    v_sub_f32 v79, v79, v160
    v_mul_f32 v95, v95, v161
    v_mul_f32 v111, v111, v161
    v_lshlrev_b32 v162, 16, v152
    v_and_b32 v163, 0xffff0000, v152
    v_mul_f32 v162, v162, v161
    v_mul_f32 v163, v163, v161
    v_cvt_pk_bf16_f32 v152, v162, v163
    v_lshlrev_b32 v162, 16, v153
    v_and_b32 v163, 0xffff0000, v153
    v_mul_f32 v162, v162, v161
    v_mul_f32 v163, v163, v161
    v_cvt_pk_bf16_f32 v153, v162, v163
    v_lshlrev_b32 v162, 16, v154
    v_and_b32 v163, 0xffff0000, v154
    v_mul_f32 v162, v162, v161
    v_mul_f32 v163, v163, v161
    v_cvt_pk_bf16_f32 v154, v162, v163
    v_lshlrev_b32 v162, 16, v155
    v_and_b32 v163, 0xffff0000, v155
    v_mul_f32 v162, v162, v161
    v_mul_f32 v163, v163, v161
    v_cvt_pk_bf16_f32 v155, v162, v163
    v_lshlrev_b32 v162, 16, v156
    v_and_b32 v163, 0xffff0000, v156
    v_mul_f32 v162, v162, v161
    v_mul_f32 v163, v163, v161
    v_cvt_pk_bf16_f32 v156, v162, v163
    v_lshlrev_b32 v162, 16, v157
    v_and_b32 v163, 0xffff0000, v157
    v_mul_f32 v162, v162, v161
    v_mul_f32 v163, v163, v161
    v_cvt_pk_bf16_f32 v157, v162, v163
    v_lshlrev_b32 v162, 16, v158
    v_and_b32 v163, 0xffff0000, v158
    v_mul_f32 v162, v162, v161
    v_mul_f32 v163, v163, v161
    v_cvt_pk_bf16_f32 v158, v162, v163
    v_lshlrev_b32 v162, 16, v159
    v_and_b32 v163, 0xffff0000, v159
    v_mul_f32 v162, v162, v161
    v_mul_f32 v163, v163, v161
    v_cvt_pk_bf16_f32 v159, v162, v163
    v_mov_b32 v164, 0
    s_nop 1
    s_branch attn_kernel_fback4
attn_kernel_fresc5:
    v_frexp_exp_i32_f32 v162, v164
    v_max_i32 v162, 0, v162
    s_nop 15
    s_nop 15
    v_cvt_f32_i32 v160, v162
    v_sub_u32 v162, 0, v162
    v_ldexp_f32 v161, 1.0, v162
    v_sub_f32 v32, v32, v160
    v_sub_f32 v64, v64, v160
    v_mul_f32 v80, v80, v161
    v_mul_f32 v96, v96, v161
    v_sub_f32 v33, v33, v160
    v_sub_f32 v65, v65, v160
    v_mul_f32 v81, v81, v161
    v_mul_f32 v97, v97, v161
    v_sub_f32 v34, v34, v160
    v_sub_f32 v66, v66, v160
    v_mul_f32 v82, v82, v161
    v_mul_f32 v98, v98, v161
    v_sub_f32 v35, v35, v160
    v_sub_f32 v67, v67, v160
    v_mul_f32 v83, v83, v161
    v_mul_f32 v99, v99, v161
    v_sub_f32 v36, v36, v160
    v_sub_f32 v68, v68, v160
    v_mul_f32 v84, v84, v161
    v_mul_f32 v100, v100, v161
    v_sub_f32 v37, v37, v160
    v_sub_f32 v69, v69, v160
    v_mul_f32 v85, v85, v161
    v_mul_f32 v101, v101, v161
    v_sub_f32 v38, v38, v160
    v_sub_f32 v70, v70, v160
    v_mul_f32 v86, v86, v161
    v_mul_f32 v102, v102, v161
    v_sub_f32 v39, v39, v160
    v_sub_f32 v71, v71, v160
    v_mul_f32 v87, v87, v161
    v_mul_f32 v103, v103, v161
    v_sub_f32 v40, v40, v160
    v_sub_f32 v72, v72, v160
    v_mul_f32 v88, v88, v161
    v_mul_f32 v104, v104, v161
    v_sub_f32 v41, v41, v160
    v_sub_f32 v73, v73, v160
    v_mul_f32 v89, v89, v161
    v_mul_f32 v105, v105, v161
    v_sub_f32 v42, v42, v160
    v_sub_f32 v74, v74, v160
    v_mul_f32 v90, v90, v161
    v_mul_f32 v106, v106, v161
    v_sub_f32 v43, v43, v160
    v_sub_f32 v75, v75, v160
    v_mul_f32 v91, v91, v161
    v_mul_f32 v107, v107, v161
    v_sub_f32 v44, v44, v160
    v_sub_f32 v76, v76, v160
    v_mul_f32 v92, v92, v161
    v_mul_f32 v108, v108, v161
    v_sub_f32 v45, v45, v160
    v_sub_f32 v77, v77, v160
    v_mul_f32 v93, v93, v161
    v_mul_f32 v109, v109, v161
    v_sub_f32 v46, v46, v160
    v_sub_f32 v78, v78, v160
    v_mul_f32 v94, v94, v161
    v_mul_f32 v110, v110, v161
    v_sub_f32 v47, v47, v160
    v_sub_f32 v79, v79, v160
    v_mul_f32 v95, v95, v161
    v_mul_f32 v111, v111, v161
    v_lshlrev_b32 v162, 16, v152
    v_and_b32 v163, 0xffff0000, v152
    v_mul_f32 v162, v162, v161
    v_mul_f32 v163, v163, v161
    v_cvt_pk_bf16_f32 v152, v162, v163
    v_lshlrev_b32 v162, 16, v153
    v_and_b32 v163, 0xffff0000, v153
    v_mul_f32 v162, v162, v161
    v_mul_f32 v163, v163, v161
    v_cvt_pk_bf16_f32 v153, v162, v163
    v_lshlrev_b32 v162, 16, v154
    v_and_b32 v163, 0xffff0000, v154
    v_mul_f32 v162, v162, v161
    v_mul_f32 v163, v163, v161
    v_cvt_pk_bf16_f32 v154, v162, v163
    v_lshlrev_b32 v162, 16, v155
    v_and_b32 v163, 0xffff0000, v155
    v_mul_f32 v162, v162, v161
    v_mul_f32 v163, v163, v161
    v_cvt_pk_bf16_f32 v155, v162, v163
    v_lshlrev_b32 v162, 16, v156
    v_and_b32 v163, 0xffff0000, v156
    v_mul_f32 v162, v162, v161
    v_mul_f32 v163, v163, v161
    v_cvt_pk_bf16_f32 v156, v162, v163
    v_lshlrev_b32 v162, 16, v157
    v_and_b32 v163, 0xffff0000, v157
    v_mul_f32 v162, v162, v161
    v_mul_f32 v163, v163, v161
    v_cvt_pk_bf16_f32 v157, v162, v163
    v_lshlrev_b32 v162, 16, v158
    v_and_b32 v163, 0xffff0000, v158
    v_mul_f32 v162, v162, v161
    v_mul_f32 v163, v163, v161
    v_cvt_pk_bf16_f32 v158, v162, v163
    v_lshlrev_b32 v162, 16, v159
    v_and_b32 v163, 0xffff0000, v159
    v_mul_f32 v162, v162, v161
    v_mul_f32 v163, v163, v161
    v_cvt_pk_bf16_f32 v159, v162, v163
    v_mov_b32 v164, 0
    s_nop 1
    s_branch attn_kernel_fback6
attn_kernel_fresc7:
    v_frexp_exp_i32_f32 v162, v164
    v_max_i32 v162, 0, v162
    s_nop 15
    s_nop 15
    v_cvt_f32_i32 v160, v162
    v_sub_u32 v162, 0, v162
    v_ldexp_f32 v161, 1.0, v162
    v_sub_f32 v32, v32, v160
    v_sub_f32 v64, v64, v160
    v_mul_f32 v80, v80, v161
    v_mul_f32 v96, v96, v161
    v_sub_f32 v33, v33, v160
    v_sub_f32 v65, v65, v160
    v_mul_f32 v81, v81, v161
    v_mul_f32 v97, v97, v161
    v_sub_f32 v34, v34, v160
    v_sub_f32 v66, v66, v160
    v_mul_f32 v82, v82, v161
    v_mul_f32 v98, v98, v161
    v_sub_f32 v35, v35, v160
    v_sub_f32 v67, v67, v160
    v_mul_f32 v83, v83, v161
    v_mul_f32 v99, v99, v161
    v_sub_f32 v36, v36, v160
    v_sub_f32 v68, v68, v160
    v_mul_f32 v84, v84, v161
    v_mul_f32 v100, v100, v161
    v_sub_f32 v37, v37, v160
    v_sub_f32 v69, v69, v160
    v_mul_f32 v85, v85, v161
    v_mul_f32 v101, v101, v161
    v_sub_f32 v38, v38, v160
    v_sub_f32 v70, v70, v160
    v_mul_f32 v86, v86, v161
    v_mul_f32 v102, v102, v161
    v_sub_f32 v39, v39, v160
    v_sub_f32 v71, v71, v160
    v_mul_f32 v87, v87, v161
    v_mul_f32 v103, v103, v161
    v_sub_f32 v40, v40, v160
    v_sub_f32 v72, v72, v160
    v_mul_f32 v88, v88, v161
    v_mul_f32 v104, v104, v161
    v_sub_f32 v41, v41, v160
    v_sub_f32 v73, v73, v160
    v_mul_f32 v89, v89, v161
    v_mul_f32 v105, v105, v161
    v_sub_f32 v42, v42, v160
    v_sub_f32 v74, v74, v160
    v_mul_f32 v90, v90, v161
    v_mul_f32 v106, v106, v161
    v_sub_f32 v43, v43, v160
    v_sub_f32 v75, v75, v160
    v_mul_f32 v91, v91, v161
    v_mul_f32 v107, v107, v161
    v_sub_f32 v44, v44, v160
    v_sub_f32 v76, v76, v160
    v_mul_f32 v92, v92, v161
    v_mul_f32 v108, v108, v161
    v_sub_f32 v45, v45, v160
    v_sub_f32 v77, v77, v160
    v_mul_f32 v93, v93, v161
    v_mul_f32 v109, v109, v161
    v_sub_f32 v46, v46, v160
    v_sub_f32 v78, v78, v160
    v_mul_f32 v94, v94, v161
    v_mul_f32 v110, v110, v161
    v_sub_f32 v47, v47, v160
    v_sub_f32 v79, v79, v160
    v_mul_f32 v95, v95, v161
    v_mul_f32 v111, v111, v161
    v_lshlrev_b32 v162, 16, v152
    v_and_b32 v163, 0xffff0000, v152
    v_mul_f32 v162, v162, v161
    v_mul_f32 v163, v163, v161
    v_cvt_pk_bf16_f32 v152, v162, v163
    v_lshlrev_b32 v162, 16, v153
    v_and_b32 v163, 0xffff0000, v153
    v_mul_f32 v162, v162, v161
    v_mul_f32 v163, v163, v161
    v_cvt_pk_bf16_f32 v153, v162, v163
    v_lshlrev_b32 v162, 16, v154
    v_and_b32 v163, 0xffff0000, v154
    v_mul_f32 v162, v162, v161
    v_mul_f32 v163, v163, v161
    v_cvt_pk_bf16_f32 v154, v162, v163
    v_lshlrev_b32 v162, 16, v155
    v_and_b32 v163, 0xffff0000, v155
    v_mul_f32 v162, v162, v161
    v_mul_f32 v163, v163, v161
    v_cvt_pk_bf16_f32 v155, v162, v163
    v_lshlrev_b32 v162, 16, v156
    v_and_b32 v163, 0xffff0000, v156
    v_mul_f32 v162, v162, v161
    v_mul_f32 v163, v163, v161
    v_cvt_pk_bf16_f32 v156, v162, v163
    v_lshlrev_b32 v162, 16, v157
    v_and_b32 v163, 0xffff0000, v157
    v_mul_f32 v162, v162, v161
    v_mul_f32 v163, v163, v161
    v_cvt_pk_bf16_f32 v157, v162, v163
    v_lshlrev_b32 v162, 16, v158
    v_and_b32 v163, 0xffff0000, v158
    v_mul_f32 v162, v162, v161
    v_mul_f32 v163, v163, v161
    v_cvt_pk_bf16_f32 v158, v162, v163
    v_lshlrev_b32 v162, 16, v159
    v_and_b32 v163, 0xffff0000, v159
    v_mul_f32 v162, v162, v161
    v_mul_f32 v163, v163, v161
    v_cvt_pk_bf16_f32 v159, v162, v163
    v_mov_b32 v164, 0
    s_nop 1
    s_branch attn_kernel_fback8
attn_kernel_end:
    s_endpgm
.globl wo_kernel
.p2align 8
.type wo_kernel,@function
wo_kernel:
    s_cmp_ge_u32 s2, 256
    s_cbranch_scc1 wo_kernel_end
    s_load_dwordx2 s[4:5], s[0:1], 88
    s_load_dwordx2 s[6:7], s[0:1], 16
    s_load_dwordx2 s[34:35], s[0:1], 0
    v_lshrrev_b32 v1, 6, v0
    v_and_b32 v0, 63, v0
    s_nop 0
    v_readfirstlane_b32 s30, v1
    s_lshr_b32 s48, s30, 2
    s_and_b32 s30, s30, 3
    s_and_b32 s31, s2, 7
    s_lshr_b32 s36, s2, 3
    s_and_b32 s28, s31, 3
    s_lshr_b32 s29, s31, 2
    s_lshl_b32 s28, s28, 2
    s_and_b32 s37, s36, 3
    s_add_u32 s28, s28, s37
    s_lshl_b32 s29, s29, 3
    s_lshr_b32 s37, s36, 2
    s_add_u32 s29, s29, s37
    v_lshrrev_b32 v1, 3, v0
    v_and_b32 v2, 7, v0
    v_lshrrev_b32 v3, 1, v1
    v_xor_b32 v3, v3, v2
    v_xor_b32 v4, 4, v3
    s_mul_i32 s31, s30, 32
    s_mul_i32 s36, s28, 128
    s_add_u32 s36, s36, s31
    v_add_u32 v1, s36, v1
    s_mov_b32 s37, 2048
    v_mul_lo_u32 v1, v1, s37
    v_lshl_add_u32 v7, v3, 4, v1
    v_lshl_add_u32 v8, v4, 4, v1
    v_add_u32 v8, 16384, v8
    v_lshl_add_u32 v9, v3, 4, v1
    v_add_u32 v9, 32768, v9
    v_lshl_add_u32 v10, v4, 4, v1
    v_add_u32 v10, 49152, v10
    s_mov_b32 s31, s30
    s_mul_i32 s31, s31, 2
    s_mul_i32 s38, s29, 128
    s_mov_b32 s39, 16384
    s_add_u32 s37, s31, 0
    s_min_u32 s37, s37, 7
    s_lshl_b32 s50, s37, 10
    s_add_u32 s50, s50, s39
    s_lshl_b32 s37, s37, 6
    v_add_u32 v1, s37, v0
    v_mul_u32_u24 v2, 8192, v1
    v_lshrrev_b32 v2, 16, v2
    v_mul_u32_u24 v3, 8, v2
    v_sub_u32 v3, v1, v3
    v_lshlrev_b32 v4, 1, v2
    v_and_b32 v4, 4, v4
    v_xor_b32 v3, v3, v4
    v_mul_u32_u24 v2, 2048, v2
    v_lshl_add_u32 v2, v3, 4, v2
    v_add_u32 v11, s38, v2
    s_add_u32 s37, s31, 1
    s_min_u32 s37, s37, 7
    s_lshl_b32 s51, s37, 10
    s_add_u32 s51, s51, s39
    s_lshl_b32 s37, s37, 6
    v_add_u32 v1, s37, v0
    v_mul_u32_u24 v2, 8192, v1
    v_lshrrev_b32 v2, 16, v2
    v_mul_u32_u24 v3, 8, v2
    v_sub_u32 v3, v1, v3
    v_lshlrev_b32 v4, 1, v2
    v_and_b32 v4, 4, v4
    v_xor_b32 v3, v3, v4
    v_mul_u32_u24 v2, 2048, v2
    v_lshl_add_u32 v2, v3, 4, v2
    v_add_u32 v12, s38, v2
    s_mul_i32 s40, s30, 4096
    s_waitcnt lgkmcnt(0)
    s_add_u32 s8, s4, 17825792
    s_addc_u32 s9, s5, 0
    s_and_b32 s9, s9, 0xffff
    s_mov_b32 s10, 4194304
    s_mov_b32 s11, 0x00020000
    s_mov_b32 s12, s6
    s_and_b32 s13, s7, 0xffff
    s_mov_b32 s14, 2097152
    s_mov_b32 s15, 0x00020000
    s_cmp_eq_u32 s48, 0
    s_cbranch_scc1 wo_kernel_compute
    s_mov_b32 s42, 0
    s_mov_b32 s43, 0
    s_add_u32 m0, s40, 0
    s_nop 0
    buffer_load_dwordx4 v7, s[8:11], s42 offen lds
    s_add_u32 m0, s40, 1024
    s_nop 0
    buffer_load_dwordx4 v8, s[8:11], s42 offen lds
    s_add_u32 m0, s40, 2048
    s_nop 0
    buffer_load_dwordx4 v9, s[8:11], s42 offen lds
    s_add_u32 m0, s40, 3072
    s_nop 0
    buffer_load_dwordx4 v10, s[8:11], s42 offen lds
    s_add_u32 m0, s50, 0
    s_nop 0
    buffer_load_dwordx4 v11, s[12:15], s43 offen lds
    s_add_u32 m0, s51, 0
    s_nop 0
    buffer_load_dwordx4 v12, s[12:15], s43 offen lds
    s_mov_b32 s42, 128
    s_mov_b32 s43, 131072
    s_add_u32 m0, s40, 24576
    s_nop 0
    buffer_load_dwordx4 v7, s[8:11], s42 offen lds
    s_add_u32 m0, s40, 25600
    s_nop 0
    buffer_load_dwordx4 v8, s[8:11], s42 offen lds
    s_add_u32 m0, s40, 26624
    s_nop 0
    buffer_load_dwordx4 v9, s[8:11], s42 offen lds
    s_add_u32 m0, s40, 27648
    s_nop 0
    buffer_load_dwordx4 v10, s[8:11], s42 offen lds
    s_add_u32 m0, s50, 24576
    s_nop 0
    buffer_load_dwordx4 v11, s[12:15], s43 offen lds
    s_add_u32 m0, s51, 24576
    s_nop 0
    buffer_load_dwordx4 v12, s[12:15], s43 offen lds
    s_mov_b32 s42, 256
    s_mov_b32 s43, 262144
    s_add_u32 m0, s40, 49152
    s_nop 0
    buffer_load_dwordx4 v7, s[8:11], s42 offen lds
    s_add_u32 m0, s40, 50176
    s_nop 0
    buffer_load_dwordx4 v8, s[8:11], s42 offen lds
    s_add_u32 m0, s40, 51200
    s_nop 0
    buffer_load_dwordx4 v9, s[8:11], s42 offen lds
    s_add_u32 m0, s40, 52224
    s_nop 0
    buffer_load_dwordx4 v10, s[8:11], s42 offen lds
    s_add_u32 m0, s50, 49152
    s_nop 0
    buffer_load_dwordx4 v11, s[12:15], s43 offen lds
    s_add_u32 m0, s51, 49152
    s_nop 0
    buffer_load_dwordx4 v12, s[12:15], s43 offen lds
    s_mov_b32 s42, 384
    s_mov_b32 s43, 393216
    s_add_u32 m0, s40, 73728
    s_nop 0
    buffer_load_dwordx4 v7, s[8:11], s42 offen lds
    s_add_u32 m0, s40, 74752
    s_nop 0
    buffer_load_dwordx4 v8, s[8:11], s42 offen lds
    s_add_u32 m0, s40, 75776
    s_nop 0
    buffer_load_dwordx4 v9, s[8:11], s42 offen lds
    s_add_u32 m0, s40, 76800
    s_nop 0
    buffer_load_dwordx4 v10, s[8:11], s42 offen lds
    s_add_u32 m0, s50, 73728
    s_nop 0
    buffer_load_dwordx4 v11, s[12:15], s43 offen lds
    s_add_u32 m0, s51, 73728
    s_nop 0
    buffer_load_dwordx4 v12, s[12:15], s43 offen lds
    s_waitcnt vmcnt(18)
    s_barrier
    s_mov_b32 s42, 512
    s_mov_b32 s43, 524288
    s_mov_b32 s47, 3
wo_kernel_lloop:
    s_waitcnt vmcnt(12)
    s_barrier
    s_add_u32 m0, s40, 0
    s_nop 0
    buffer_load_dwordx4 v7, s[8:11], s42 offen lds
    s_add_u32 m0, s40, 1024
    s_nop 0
    buffer_load_dwordx4 v8, s[8:11], s42 offen lds
    s_add_u32 m0, s40, 2048
    s_nop 0
    buffer_load_dwordx4 v9, s[8:11], s42 offen lds
    s_add_u32 m0, s40, 3072
    s_nop 0
    buffer_load_dwordx4 v10, s[8:11], s42 offen lds
    s_add_u32 m0, s50, 0
    s_nop 0
    buffer_load_dwordx4 v11, s[12:15], s43 offen lds
    s_add_u32 m0, s51, 0
    s_nop 0
    buffer_load_dwordx4 v12, s[12:15], s43 offen lds
    s_add_u32 s42, s42, 128
    s_add_u32 s43, s43, 131072
    s_waitcnt vmcnt(12)
    s_barrier
    s_add_u32 m0, s40, 24576
    s_nop 0
    buffer_load_dwordx4 v7, s[8:11], s42 offen lds
    s_add_u32 m0, s40, 25600
    s_nop 0
    buffer_load_dwordx4 v8, s[8:11], s42 offen lds
    s_add_u32 m0, s40, 26624
    s_nop 0
    buffer_load_dwordx4 v9, s[8:11], s42 offen lds
    s_add_u32 m0, s40, 27648
    s_nop 0
    buffer_load_dwordx4 v10, s[8:11], s42 offen lds
    s_add_u32 m0, s50, 24576
    s_nop 0
    buffer_load_dwordx4 v11, s[12:15], s43 offen lds
    s_add_u32 m0, s51, 24576
    s_nop 0
    buffer_load_dwordx4 v12, s[12:15], s43 offen lds
    s_add_u32 s42, s42, 128
    s_add_u32 s43, s43, 131072
    s_waitcnt vmcnt(12)
    s_barrier
    s_add_u32 m0, s40, 49152
    s_nop 0
    buffer_load_dwordx4 v7, s[8:11], s42 offen lds
    s_add_u32 m0, s40, 50176
    s_nop 0
    buffer_load_dwordx4 v8, s[8:11], s42 offen lds
    s_add_u32 m0, s40, 51200
    s_nop 0
    buffer_load_dwordx4 v9, s[8:11], s42 offen lds
    s_add_u32 m0, s40, 52224
    s_nop 0
    buffer_load_dwordx4 v10, s[8:11], s42 offen lds
    s_add_u32 m0, s50, 49152
    s_nop 0
    buffer_load_dwordx4 v11, s[12:15], s43 offen lds
    s_add_u32 m0, s51, 49152
    s_nop 0
    buffer_load_dwordx4 v12, s[12:15], s43 offen lds
    s_add_u32 s42, s42, 128
    s_add_u32 s43, s43, 131072
    s_waitcnt vmcnt(12)
    s_barrier
    s_add_u32 m0, s40, 73728
    s_nop 0
    buffer_load_dwordx4 v7, s[8:11], s42 offen lds
    s_add_u32 m0, s40, 74752
    s_nop 0
    buffer_load_dwordx4 v8, s[8:11], s42 offen lds
    s_add_u32 m0, s40, 75776
    s_nop 0
    buffer_load_dwordx4 v9, s[8:11], s42 offen lds
    s_add_u32 m0, s40, 76800
    s_nop 0
    buffer_load_dwordx4 v10, s[8:11], s42 offen lds
    s_add_u32 m0, s50, 73728
    s_nop 0
    buffer_load_dwordx4 v11, s[12:15], s43 offen lds
    s_add_u32 m0, s51, 73728
    s_nop 0
    buffer_load_dwordx4 v12, s[12:15], s43 offen lds
    s_add_u32 s42, s42, 128
    s_add_u32 s43, s43, 131072
    s_sub_u32 s47, s47, 1
    s_cmp_lg_u32 s47, 0
    s_cbranch_scc1 wo_kernel_lloop
    s_waitcnt vmcnt(12)
    s_barrier
    s_waitcnt vmcnt(6)
    s_barrier
    s_waitcnt vmcnt(0)
    s_barrier
    s_endpgm
wo_kernel_compute:
    s_add_u32 s16, s4, 22020096
    s_addc_u32 s17, s5, 0
    s_and_b32 s17, s17, 0xffff
    s_mov_b32 s18, 4194304
    s_mov_b32 s19, 0x00020000
    s_mov_b32 s20, s34
    s_and_b32 s21, s35, 0xffff
    s_mov_b32 s22, 4194304
    s_mov_b32 s23, 0x00020000
    s_add_u32 s24, s4, 8192
    s_addc_u32 s25, s5, 0
    s_and_b32 s25, s25, 0xffff
    s_mov_b32 s26, 4096
    s_mov_b32 s27, 0x00020000
    s_lshr_b32 s44, s30, 1
    s_and_b32 s45, s30, 1
    v_and_b32 v1, 31, v0
    v_lshrrev_b32 v2, 5, v0
    v_bfe_u32 v3, v1, 1, 3
    v_xor_b32 v3, v3, v2
    s_mul_i32 s31, s44, 8192
    v_lshlrev_b32 v4, 7, v1
    v_lshl_add_u32 v4, v3, 4, v4
    v_add_u32 v4, s31, v4
    v_mov_b32 v13, v4
    v_xor_b32 v14, 32, v4
    v_xor_b32 v15, 64, v4
    v_xor_b32 v16, 96, v4
    v_add_u32 v17, 24576, v4
    v_xor_b32 v18, 32, v4
    v_add_u32 v18, 24576, v18
    v_xor_b32 v19, 64, v4
    v_add_u32 v19, 24576, v19
    v_xor_b32 v20, 96, v4
    v_add_u32 v20, 24576, v20
    v_add_u32 v21, 49152, v4
    v_xor_b32 v22, 32, v4
    v_add_u32 v22, 49152, v22
    v_xor_b32 v23, 64, v4
    v_add_u32 v23, 49152, v23
    v_xor_b32 v24, 96, v4
    v_add_u32 v24, 49152, v24
    v_add_u32 v25, 73728, v4
    v_xor_b32 v26, 32, v4
    v_add_u32 v26, 73728, v26
    v_xor_b32 v27, 64, v4
    v_add_u32 v27, 73728, v27
    v_xor_b32 v28, 96, v4
    v_add_u32 v28, 73728, v28
    v_and_b32 v1, 15, v0
    v_bfe_u32 v2, v0, 4, 1
    v_lshrrev_b32 v3, 5, v0
    v_lshrrev_b32 v4, 2, v1
    v_lshl_add_u32 v4, v3, 3, v4
    v_mul_u32_u24 v4, 128, v4
    v_and_b32 v3, 3, v1
    v_lshl_add_u32 v4, v3, 3, v4
    v_lshl_add_u32 v4, v2, 5, v4
    s_mul_i32 s31, s45, 64
    v_add_u32 v4, s31, v4
    v_lshlrev_b32 v3, 3, v1
    v_and_b32 v3, 64, v3
    v_xor_b32 v4, v4, v3
    v_add_u32 v29, 16384, v4
    v_add_u32 v30, 40960, v4
    v_add_u32 v31, 65536, v4
    v_add_u32 v32, 90112, v4
    v_mov_b32 v132, 0
    v_mov_b32 v133, 0
    v_mov_b32 v134, 0
    v_mov_b32 v135, 0
    v_mov_b32 v136, 0
    v_mov_b32 v137, 0
    v_mov_b32 v138, 0
    v_mov_b32 v139, 0
    v_mov_b32 v140, 0
    v_mov_b32 v141, 0
    v_mov_b32 v142, 0
    v_mov_b32 v143, 0
    v_mov_b32 v144, 0
    v_mov_b32 v145, 0
    v_mov_b32 v146, 0
    v_mov_b32 v147, 0
    v_mov_b32 v148, 0
    v_mov_b32 v149, 0
    v_mov_b32 v150, 0
    v_mov_b32 v151, 0
    v_mov_b32 v152, 0
    v_mov_b32 v153, 0
    v_mov_b32 v154, 0
    v_mov_b32 v155, 0
    v_mov_b32 v156, 0
    v_mov_b32 v157, 0
    v_mov_b32 v158, 0
    v_mov_b32 v159, 0
    v_mov_b32 v160, 0
    v_mov_b32 v161, 0
    v_mov_b32 v162, 0
    v_mov_b32 v163, 0
    s_barrier
    ds_read_b128 v[36:39], v13 offset:0
    ds_read_b128 v[40:43], v13 offset:4096
    ds_read_b64_tr_b16 v[44:45], v29 offset:0
    ds_read_b64_tr_b16 v[46:47], v29 offset:512
    ds_read_b128 v[48:51], v14 offset:0
    ds_read_b128 v[52:55], v14 offset:4096
    ds_read_b64_tr_b16 v[56:57], v29 offset:2048
    ds_read_b64_tr_b16 v[58:59], v29 offset:2560
    ds_read_b128 v[60:63], v15 offset:0
    ds_read_b128 v[64:67], v15 offset:4096
    ds_read_b64_tr_b16 v[68:69], v29 offset:4096
    ds_read_b64_tr_b16 v[70:71], v29 offset:4608
    ds_read_b128 v[72:75], v16 offset:0
    ds_read_b128 v[76:79], v16 offset:4096
    ds_read_b64_tr_b16 v[80:81], v29 offset:6144
    ds_read_b64_tr_b16 v[82:83], v29 offset:6656
    s_mov_b32 s42, 512
    s_mov_b32 s43, 524288
    s_mov_b32 s47, 3
.p2align 6
wo_kernel_loop:
    s_waitcnt lgkmcnt(0)
    s_barrier
    v_mfma_f32_32x32x16_bf16 v[132:147], v[44:47], v[36:39], v[132:147]
    ds_read_b128 v[84:87], v17 offset:0
    ds_read_b128 v[88:91], v17 offset:4096
    v_mfma_f32_32x32x16_bf16 v[148:163], v[44:47], v[40:43], v[148:163]
    ds_read_b64_tr_b16 v[92:93], v30 offset:0
    ds_read_b64_tr_b16 v[94:95], v30 offset:512
    v_mfma_f32_32x32x16_bf16 v[132:147], v[56:59], v[48:51], v[132:147]
    ds_read_b128 v[96:99], v18 offset:0
    ds_read_b128 v[100:103], v18 offset:4096
    v_mfma_f32_32x32x16_bf16 v[148:163], v[56:59], v[52:55], v[148:163]
    ds_read_b64_tr_b16 v[104:105], v30 offset:2048
    ds_read_b64_tr_b16 v[106:107], v30 offset:2560
    v_mfma_f32_32x32x16_bf16 v[132:147], v[68:71], v[60:63], v[132:147]
    ds_read_b128 v[108:111], v19 offset:0
    ds_read_b128 v[112:115], v19 offset:4096
    v_mfma_f32_32x32x16_bf16 v[148:163], v[68:71], v[64:67], v[148:163]
    ds_read_b64_tr_b16 v[116:117], v30 offset:4096
    ds_read_b64_tr_b16 v[118:119], v30 offset:4608
    v_mfma_f32_32x32x16_bf16 v[132:147], v[80:83], v[72:75], v[132:147]
    ds_read_b128 v[120:123], v20 offset:0
    ds_read_b128 v[124:127], v20 offset:4096
    v_mfma_f32_32x32x16_bf16 v[148:163], v[80:83], v[76:79], v[148:163]
    ds_read_b64_tr_b16 v[128:129], v30 offset:6144
    ds_read_b64_tr_b16 v[130:131], v30 offset:6656
    s_waitcnt lgkmcnt(0)
    s_barrier
    v_mfma_f32_32x32x16_bf16 v[132:147], v[92:95], v[84:87], v[132:147]
    ds_read_b128 v[36:39], v21 offset:0
    ds_read_b128 v[40:43], v21 offset:4096
    v_mfma_f32_32x32x16_bf16 v[148:163], v[92:95], v[88:91], v[148:163]
    ds_read_b64_tr_b16 v[44:45], v31 offset:0
    ds_read_b64_tr_b16 v[46:47], v31 offset:512
    v_mfma_f32_32x32x16_bf16 v[132:147], v[104:107], v[96:99], v[132:147]
    ds_read_b128 v[48:51], v22 offset:0
    ds_read_b128 v[52:55], v22 offset:4096
    v_mfma_f32_32x32x16_bf16 v[148:163], v[104:107], v[100:103], v[148:163]
    ds_read_b64_tr_b16 v[56:57], v31 offset:2048
    ds_read_b64_tr_b16 v[58:59], v31 offset:2560
    v_mfma_f32_32x32x16_bf16 v[132:147], v[116:119], v[108:111], v[132:147]
    ds_read_b128 v[60:63], v23 offset:0
    ds_read_b128 v[64:67], v23 offset:4096
    v_mfma_f32_32x32x16_bf16 v[148:163], v[116:119], v[112:115], v[148:163]
    ds_read_b64_tr_b16 v[68:69], v31 offset:4096
    ds_read_b64_tr_b16 v[70:71], v31 offset:4608
    v_mfma_f32_32x32x16_bf16 v[132:147], v[128:131], v[120:123], v[132:147]
    ds_read_b128 v[72:75], v24 offset:0
    ds_read_b128 v[76:79], v24 offset:4096
    v_mfma_f32_32x32x16_bf16 v[148:163], v[128:131], v[124:127], v[148:163]
    ds_read_b64_tr_b16 v[80:81], v31 offset:6144
    ds_read_b64_tr_b16 v[82:83], v31 offset:6656
    s_waitcnt lgkmcnt(0)
    s_barrier
    v_mfma_f32_32x32x16_bf16 v[132:147], v[44:47], v[36:39], v[132:147]
    ds_read_b128 v[84:87], v25 offset:0
    ds_read_b128 v[88:91], v25 offset:4096
    v_mfma_f32_32x32x16_bf16 v[148:163], v[44:47], v[40:43], v[148:163]
    ds_read_b64_tr_b16 v[92:93], v32 offset:0
    ds_read_b64_tr_b16 v[94:95], v32 offset:512
    v_mfma_f32_32x32x16_bf16 v[132:147], v[56:59], v[48:51], v[132:147]
    ds_read_b128 v[96:99], v26 offset:0
    ds_read_b128 v[100:103], v26 offset:4096
    v_mfma_f32_32x32x16_bf16 v[148:163], v[56:59], v[52:55], v[148:163]
    ds_read_b64_tr_b16 v[104:105], v32 offset:2048
    ds_read_b64_tr_b16 v[106:107], v32 offset:2560
    v_mfma_f32_32x32x16_bf16 v[132:147], v[68:71], v[60:63], v[132:147]
    ds_read_b128 v[108:111], v27 offset:0
    ds_read_b128 v[112:115], v27 offset:4096
    v_mfma_f32_32x32x16_bf16 v[148:163], v[68:71], v[64:67], v[148:163]
    ds_read_b64_tr_b16 v[116:117], v32 offset:4096
    ds_read_b64_tr_b16 v[118:119], v32 offset:4608
    v_mfma_f32_32x32x16_bf16 v[132:147], v[80:83], v[72:75], v[132:147]
    ds_read_b128 v[120:123], v28 offset:0
    ds_read_b128 v[124:127], v28 offset:4096
    v_mfma_f32_32x32x16_bf16 v[148:163], v[80:83], v[76:79], v[148:163]
    ds_read_b64_tr_b16 v[128:129], v32 offset:6144
    ds_read_b64_tr_b16 v[130:131], v32 offset:6656
    s_waitcnt lgkmcnt(0)
    s_barrier
    v_mfma_f32_32x32x16_bf16 v[132:147], v[92:95], v[84:87], v[132:147]
    ds_read_b128 v[36:39], v13 offset:0
    ds_read_b128 v[40:43], v13 offset:4096
    v_mfma_f32_32x32x16_bf16 v[148:163], v[92:95], v[88:91], v[148:163]
    ds_read_b64_tr_b16 v[44:45], v29 offset:0
    ds_read_b64_tr_b16 v[46:47], v29 offset:512
    v_mfma_f32_32x32x16_bf16 v[132:147], v[104:107], v[96:99], v[132:147]
    ds_read_b128 v[48:51], v14 offset:0
    ds_read_b128 v[52:55], v14 offset:4096
    v_mfma_f32_32x32x16_bf16 v[148:163], v[104:107], v[100:103], v[148:163]
    ds_read_b64_tr_b16 v[56:57], v29 offset:2048
    ds_read_b64_tr_b16 v[58:59], v29 offset:2560
    v_mfma_f32_32x32x16_bf16 v[132:147], v[116:119], v[108:111], v[132:147]
    ds_read_b128 v[60:63], v15 offset:0
    ds_read_b128 v[64:67], v15 offset:4096
    v_mfma_f32_32x32x16_bf16 v[148:163], v[116:119], v[112:115], v[148:163]
    ds_read_b64_tr_b16 v[68:69], v29 offset:4096
    ds_read_b64_tr_b16 v[70:71], v29 offset:4608
    v_mfma_f32_32x32x16_bf16 v[132:147], v[128:131], v[120:123], v[132:147]
    ds_read_b128 v[72:75], v16 offset:0
    ds_read_b128 v[76:79], v16 offset:4096
    v_mfma_f32_32x32x16_bf16 v[148:163], v[128:131], v[124:127], v[148:163]
    ds_read_b64_tr_b16 v[80:81], v29 offset:6144
    ds_read_b64_tr_b16 v[82:83], v29 offset:6656
    s_sub_u32 s47, s47, 1
    s_cmp_lg_u32 s47, 0
    s_cbranch_scc1 wo_kernel_loop
    s_waitcnt lgkmcnt(0)
    s_barrier
    v_mfma_f32_32x32x16_bf16 v[132:147], v[44:47], v[36:39], v[132:147]
    ds_read_b128 v[84:87], v17 offset:0
    ds_read_b128 v[88:91], v17 offset:4096
    v_mfma_f32_32x32x16_bf16 v[148:163], v[44:47], v[40:43], v[148:163]
    ds_read_b64_tr_b16 v[92:93], v30 offset:0
    ds_read_b64_tr_b16 v[94:95], v30 offset:512
    v_mfma_f32_32x32x16_bf16 v[132:147], v[56:59], v[48:51], v[132:147]
    ds_read_b128 v[96:99], v18 offset:0
    ds_read_b128 v[100:103], v18 offset:4096
    v_mfma_f32_32x32x16_bf16 v[148:163], v[56:59], v[52:55], v[148:163]
    ds_read_b64_tr_b16 v[104:105], v30 offset:2048
    ds_read_b64_tr_b16 v[106:107], v30 offset:2560
    v_mfma_f32_32x32x16_bf16 v[132:147], v[68:71], v[60:63], v[132:147]
    ds_read_b128 v[108:111], v19 offset:0
    ds_read_b128 v[112:115], v19 offset:4096
    v_mfma_f32_32x32x16_bf16 v[148:163], v[68:71], v[64:67], v[148:163]
    ds_read_b64_tr_b16 v[116:117], v30 offset:4096
    ds_read_b64_tr_b16 v[118:119], v30 offset:4608
    v_mfma_f32_32x32x16_bf16 v[132:147], v[80:83], v[72:75], v[132:147]
    ds_read_b128 v[120:123], v20 offset:0
    ds_read_b128 v[124:127], v20 offset:4096
    v_mfma_f32_32x32x16_bf16 v[148:163], v[80:83], v[76:79], v[148:163]
    ds_read_b64_tr_b16 v[128:129], v30 offset:6144
    ds_read_b64_tr_b16 v[130:131], v30 offset:6656
    s_waitcnt lgkmcnt(0)
    s_barrier
    v_mfma_f32_32x32x16_bf16 v[132:147], v[92:95], v[84:87], v[132:147]
    ds_read_b128 v[36:39], v21 offset:0
    ds_read_b128 v[40:43], v21 offset:4096
    v_mfma_f32_32x32x16_bf16 v[148:163], v[92:95], v[88:91], v[148:163]
    ds_read_b64_tr_b16 v[44:45], v31 offset:0
    ds_read_b64_tr_b16 v[46:47], v31 offset:512
    v_mfma_f32_32x32x16_bf16 v[132:147], v[104:107], v[96:99], v[132:147]
    ds_read_b128 v[48:51], v22 offset:0
    ds_read_b128 v[52:55], v22 offset:4096
    v_mfma_f32_32x32x16_bf16 v[148:163], v[104:107], v[100:103], v[148:163]
    ds_read_b64_tr_b16 v[56:57], v31 offset:2048
    ds_read_b64_tr_b16 v[58:59], v31 offset:2560
    v_mfma_f32_32x32x16_bf16 v[132:147], v[116:119], v[108:111], v[132:147]
    ds_read_b128 v[60:63], v23 offset:0
    ds_read_b128 v[64:67], v23 offset:4096
    v_mfma_f32_32x32x16_bf16 v[148:163], v[116:119], v[112:115], v[148:163]
    ds_read_b64_tr_b16 v[68:69], v31 offset:4096
    ds_read_b64_tr_b16 v[70:71], v31 offset:4608
    v_mfma_f32_32x32x16_bf16 v[132:147], v[128:131], v[120:123], v[132:147]
    ds_read_b128 v[72:75], v24 offset:0
    ds_read_b128 v[76:79], v24 offset:4096
    v_mfma_f32_32x32x16_bf16 v[148:163], v[128:131], v[124:127], v[148:163]
    ds_read_b64_tr_b16 v[80:81], v31 offset:6144
    ds_read_b64_tr_b16 v[82:83], v31 offset:6656
    s_waitcnt lgkmcnt(0)
    s_barrier
    v_mfma_f32_32x32x16_bf16 v[132:147], v[44:47], v[36:39], v[132:147]
    ds_read_b128 v[84:87], v25 offset:0
    ds_read_b128 v[88:91], v25 offset:4096
    v_mfma_f32_32x32x16_bf16 v[148:163], v[44:47], v[40:43], v[148:163]
    ds_read_b64_tr_b16 v[92:93], v32 offset:0
    ds_read_b64_tr_b16 v[94:95], v32 offset:512
    v_mfma_f32_32x32x16_bf16 v[132:147], v[56:59], v[48:51], v[132:147]
    ds_read_b128 v[96:99], v26 offset:0
    ds_read_b128 v[100:103], v26 offset:4096
    v_mfma_f32_32x32x16_bf16 v[148:163], v[56:59], v[52:55], v[148:163]
    ds_read_b64_tr_b16 v[104:105], v32 offset:2048
    ds_read_b64_tr_b16 v[106:107], v32 offset:2560
    v_mfma_f32_32x32x16_bf16 v[132:147], v[68:71], v[60:63], v[132:147]
    ds_read_b128 v[108:111], v27 offset:0
    ds_read_b128 v[112:115], v27 offset:4096
    v_mfma_f32_32x32x16_bf16 v[148:163], v[68:71], v[64:67], v[148:163]
    ds_read_b64_tr_b16 v[116:117], v32 offset:4096
    ds_read_b64_tr_b16 v[118:119], v32 offset:4608
    v_mfma_f32_32x32x16_bf16 v[132:147], v[80:83], v[72:75], v[132:147]
    ds_read_b128 v[120:123], v28 offset:0
    ds_read_b128 v[124:127], v28 offset:4096
    v_mfma_f32_32x32x16_bf16 v[148:163], v[80:83], v[76:79], v[148:163]
    ds_read_b64_tr_b16 v[128:129], v32 offset:6144
    ds_read_b64_tr_b16 v[130:131], v32 offset:6656
    s_waitcnt lgkmcnt(0)
    v_mfma_f32_32x32x16_bf16 v[132:147], v[92:95], v[84:87], v[132:147]
    v_mfma_f32_32x32x16_bf16 v[148:163], v[92:95], v[88:91], v[148:163]
    v_mfma_f32_32x32x16_bf16 v[132:147], v[104:107], v[96:99], v[132:147]
    v_mfma_f32_32x32x16_bf16 v[148:163], v[104:107], v[100:103], v[148:163]
    v_mfma_f32_32x32x16_bf16 v[132:147], v[116:119], v[108:111], v[132:147]
    v_mfma_f32_32x32x16_bf16 v[148:163], v[116:119], v[112:115], v[148:163]
    v_mfma_f32_32x32x16_bf16 v[132:147], v[128:131], v[120:123], v[132:147]
    v_mfma_f32_32x32x16_bf16 v[148:163], v[128:131], v[124:127], v[148:163]
    v_and_b32 v1, 31, v0
    v_lshrrev_b32 v2, 5, v0
    s_mul_i32 s36, s28, 128
    s_mul_i32 s31, s44, 64
    s_add_u32 s36, s36, s31
    v_add_u32 v1, s36, v1
    s_mul_i32 s37, s29, 64
    s_lshl_b32 s31, s45, 5
    s_add_u32 s37, s37, s31
    v_lshlrev_b32 v3, 11, v1
    v_lshl_add_u32 v3, v2, 4, v3
    s_lshl_b32 s31, s37, 1
    v_add_u32 v3, s31, v3
    s_lshl_b32 s31, s37, 2
    v_lshlrev_b32 v4, 5, v2
    v_add_u32 v4, s31, v4
    s_mov_b32 s46, 65536
    s_nop 15
    buffer_load_dwordx4 v[68:71], v4, s[24:27], 0 offen offset:0
    buffer_load_dwordx4 v[72:75], v4, s[24:27], 0 offen offset:16
    buffer_load_dwordx4 v[76:79], v4, s[24:27], 0 offen offset:64
    buffer_load_dwordx4 v[80:83], v4, s[24:27], 0 offen offset:80
    buffer_load_dwordx4 v[84:87], v3, s[20:23], 0 offen offset:0
    buffer_load_dwordx4 v[88:91], v3, s[20:23], 0 offen offset:32
    buffer_load_dwordx4 v[92:95], v3, s[20:23], s46 offen offset:0
    buffer_load_dwordx4 v[96:99], v3, s[20:23], s46 offen offset:32
    v_cvt_pk_bf16_f32 v52, v132, v133
    v_cvt_pk_bf16_f32 v53, v134, v135
    v_cvt_pk_bf16_f32 v54, v136, v137
    v_cvt_pk_bf16_f32 v55, v138, v139
    v_cvt_pk_bf16_f32 v56, v140, v141
    v_cvt_pk_bf16_f32 v57, v142, v143
    v_cvt_pk_bf16_f32 v58, v144, v145
    v_cvt_pk_bf16_f32 v59, v146, v147
    s_nop 1
    v_permlane32_swap_b32 v52, v54
    v_permlane32_swap_b32 v53, v55
    v_permlane32_swap_b32 v56, v58
    v_permlane32_swap_b32 v57, v59
    s_waitcnt vmcnt(0)
    v_lshlrev_b32 v36, 16, v52
    v_and_b32 v37, 0xffff0000, v52
    v_mul_f32 v36, v68, v36
    v_mul_f32 v37, v69, v37
    v_cvt_pk_bf16_f32 v52, v36, v37
    v_lshlrev_b32 v36, 16, v52
    v_and_b32 v37, 0xffff0000, v52
    v_lshlrev_b32 v38, 16, v84
    v_and_b32 v39, 0xffff0000, v84
    v_add_f32 v36, v36, v38
    v_add_f32 v37, v37, v39
    v_cvt_pk_bf16_f32 v84, v36, v37
    v_lshlrev_b32 v36, 16, v53
    v_and_b32 v37, 0xffff0000, v53
    v_mul_f32 v36, v70, v36
    v_mul_f32 v37, v71, v37
    v_cvt_pk_bf16_f32 v53, v36, v37
    v_lshlrev_b32 v36, 16, v53
    v_and_b32 v37, 0xffff0000, v53
    v_lshlrev_b32 v38, 16, v85
    v_and_b32 v39, 0xffff0000, v85
    v_add_f32 v36, v36, v38
    v_add_f32 v37, v37, v39
    v_cvt_pk_bf16_f32 v85, v36, v37
    v_lshlrev_b32 v36, 16, v54
    v_and_b32 v37, 0xffff0000, v54
    v_mul_f32 v36, v72, v36
    v_mul_f32 v37, v73, v37
    v_cvt_pk_bf16_f32 v54, v36, v37
    v_lshlrev_b32 v36, 16, v54
    v_and_b32 v37, 0xffff0000, v54
    v_lshlrev_b32 v38, 16, v86
    v_and_b32 v39, 0xffff0000, v86
    v_add_f32 v36, v36, v38
    v_add_f32 v37, v37, v39
    v_cvt_pk_bf16_f32 v86, v36, v37
    v_lshlrev_b32 v36, 16, v55
    v_and_b32 v37, 0xffff0000, v55
    v_mul_f32 v36, v74, v36
    v_mul_f32 v37, v75, v37
    v_cvt_pk_bf16_f32 v55, v36, v37
    v_lshlrev_b32 v36, 16, v55
    v_and_b32 v37, 0xffff0000, v55
    v_lshlrev_b32 v38, 16, v87
    v_and_b32 v39, 0xffff0000, v87
    v_add_f32 v36, v36, v38
    v_add_f32 v37, v37, v39
    v_cvt_pk_bf16_f32 v87, v36, v37
    buffer_store_dwordx4 v[84:87], v3, s[16:19], 0 offen offset:0
    v_lshlrev_b32 v36, 16, v56
    v_and_b32 v37, 0xffff0000, v56
    v_mul_f32 v36, v76, v36
    v_mul_f32 v37, v77, v37
    v_cvt_pk_bf16_f32 v56, v36, v37
    v_lshlrev_b32 v36, 16, v56
    v_and_b32 v37, 0xffff0000, v56
    v_lshlrev_b32 v38, 16, v88
    v_and_b32 v39, 0xffff0000, v88
    v_add_f32 v36, v36, v38
    v_add_f32 v37, v37, v39
    v_cvt_pk_bf16_f32 v88, v36, v37
    v_lshlrev_b32 v36, 16, v57
    v_and_b32 v37, 0xffff0000, v57
    v_mul_f32 v36, v78, v36
    v_mul_f32 v37, v79, v37
    v_cvt_pk_bf16_f32 v57, v36, v37
    v_lshlrev_b32 v36, 16, v57
    v_and_b32 v37, 0xffff0000, v57
    v_lshlrev_b32 v38, 16, v89
    v_and_b32 v39, 0xffff0000, v89
    v_add_f32 v36, v36, v38
    v_add_f32 v37, v37, v39
    v_cvt_pk_bf16_f32 v89, v36, v37
    v_lshlrev_b32 v36, 16, v58
    v_and_b32 v37, 0xffff0000, v58
    v_mul_f32 v36, v80, v36
    v_mul_f32 v37, v81, v37
    v_cvt_pk_bf16_f32 v58, v36, v37
    v_lshlrev_b32 v36, 16, v58
    v_and_b32 v37, 0xffff0000, v58
    v_lshlrev_b32 v38, 16, v90
    v_and_b32 v39, 0xffff0000, v90
    v_add_f32 v36, v36, v38
    v_add_f32 v37, v37, v39
    v_cvt_pk_bf16_f32 v90, v36, v37
    v_lshlrev_b32 v36, 16, v59
    v_and_b32 v37, 0xffff0000, v59
    v_mul_f32 v36, v82, v36
    v_mul_f32 v37, v83, v37
    v_cvt_pk_bf16_f32 v59, v36, v37
    v_lshlrev_b32 v36, 16, v59
    v_and_b32 v37, 0xffff0000, v59
    v_lshlrev_b32 v38, 16, v91
    v_and_b32 v39, 0xffff0000, v91
    v_add_f32 v36, v36, v38
    v_add_f32 v37, v37, v39
    v_cvt_pk_bf16_f32 v91, v36, v37
    buffer_store_dwordx4 v[88:91], v3, s[16:19], 0 offen offset:32
    v_cvt_pk_bf16_f32 v52, v148, v149
    v_cvt_pk_bf16_f32 v53, v150, v151
    v_cvt_pk_bf16_f32 v54, v152, v153
    v_cvt_pk_bf16_f32 v55, v154, v155
    v_cvt_pk_bf16_f32 v56, v156, v157
    v_cvt_pk_bf16_f32 v57, v158, v159
    v_cvt_pk_bf16_f32 v58, v160, v161
    v_cvt_pk_bf16_f32 v59, v162, v163
    s_nop 1
    v_permlane32_swap_b32 v52, v54
    v_permlane32_swap_b32 v53, v55
    v_permlane32_swap_b32 v56, v58
    v_permlane32_swap_b32 v57, v59
    v_lshlrev_b32 v36, 16, v52
    v_and_b32 v37, 0xffff0000, v52
    v_mul_f32 v36, v68, v36
    v_mul_f32 v37, v69, v37
    v_cvt_pk_bf16_f32 v52, v36, v37
    v_lshlrev_b32 v36, 16, v52
    v_and_b32 v37, 0xffff0000, v52
    v_lshlrev_b32 v38, 16, v92
    v_and_b32 v39, 0xffff0000, v92
    v_add_f32 v36, v36, v38
    v_add_f32 v37, v37, v39
    v_cvt_pk_bf16_f32 v92, v36, v37
    v_lshlrev_b32 v36, 16, v53
    v_and_b32 v37, 0xffff0000, v53
    v_mul_f32 v36, v70, v36
    v_mul_f32 v37, v71, v37
    v_cvt_pk_bf16_f32 v53, v36, v37
    v_lshlrev_b32 v36, 16, v53
    v_and_b32 v37, 0xffff0000, v53
    v_lshlrev_b32 v38, 16, v93
    v_and_b32 v39, 0xffff0000, v93
    v_add_f32 v36, v36, v38
    v_add_f32 v37, v37, v39
    v_cvt_pk_bf16_f32 v93, v36, v37
    v_lshlrev_b32 v36, 16, v54
    v_and_b32 v37, 0xffff0000, v54
    v_mul_f32 v36, v72, v36
    v_mul_f32 v37, v73, v37
    v_cvt_pk_bf16_f32 v54, v36, v37
    v_lshlrev_b32 v36, 16, v54
    v_and_b32 v37, 0xffff0000, v54
    v_lshlrev_b32 v38, 16, v94
    v_and_b32 v39, 0xffff0000, v94
    v_add_f32 v36, v36, v38
    v_add_f32 v37, v37, v39
    v_cvt_pk_bf16_f32 v94, v36, v37
    v_lshlrev_b32 v36, 16, v55
    v_and_b32 v37, 0xffff0000, v55
    v_mul_f32 v36, v74, v36
    v_mul_f32 v37, v75, v37
    v_cvt_pk_bf16_f32 v55, v36, v37
    v_lshlrev_b32 v36, 16, v55
    v_and_b32 v37, 0xffff0000, v55
    v_lshlrev_b32 v38, 16, v95
    v_and_b32 v39, 0xffff0000, v95
    v_add_f32 v36, v36, v38
    v_add_f32 v37, v37, v39
    v_cvt_pk_bf16_f32 v95, v36, v37
    buffer_store_dwordx4 v[92:95], v3, s[16:19], s46 offen offset:0
    v_lshlrev_b32 v36, 16, v56
    v_and_b32 v37, 0xffff0000, v56
    v_mul_f32 v36, v76, v36
    v_mul_f32 v37, v77, v37
    v_cvt_pk_bf16_f32 v56, v36, v37
    v_lshlrev_b32 v36, 16, v56
    v_and_b32 v37, 0xffff0000, v56
    v_lshlrev_b32 v38, 16, v96
    v_and_b32 v39, 0xffff0000, v96
    v_add_f32 v36, v36, v38
    v_add_f32 v37, v37, v39
    v_cvt_pk_bf16_f32 v96, v36, v37
    v_lshlrev_b32 v36, 16, v57
    v_and_b32 v37, 0xffff0000, v57
    v_mul_f32 v36, v78, v36
    v_mul_f32 v37, v79, v37
    v_cvt_pk_bf16_f32 v57, v36, v37
    v_lshlrev_b32 v36, 16, v57
    v_and_b32 v37, 0xffff0000, v57
    v_lshlrev_b32 v38, 16, v97
    v_and_b32 v39, 0xffff0000, v97
    v_add_f32 v36, v36, v38
    v_add_f32 v37, v37, v39
    v_cvt_pk_bf16_f32 v97, v36, v37
    v_lshlrev_b32 v36, 16, v58
    v_and_b32 v37, 0xffff0000, v58
    v_mul_f32 v36, v80, v36
    v_mul_f32 v37, v81, v37
    v_cvt_pk_bf16_f32 v58, v36, v37
    v_lshlrev_b32 v36, 16, v58
    v_and_b32 v37, 0xffff0000, v58
    v_lshlrev_b32 v38, 16, v98
    v_and_b32 v39, 0xffff0000, v98
    v_add_f32 v36, v36, v38
    v_add_f32 v37, v37, v39
    v_cvt_pk_bf16_f32 v98, v36, v37
    v_lshlrev_b32 v36, 16, v59
    v_and_b32 v37, 0xffff0000, v59
    v_mul_f32 v36, v82, v36
    v_mul_f32 v37, v83, v37
    v_cvt_pk_bf16_f32 v59, v36, v37
    v_lshlrev_b32 v36, 16, v59
    v_and_b32 v37, 0xffff0000, v59
    v_lshlrev_b32 v38, 16, v99
    v_and_b32 v39, 0xffff0000, v99
    v_add_f32 v36, v36, v38
    v_add_f32 v37, v37, v39
    v_cvt_pk_bf16_f32 v99, v36, v37
    buffer_store_dwordx4 v[96:99], v3, s[16:19], s46 offen offset:32
wo_kernel_end:
    s_endpgm
.globl ln2_kernel
.p2align 8
.type ln2_kernel,@function
ln2_kernel:
    s_cmp_ge_u32 s2, 512
    s_cbranch_scc1 ln2_kernel_end
    s_load_dwordx2 s[4:5], s[0:1], 0
    s_load_dwordx2 s[8:9], s[0:1], 88
    v_and_b32 v1, 63, v0
    v_lshrrev_b32 v2, 6, v0
    s_waitcnt lgkmcnt(0)
    s_add_u32 s12, s8, 22020096
    s_addc_u32 s13, s9, 0
    s_and_b32 s13, s13, 0xffff
    s_mov_b32 s14, 4194304
    s_mov_b32 s15, 0x00020000
    s_add_u32 s16, s8, 26214400
    s_addc_u32 s17, s9, 0
    s_and_b32 s17, s17, 0xffff
    s_mov_b32 s18, 4194304
    s_mov_b32 s19, 0x00020000
    s_add_u32 s20, s8, 12288
    s_addc_u32 s21, s9, 0
    s_and_b32 s21, s21, 0xffff
    s_mov_b32 s22, 8192
    s_mov_b32 s23, 0x00020000
    s_lshl_b32 s3, s2, 13
    v_lshlrev_b32 v3, 11, v2
    v_lshl_add_u32 v3, v1, 4, v3
    v_add_u32 v3, s3, v3
    v_lshlrev_b32 v4, 5, v1
    s_mov_b32 s24, 4096
    buffer_load_dwordx4 v[8:11], v3, s[12:15], 0 offen
    buffer_load_dwordx4 v[12:15], v3, s[12:15], 0 offen offset:1024
    buffer_load_dwordx4 v[16:19], v4, s[20:23], 0 offen offset:0
    buffer_load_dwordx4 v[20:23], v4, s[20:23], 0 offen offset:16
    buffer_load_dwordx4 v[24:27], v4, s[20:23], 0 offen offset:2048
    buffer_load_dwordx4 v[28:31], v4, s[20:23], 0 offen offset:2064
    buffer_load_dwordx4 v[32:35], v4, s[20:23], s24 offen offset:0
    buffer_load_dwordx4 v[36:39], v4, s[20:23], s24 offen offset:16
    buffer_load_dwordx4 v[40:43], v4, s[20:23], s24 offen offset:2048
    buffer_load_dwordx4 v[44:47], v4, s[20:23], s24 offen offset:2064
    s_waitcnt vmcnt(8)
    v_lshlrev_b32 v48, 16, v8
    v_and_b32 v49, 0xffff0000, v8
    v_lshlrev_b32 v50, 16, v9
    v_and_b32 v51, 0xffff0000, v9
    v_lshlrev_b32 v52, 16, v10
    v_and_b32 v53, 0xffff0000, v10
    v_lshlrev_b32 v54, 16, v11
    v_and_b32 v55, 0xffff0000, v11
    v_lshlrev_b32 v56, 16, v12
    v_and_b32 v57, 0xffff0000, v12
    v_lshlrev_b32 v58, 16, v13
    v_and_b32 v59, 0xffff0000, v13
    v_lshlrev_b32 v60, 16, v14
    v_and_b32 v61, 0xffff0000, v14
    v_lshlrev_b32 v62, 16, v15
    v_and_b32 v63, 0xffff0000, v15
    v_add_f32 v5, v48, v49
    v_add_f32 v5, v5, v50
    v_add_f32 v5, v5, v51
    v_add_f32 v5, v5, v52
    v_add_f32 v5, v5, v53
    v_add_f32 v5, v5, v54
    v_add_f32 v5, v5, v55
    v_add_f32 v5, v5, v56
    v_add_f32 v5, v5, v57
    v_add_f32 v5, v5, v58
    v_add_f32 v5, v5, v59
    v_add_f32 v5, v5, v60
    v_add_f32 v5, v5, v61
    v_add_f32 v5, v5, v62
    v_add_f32 v5, v5, v63
    s_nop 1
    v_add_f32_dpp v6, v5, v5 quad_perm:[1,0,3,2] row_mask:0xf bank_mask:0xf
    s_nop 1
    v_add_f32_dpp v5, v6, v6 quad_perm:[2,3,0,1] row_mask:0xf bank_mask:0xf
    s_nop 1
    v_add_f32_dpp v6, v5, v5 row_half_mirror row_mask:0xf bank_mask:0xf
    s_nop 1
    v_add_f32_dpp v5, v6, v6 row_mirror row_mask:0xf bank_mask:0xf
    s_nop 1
    v_readlane_b32 s28, v5, 0
    v_readlane_b32 s29, v5, 16
    v_readlane_b32 s30, v5, 32
    v_readlane_b32 s31, v5, 48
    s_nop 1
    v_mov_b32 v5, s28
    v_add_f32 v5, s29, v5
    v_add_f32 v5, s30, v5
    v_add_f32 v5, s31, v5
    v_mul_f32 v5, 0x3a800000, v5
    v_mov_b32 v7, 0
    v_sub_f32 v6, v48, v5
    v_fmac_f32 v7, v6, v6
    v_sub_f32 v6, v49, v5
    v_fmac_f32 v7, v6, v6
    v_sub_f32 v6, v50, v5
    v_fmac_f32 v7, v6, v6
    v_sub_f32 v6, v51, v5
    v_fmac_f32 v7, v6, v6
    v_sub_f32 v6, v52, v5
    v_fmac_f32 v7, v6, v6
    v_sub_f32 v6, v53, v5
    v_fmac_f32 v7, v6, v6
    v_sub_f32 v6, v54, v5
    v_fmac_f32 v7, v6, v6
    v_sub_f32 v6, v55, v5
    v_fmac_f32 v7, v6, v6
    v_sub_f32 v6, v56, v5
    v_fmac_f32 v7, v6, v6
    v_sub_f32 v6, v57, v5
    v_fmac_f32 v7, v6, v6
    v_sub_f32 v6, v58, v5
    v_fmac_f32 v7, v6, v6
    v_sub_f32 v6, v59, v5
    v_fmac_f32 v7, v6, v6
    v_sub_f32 v6, v60, v5
    v_fmac_f32 v7, v6, v6
    v_sub_f32 v6, v61, v5
    v_fmac_f32 v7, v6, v6
    v_sub_f32 v6, v62, v5
    v_fmac_f32 v7, v6, v6
    v_sub_f32 v6, v63, v5
    v_fmac_f32 v7, v6, v6
    s_nop 1
    v_add_f32_dpp v6, v7, v7 quad_perm:[1,0,3,2] row_mask:0xf bank_mask:0xf
    s_nop 1
    v_add_f32_dpp v7, v6, v6 quad_perm:[2,3,0,1] row_mask:0xf bank_mask:0xf
    s_nop 1
    v_add_f32_dpp v6, v7, v7 row_half_mirror row_mask:0xf bank_mask:0xf
    s_nop 1
    v_add_f32_dpp v7, v6, v6 row_mirror row_mask:0xf bank_mask:0xf
    s_nop 1
    v_readlane_b32 s28, v7, 0
    v_readlane_b32 s29, v7, 16
    v_readlane_b32 s30, v7, 32
    v_readlane_b32 s31, v7, 48
    s_nop 1
    v_mov_b32 v7, s28
    v_add_f32 v7, s29, v7
    v_add_f32 v7, s30, v7
    v_add_f32 v7, s31, v7
    v_mul_f32 v7, 0x3a800000, v7
    v_cvt_pk_bf16_f32 v6, v5, v5
    v_lshlrev_b32 v5, 16, v6
    v_cvt_pk_bf16_f32 v6, v7, v7
    v_lshlrev_b32 v7, 16, v6
    v_add_f32 v7, 0x3727c5ac, v7
    v_cvt_pk_bf16_f32 v6, v7, v7
    v_lshlrev_b32 v7, 16, v6
    v_sqrt_f32 v7, v7
    s_nop 0
    v_cvt_pk_bf16_f32 v6, v7, v7
    v_lshlrev_b32 v7, 16, v6
    v_rcp_f32 v7, v7
    s_waitcnt vmcnt(0)
    v_add_f32 v32, 1.0, v32
    v_add_f32 v33, 1.0, v33
    v_cvt_pk_bf16_f32 v6, v32, v33
    v_lshlrev_b32 v32, 16, v6
    v_and_b32 v33, 0xffff0000, v6
    v_add_f32 v34, 1.0, v34
    v_add_f32 v35, 1.0, v35
    v_cvt_pk_bf16_f32 v6, v34, v35
    v_lshlrev_b32 v34, 16, v6
    v_and_b32 v35, 0xffff0000, v6
    v_add_f32 v36, 1.0, v36
    v_add_f32 v37, 1.0, v37
    v_cvt_pk_bf16_f32 v6, v36, v37
    v_lshlrev_b32 v36, 16, v6
    v_and_b32 v37, 0xffff0000, v6
    v_add_f32 v38, 1.0, v38
    v_add_f32 v39, 1.0, v39
    v_cvt_pk_bf16_f32 v6, v38, v39
    v_lshlrev_b32 v38, 16, v6
    v_and_b32 v39, 0xffff0000, v6
    v_add_f32 v40, 1.0, v40
    v_add_f32 v41, 1.0, v41
    v_cvt_pk_bf16_f32 v6, v40, v41
    v_lshlrev_b32 v40, 16, v6
    v_and_b32 v41, 0xffff0000, v6
    v_add_f32 v42, 1.0, v42
    v_add_f32 v43, 1.0, v43
    v_cvt_pk_bf16_f32 v6, v42, v43
    v_lshlrev_b32 v42, 16, v6
    v_and_b32 v43, 0xffff0000, v6
    v_add_f32 v44, 1.0, v44
    v_add_f32 v45, 1.0, v45
    v_cvt_pk_bf16_f32 v6, v44, v45
    v_lshlrev_b32 v44, 16, v6
    v_and_b32 v45, 0xffff0000, v6
    v_add_f32 v46, 1.0, v46
    v_add_f32 v47, 1.0, v47
    v_cvt_pk_bf16_f32 v6, v46, v47
    v_lshlrev_b32 v46, 16, v6
    v_and_b32 v47, 0xffff0000, v6
    v_sub_f32 v48, v48, v5
    v_sub_f32 v49, v49, v5
    v_cvt_pk_bf16_f32 v6, v48, v49
    v_lshlrev_b32 v48, 16, v6
    v_and_b32 v49, 0xffff0000, v6
    v_mul_f32 v48, v48, v7
    v_mul_f32 v49, v49, v7
    v_cvt_pk_bf16_f32 v6, v48, v49
    v_lshlrev_b32 v48, 16, v6
    v_and_b32 v49, 0xffff0000, v6
    v_mul_f32 v48, v48, v32
    v_mul_f32 v49, v49, v33
    v_cvt_pk_bf16_f32 v6, v48, v49
    v_lshlrev_b32 v48, 16, v6
    v_and_b32 v49, 0xffff0000, v6
    v_add_f32 v48, v48, v16
    v_add_f32 v49, v49, v17
    v_cvt_pk_bf16_f32 v8, v48, v49
    v_sub_f32 v50, v50, v5
    v_sub_f32 v51, v51, v5
    v_cvt_pk_bf16_f32 v6, v50, v51
    v_lshlrev_b32 v50, 16, v6
    v_and_b32 v51, 0xffff0000, v6
    v_mul_f32 v50, v50, v7
    v_mul_f32 v51, v51, v7
    v_cvt_pk_bf16_f32 v6, v50, v51
    v_lshlrev_b32 v50, 16, v6
    v_and_b32 v51, 0xffff0000, v6
    v_mul_f32 v50, v50, v34
    v_mul_f32 v51, v51, v35
    v_cvt_pk_bf16_f32 v6, v50, v51
    v_lshlrev_b32 v50, 16, v6
    v_and_b32 v51, 0xffff0000, v6
    v_add_f32 v50, v50, v18
    v_add_f32 v51, v51, v19
    v_cvt_pk_bf16_f32 v9, v50, v51
    v_sub_f32 v52, v52, v5
    v_sub_f32 v53, v53, v5
    v_cvt_pk_bf16_f32 v6, v52, v53
    v_lshlrev_b32 v52, 16, v6
    v_and_b32 v53, 0xffff0000, v6
    v_mul_f32 v52, v52, v7
    v_mul_f32 v53, v53, v7
    v_cvt_pk_bf16_f32 v6, v52, v53
    v_lshlrev_b32 v52, 16, v6
    v_and_b32 v53, 0xffff0000, v6
    v_mul_f32 v52, v52, v36
    v_mul_f32 v53, v53, v37
    v_cvt_pk_bf16_f32 v6, v52, v53
    v_lshlrev_b32 v52, 16, v6
    v_and_b32 v53, 0xffff0000, v6
    v_add_f32 v52, v52, v20
    v_add_f32 v53, v53, v21
    v_cvt_pk_bf16_f32 v10, v52, v53
    v_sub_f32 v54, v54, v5
    v_sub_f32 v55, v55, v5
    v_cvt_pk_bf16_f32 v6, v54, v55
    v_lshlrev_b32 v54, 16, v6
    v_and_b32 v55, 0xffff0000, v6
    v_mul_f32 v54, v54, v7
    v_mul_f32 v55, v55, v7
    v_cvt_pk_bf16_f32 v6, v54, v55
    v_lshlrev_b32 v54, 16, v6
    v_and_b32 v55, 0xffff0000, v6
    v_mul_f32 v54, v54, v38
    v_mul_f32 v55, v55, v39
    v_cvt_pk_bf16_f32 v6, v54, v55
    v_lshlrev_b32 v54, 16, v6
    v_and_b32 v55, 0xffff0000, v6
    v_add_f32 v54, v54, v22
    v_add_f32 v55, v55, v23
    v_cvt_pk_bf16_f32 v11, v54, v55
    v_sub_f32 v56, v56, v5
    v_sub_f32 v57, v57, v5
    v_cvt_pk_bf16_f32 v6, v56, v57
    v_lshlrev_b32 v56, 16, v6
    v_and_b32 v57, 0xffff0000, v6
    v_mul_f32 v56, v56, v7
    v_mul_f32 v57, v57, v7
    v_cvt_pk_bf16_f32 v6, v56, v57
    v_lshlrev_b32 v56, 16, v6
    v_and_b32 v57, 0xffff0000, v6
    v_mul_f32 v56, v56, v40
    v_mul_f32 v57, v57, v41
    v_cvt_pk_bf16_f32 v6, v56, v57
    v_lshlrev_b32 v56, 16, v6
    v_and_b32 v57, 0xffff0000, v6
    v_add_f32 v56, v56, v24
    v_add_f32 v57, v57, v25
    v_cvt_pk_bf16_f32 v12, v56, v57
    v_sub_f32 v58, v58, v5
    v_sub_f32 v59, v59, v5
    v_cvt_pk_bf16_f32 v6, v58, v59
    v_lshlrev_b32 v58, 16, v6
    v_and_b32 v59, 0xffff0000, v6
    v_mul_f32 v58, v58, v7
    v_mul_f32 v59, v59, v7
    v_cvt_pk_bf16_f32 v6, v58, v59
    v_lshlrev_b32 v58, 16, v6
    v_and_b32 v59, 0xffff0000, v6
    v_mul_f32 v58, v58, v42
    v_mul_f32 v59, v59, v43
    v_cvt_pk_bf16_f32 v6, v58, v59
    v_lshlrev_b32 v58, 16, v6
    v_and_b32 v59, 0xffff0000, v6
    v_add_f32 v58, v58, v26
    v_add_f32 v59, v59, v27
    v_cvt_pk_bf16_f32 v13, v58, v59
    v_sub_f32 v60, v60, v5
    v_sub_f32 v61, v61, v5
    v_cvt_pk_bf16_f32 v6, v60, v61
    v_lshlrev_b32 v60, 16, v6
    v_and_b32 v61, 0xffff0000, v6
    v_mul_f32 v60, v60, v7
    v_mul_f32 v61, v61, v7
    v_cvt_pk_bf16_f32 v6, v60, v61
    v_lshlrev_b32 v60, 16, v6
    v_and_b32 v61, 0xffff0000, v6
    v_mul_f32 v60, v60, v44
    v_mul_f32 v61, v61, v45
    v_cvt_pk_bf16_f32 v6, v60, v61
    v_lshlrev_b32 v60, 16, v6
    v_and_b32 v61, 0xffff0000, v6
    v_add_f32 v60, v60, v28
    v_add_f32 v61, v61, v29
    v_cvt_pk_bf16_f32 v14, v60, v61
    v_sub_f32 v62, v62, v5
    v_sub_f32 v63, v63, v5
    v_cvt_pk_bf16_f32 v6, v62, v63
    v_lshlrev_b32 v62, 16, v6
    v_and_b32 v63, 0xffff0000, v6
    v_mul_f32 v62, v62, v7
    v_mul_f32 v63, v63, v7
    v_cvt_pk_bf16_f32 v6, v62, v63
    v_lshlrev_b32 v62, 16, v6
    v_and_b32 v63, 0xffff0000, v6
    v_mul_f32 v62, v62, v46
    v_mul_f32 v63, v63, v47
    v_cvt_pk_bf16_f32 v6, v62, v63
    v_lshlrev_b32 v62, 16, v6
    v_and_b32 v63, 0xffff0000, v6
    v_add_f32 v62, v62, v30
    v_add_f32 v63, v63, v31
    v_cvt_pk_bf16_f32 v15, v62, v63
    buffer_store_dwordx4 v[8:11], v3, s[16:19], 0 offen
    buffer_store_dwordx4 v[12:15], v3, s[16:19], 0 offen offset:1024
ln2_kernel_end:
    s_endpgm
.globl gu_kernel
.p2align 8
.type gu_kernel,@function
gu_kernel:
    s_cmp_ge_u32 s2, 256
    s_cbranch_scc1 gu_kernel_end
    s_load_dwordx2 s[4:5], s[0:1], 88
    s_load_dwordx2 s[6:7], s[0:1], 32
    s_load_dwordx2 s[32:33], s[0:1], 40
    v_lshrrev_b32 v1, 6, v0
    v_and_b32 v0, 63, v0
    s_nop 0
    v_readfirstlane_b32 s30, v1
    s_and_b32 s31, s2, 7
    s_lshr_b32 s36, s2, 3
    s_and_b32 s28, s31, 1
    s_lshr_b32 s29, s31, 1
    s_lshl_b32 s28, s28, 2
    s_and_b32 s37, s36, 3
    s_add_u32 s28, s28, s37
    s_lshl_b32 s29, s29, 3
    s_lshr_b32 s37, s36, 2
    s_add_u32 s29, s29, s37
    v_lshrrev_b32 v1, 3, v0
    v_and_b32 v2, 7, v0
    v_lshrrev_b32 v3, 1, v1
    v_xor_b32 v3, v3, v2
    v_xor_b32 v4, 4, v3
    s_mul_i32 s31, s30, 32
    s_mul_i32 s36, s28, 256
    s_add_u32 s36, s36, s31
    v_add_u32 v1, s36, v1
    s_mov_b32 s37, 2048
    v_mul_lo_u32 v1, v1, s37
    v_lshl_add_u32 v7, v3, 4, v1
    v_lshl_add_u32 v8, v4, 4, v1
    v_add_u32 v8, 16384, v8
    v_lshl_add_u32 v9, v3, 4, v1
    v_add_u32 v9, 32768, v9
    v_lshl_add_u32 v10, v4, 4, v1
    v_add_u32 v10, 49152, v10
    s_and_b32 s31, s30, 3
    s_mul_i32 s31, s31, 4
    s_mul_i32 s38, s29, 224
    s_cmp_ge_u32 s30, 4
    s_cselect_b32 s39, 14464, 0
    s_add_u32 s39, s39, 32768
    s_add_u32 s37, s31, 0
    s_min_u32 s37, s37, 13
    s_lshl_b32 s50, s37, 10
    s_add_u32 s50, s50, s39
    s_lshl_b32 s37, s37, 6
    v_add_u32 v1, s37, v0
    v_mul_u32_u24 v2, 4682, v1
    v_lshrrev_b32 v2, 16, v2
    v_mul_u32_u24 v3, 14, v2
    v_sub_u32 v3, v1, v3
    v_mul_u32_u24 v2, 7168, v2
    v_lshl_add_u32 v2, v3, 4, v2
    v_add_u32 v11, s38, v2
    s_add_u32 s37, s31, 1
    s_min_u32 s37, s37, 13
    s_lshl_b32 s51, s37, 10
    s_add_u32 s51, s51, s39
    s_lshl_b32 s37, s37, 6
    v_add_u32 v1, s37, v0
    v_mul_u32_u24 v2, 4682, v1
    v_lshrrev_b32 v2, 16, v2
    v_mul_u32_u24 v3, 14, v2
    v_sub_u32 v3, v1, v3
    v_mul_u32_u24 v2, 7168, v2
    v_lshl_add_u32 v2, v3, 4, v2
    v_add_u32 v12, s38, v2
    s_add_u32 s37, s31, 2
    s_min_u32 s37, s37, 13
    s_lshl_b32 s52, s37, 10
    s_add_u32 s52, s52, s39
    s_lshl_b32 s37, s37, 6
    v_add_u32 v1, s37, v0
    v_mul_u32_u24 v2, 4682, v1
    v_lshrrev_b32 v2, 16, v2
    v_mul_u32_u24 v3, 14, v2
    v_sub_u32 v3, v1, v3
    v_mul_u32_u24 v2, 7168, v2
    v_lshl_add_u32 v2, v3, 4, v2
    v_add_u32 v13, s38, v2
    s_add_u32 s37, s31, 3
    s_min_u32 s37, s37, 13
    s_lshl_b32 s53, s37, 10
    s_add_u32 s53, s53, s39
    s_lshl_b32 s37, s37, 6
    v_add_u32 v1, s37, v0
    v_mul_u32_u24 v2, 4682, v1
    v_lshrrev_b32 v2, 16, v2
    v_mul_u32_u24 v3, 14, v2
    v_sub_u32 v3, v1, v3
    v_mul_u32_u24 v2, 7168, v2
    v_lshl_add_u32 v2, v3, 4, v2
    v_add_u32 v14, s38, v2
    s_mul_i32 s40, s30, 4096
    s_waitcnt lgkmcnt(0)
    s_add_u32 s8, s4, 26214400
    s_addc_u32 s9, s5, 0
    s_and_b32 s9, s9, 0xffff
    s_mov_b32 s10, 4194304
    s_mov_b32 s11, 0x00020000
    s_cmp_ge_u32 s30, 4
    s_cselect_b32 s6, s32, s6
    s_cselect_b32 s7, s33, s7
    s_mov_b32 s12, s6
    s_and_b32 s13, s7, 0xffff
    s_mov_b32 s14, 7340032
    s_mov_b32 s15, 0x00020000
    s_mov_b32 s42, 0
    s_mov_b32 s43, 0
    s_add_u32 m0, s40, 0
    s_nop 0
    buffer_load_dwordx4 v7, s[8:11], s42 offen lds
    s_add_u32 m0, s40, 1024
    s_nop 0
    buffer_load_dwordx4 v8, s[8:11], s42 offen lds
    s_add_u32 m0, s40, 2048
    s_nop 0
    buffer_load_dwordx4 v9, s[8:11], s42 offen lds
    s_add_u32 m0, s40, 3072
    s_nop 0
    buffer_load_dwordx4 v10, s[8:11], s42 offen lds
    s_add_u32 m0, s50, 0
    s_nop 0
    buffer_load_dwordx4 v11, s[12:15], s43 offen lds
    s_add_u32 m0, s51, 0
    s_nop 0
    buffer_load_dwordx4 v12, s[12:15], s43 offen lds
    s_add_u32 m0, s52, 0
    s_nop 0
    buffer_load_dwordx4 v13, s[12:15], s43 offen lds
    s_add_u32 m0, s53, 0
    s_nop 0
    buffer_load_dwordx4 v14, s[12:15], s43 offen lds
    s_add_u32 s16, s4, 30408704
    s_addc_u32 s17, s5, 0
    s_and_b32 s17, s17, 0xffff
    s_mov_b32 s18, 14680064
    s_mov_b32 s19, 0x00020000
    s_and_b32 s44, s30, 3
    s_lshr_b32 s45, s30, 2
    v_and_b32 v1, 31, v0
    v_lshrrev_b32 v2, 5, v0
    v_bfe_u32 v3, v1, 1, 3
    v_xor_b32 v3, v3, v2
    s_mul_i32 s31, s44, 8192
    v_lshlrev_b32 v4, 7, v1
    v_lshl_add_u32 v4, v3, 4, v4
    v_add_u32 v4, s31, v4
    v_mov_b32 v15, v4
    v_xor_b32 v16, 32, v4
    v_xor_b32 v17, 64, v4
    v_xor_b32 v18, 96, v4
    v_add_u32 v19, 61696, v4
    v_xor_b32 v20, 32, v4
    v_add_u32 v20, 61696, v20
    v_xor_b32 v21, 64, v4
    v_add_u32 v21, 61696, v21
    v_xor_b32 v22, 96, v4
    v_add_u32 v22, 61696, v22
    v_and_b32 v1, 15, v0
    v_bfe_u32 v2, v0, 4, 1
    v_lshrrev_b32 v3, 5, v0
    v_lshrrev_b32 v4, 2, v1
    v_lshl_add_u32 v4, v3, 3, v4
    v_mul_u32_u24 v4, 224, v4
    v_and_b32 v3, 3, v1
    v_lshl_add_u32 v4, v3, 3, v4
    v_mul_u32_u24 v2, 14464, v2
    v_add_u32 v4, v4, v2
    s_mul_i32 s31, s45, 128
    v_add_u32 v4, s31, v4
    v_add_u32 v23, 32768, v4
    v_add_u32 v24, 94464, v4
    s_mov_b32 s42, 128
    s_mov_b32 s43, 458752
    s_add_u32 m0, s40, 61696
    s_nop 0
    buffer_load_dwordx4 v7, s[8:11], s42 offen lds
    s_add_u32 m0, s40, 62720
    s_nop 0
    buffer_load_dwordx4 v8, s[8:11], s42 offen lds
    s_add_u32 m0, s40, 63744
    s_nop 0
    buffer_load_dwordx4 v9, s[8:11], s42 offen lds
    s_add_u32 m0, s40, 64768
    s_nop 0
    buffer_load_dwordx4 v10, s[8:11], s42 offen lds
    s_add_u32 m0, s50, 61696
    s_nop 0
    buffer_load_dwordx4 v11, s[12:15], s43 offen lds
    s_add_u32 m0, s51, 61696
    s_nop 0
    buffer_load_dwordx4 v12, s[12:15], s43 offen lds
    s_add_u32 m0, s52, 61696
    s_nop 0
    buffer_load_dwordx4 v13, s[12:15], s43 offen lds
    s_add_u32 m0, s53, 61696
    s_nop 0
    buffer_load_dwordx4 v14, s[12:15], s43 offen lds
    v_mov_b32 v76, 0
    v_mov_b32 v77, 0
    v_mov_b32 v78, 0
    v_mov_b32 v79, 0
    v_mov_b32 v80, 0
    v_mov_b32 v81, 0
    v_mov_b32 v82, 0
    v_mov_b32 v83, 0
    v_mov_b32 v84, 0
    v_mov_b32 v85, 0
    v_mov_b32 v86, 0
    v_mov_b32 v87, 0
    v_mov_b32 v88, 0
    v_mov_b32 v89, 0
    v_mov_b32 v90, 0
    v_mov_b32 v91, 0
    v_mov_b32 v92, 0
    v_mov_b32 v93, 0
    v_mov_b32 v94, 0
    v_mov_b32 v95, 0
    v_mov_b32 v96, 0
    v_mov_b32 v97, 0
    v_mov_b32 v98, 0
    v_mov_b32 v99, 0
    v_mov_b32 v100, 0
    v_mov_b32 v101, 0
    v_mov_b32 v102, 0
    v_mov_b32 v103, 0
    v_mov_b32 v104, 0
    v_mov_b32 v105, 0
    v_mov_b32 v106, 0
    v_mov_b32 v107, 0
    v_mov_b32 v108, 0
    v_mov_b32 v109, 0
    v_mov_b32 v110, 0
    v_mov_b32 v111, 0
    v_mov_b32 v112, 0
    v_mov_b32 v113, 0
    v_mov_b32 v114, 0
    v_mov_b32 v115, 0
    v_mov_b32 v116, 0
    v_mov_b32 v117, 0
    v_mov_b32 v118, 0
    v_mov_b32 v119, 0
    v_mov_b32 v120, 0
    v_mov_b32 v121, 0
    v_mov_b32 v122, 0
    v_mov_b32 v123, 0
    v_mov_b32 v124, 0
    v_mov_b32 v125, 0
    v_mov_b32 v126, 0
    v_mov_b32 v127, 0
    v_mov_b32 v128, 0
    v_mov_b32 v129, 0
    v_mov_b32 v130, 0
    v_mov_b32 v131, 0
    v_mov_b32 v132, 0
    v_mov_b32 v133, 0
    v_mov_b32 v134, 0
    v_mov_b32 v135, 0
    v_mov_b32 v136, 0
    v_mov_b32 v137, 0
    v_mov_b32 v138, 0
    v_mov_b32 v139, 0
    v_mov_b32 v140, 0
    v_mov_b32 v141, 0
    v_mov_b32 v142, 0
    v_mov_b32 v143, 0
    v_mov_b32 v144, 0
    v_mov_b32 v145, 0
    v_mov_b32 v146, 0
    v_mov_b32 v147, 0
    v_mov_b32 v148, 0
    v_mov_b32 v149, 0
    v_mov_b32 v150, 0
    v_mov_b32 v151, 0
    v_mov_b32 v152, 0
    v_mov_b32 v153, 0
    v_mov_b32 v154, 0
    v_mov_b32 v155, 0
    v_mov_b32 v156, 0
    v_mov_b32 v157, 0
    v_mov_b32 v158, 0
    v_mov_b32 v159, 0
    v_mov_b32 v160, 0
    v_mov_b32 v161, 0
    v_mov_b32 v162, 0
    v_mov_b32 v163, 0
    v_mov_b32 v164, 0
    v_mov_b32 v165, 0
    v_mov_b32 v166, 0
    v_mov_b32 v167, 0
    v_mov_b32 v168, 0
    v_mov_b32 v169, 0
    v_mov_b32 v170, 0
    v_mov_b32 v171, 0
    v_mov_b32 v172, 0
    v_mov_b32 v173, 0
    v_mov_b32 v174, 0
    v_mov_b32 v175, 0
    v_mov_b32 v176, 0
    v_mov_b32 v177, 0
    v_mov_b32 v178, 0
    v_mov_b32 v179, 0
    v_mov_b32 v180, 0
    v_mov_b32 v181, 0
    v_mov_b32 v182, 0
    v_mov_b32 v183, 0
    v_mov_b32 v184, 0
    v_mov_b32 v185, 0
    v_mov_b32 v186, 0
    v_mov_b32 v187, 0
    v_mov_b32 v188, 0
    v_mov_b32 v189, 0
    v_mov_b32 v190, 0
    v_mov_b32 v191, 0
    v_mov_b32 v192, 0
    v_mov_b32 v193, 0
    v_mov_b32 v194, 0
    v_mov_b32 v195, 0
    v_mov_b32 v196, 0
    v_mov_b32 v197, 0
    v_mov_b32 v198, 0
    v_mov_b32 v199, 0
    v_mov_b32 v200, 0
    v_mov_b32 v201, 0
    v_mov_b32 v202, 0
    v_mov_b32 v203, 0
    s_cmp_lg_u32 s45, 0
    s_cbranch_scc1 gu_kernel_grp1
    s_waitcnt vmcnt(8)
    s_barrier
    ds_read_b128 v[28:31], v15 offset:0
    ds_read_b128 v[32:35], v15 offset:4096
    ds_read_b64_tr_b16 v[36:37], v23 offset:0
    ds_read_b64_tr_b16 v[38:39], v23 offset:896
    ds_read_b64_tr_b16 v[40:41], v23 offset:32
    ds_read_b64_tr_b16 v[42:43], v23 offset:928
    ds_read_b64_tr_b16 v[44:45], v23 offset:64
    ds_read_b64_tr_b16 v[46:47], v23 offset:960
    ds_read_b64_tr_b16 v[48:49], v23 offset:96
    ds_read_b64_tr_b16 v[50:51], v23 offset:992
    s_mov_b32 s42, 256
    s_mov_b32 s43, 917504
    s_mov_b32 s47, 7
.p2align 6
gu_kernel_loopg0:
    s_waitcnt lgkmcnt(0)
    v_mfma_f32_32x32x16_bf16 v[76:91], v[36:39], v[28:31], v[76:91]
    ds_read_b128 v[52:55], v16 offset:0
    ds_read_b128 v[56:59], v16 offset:4096
    v_mfma_f32_32x32x16_bf16 v[140:155], v[36:39], v[32:35], v[140:155]
    ds_read_b64_tr_b16 v[60:61], v23 offset:3584
    v_mfma_f32_32x32x16_bf16 v[92:107], v[40:43], v[28:31], v[92:107]
    ds_read_b64_tr_b16 v[62:63], v23 offset:4480
    v_mfma_f32_32x32x16_bf16 v[156:171], v[40:43], v[32:35], v[156:171]
    ds_read_b64_tr_b16 v[64:65], v23 offset:3616
    v_mfma_f32_32x32x16_bf16 v[108:123], v[44:47], v[28:31], v[108:123]
    ds_read_b64_tr_b16 v[66:67], v23 offset:4512
    ds_read_b64_tr_b16 v[68:69], v23 offset:3648
    v_mfma_f32_32x32x16_bf16 v[172:187], v[44:47], v[32:35], v[172:187]
    ds_read_b64_tr_b16 v[70:71], v23 offset:4544
    v_mfma_f32_32x32x16_bf16 v[124:139], v[48:51], v[28:31], v[124:139]
    ds_read_b64_tr_b16 v[72:73], v23 offset:3680
    v_mfma_f32_32x32x16_bf16 v[188:203], v[48:51], v[32:35], v[188:203]
    ds_read_b64_tr_b16 v[74:75], v23 offset:4576
    s_waitcnt lgkmcnt(0)
    v_mfma_f32_32x32x16_bf16 v[76:91], v[60:63], v[52:55], v[76:91]
    ds_read_b128 v[28:31], v17 offset:0
    ds_read_b128 v[32:35], v17 offset:4096
    v_mfma_f32_32x32x16_bf16 v[140:155], v[60:63], v[56:59], v[140:155]
    ds_read_b64_tr_b16 v[36:37], v23 offset:7168
    v_mfma_f32_32x32x16_bf16 v[92:107], v[64:67], v[52:55], v[92:107]
    ds_read_b64_tr_b16 v[38:39], v23 offset:8064
    v_mfma_f32_32x32x16_bf16 v[156:171], v[64:67], v[56:59], v[156:171]
    ds_read_b64_tr_b16 v[40:41], v23 offset:7200
    v_mfma_f32_32x32x16_bf16 v[108:123], v[68:71], v[52:55], v[108:123]
    ds_read_b64_tr_b16 v[42:43], v23 offset:8096
    ds_read_b64_tr_b16 v[44:45], v23 offset:7232
    v_mfma_f32_32x32x16_bf16 v[172:187], v[68:71], v[56:59], v[172:187]
    ds_read_b64_tr_b16 v[46:47], v23 offset:8128
    v_mfma_f32_32x32x16_bf16 v[124:139], v[72:75], v[52:55], v[124:139]
    ds_read_b64_tr_b16 v[48:49], v23 offset:7264
    v_mfma_f32_32x32x16_bf16 v[188:203], v[72:75], v[56:59], v[188:203]
    ds_read_b64_tr_b16 v[50:51], v23 offset:8160
    s_waitcnt lgkmcnt(0)
    v_mfma_f32_32x32x16_bf16 v[76:91], v[36:39], v[28:31], v[76:91]
    ds_read_b128 v[52:55], v18 offset:0
    ds_read_b128 v[56:59], v18 offset:4096
    v_mfma_f32_32x32x16_bf16 v[140:155], v[36:39], v[32:35], v[140:155]
    ds_read_b64_tr_b16 v[60:61], v23 offset:10752
    v_mfma_f32_32x32x16_bf16 v[92:107], v[40:43], v[28:31], v[92:107]
    ds_read_b64_tr_b16 v[62:63], v23 offset:11648
    v_mfma_f32_32x32x16_bf16 v[156:171], v[40:43], v[32:35], v[156:171]
    ds_read_b64_tr_b16 v[64:65], v23 offset:10784
    v_mfma_f32_32x32x16_bf16 v[108:123], v[44:47], v[28:31], v[108:123]
    ds_read_b64_tr_b16 v[66:67], v23 offset:11680
    ds_read_b64_tr_b16 v[68:69], v23 offset:10816
    v_mfma_f32_32x32x16_bf16 v[172:187], v[44:47], v[32:35], v[172:187]
    ds_read_b64_tr_b16 v[70:71], v23 offset:11712
    v_mfma_f32_32x32x16_bf16 v[124:139], v[48:51], v[28:31], v[124:139]
    ds_read_b64_tr_b16 v[72:73], v23 offset:10848
    v_mfma_f32_32x32x16_bf16 v[188:203], v[48:51], v[32:35], v[188:203]
    ds_read_b64_tr_b16 v[74:75], v23 offset:11744
    s_waitcnt vmcnt(0) lgkmcnt(0)
    s_barrier
    v_mfma_f32_32x32x16_bf16 v[76:91], v[60:63], v[52:55], v[76:91]
    ds_read_b128 v[28:31], v19 offset:0
    ds_read_b128 v[32:35], v19 offset:4096
    ds_read_b64_tr_b16 v[36:37], v24 offset:0
    v_mfma_f32_32x32x16_bf16 v[140:155], v[60:63], v[56:59], v[140:155]
    ds_read_b64_tr_b16 v[38:39], v24 offset:896
    ds_read_b64_tr_b16 v[40:41], v24 offset:32
    v_mfma_f32_32x32x16_bf16 v[92:107], v[64:67], v[52:55], v[92:107]
    ds_read_b64_tr_b16 v[42:43], v24 offset:928
    ds_read_b64_tr_b16 v[44:45], v24 offset:64
    ds_read_b64_tr_b16 v[46:47], v24 offset:960
    v_mfma_f32_32x32x16_bf16 v[156:171], v[64:67], v[56:59], v[156:171]
    ds_read_b64_tr_b16 v[48:49], v24 offset:96
    ds_read_b64_tr_b16 v[50:51], v24 offset:992
    v_mfma_f32_32x32x16_bf16 v[108:123], v[68:71], v[52:55], v[108:123]
    s_add_u32 m0, s40, 0
    s_nop 0
    buffer_load_dwordx4 v7, s[8:11], s42 offen lds
    s_add_u32 m0, s40, 1024
    s_nop 0
    buffer_load_dwordx4 v8, s[8:11], s42 offen lds
    v_mfma_f32_32x32x16_bf16 v[172:187], v[68:71], v[56:59], v[172:187]
    s_add_u32 m0, s40, 2048
    s_nop 0
    buffer_load_dwordx4 v9, s[8:11], s42 offen lds
    s_add_u32 m0, s40, 3072
    s_nop 0
    buffer_load_dwordx4 v10, s[8:11], s42 offen lds
    s_add_u32 m0, s50, 0
    s_nop 0
    buffer_load_dwordx4 v11, s[12:15], s43 offen lds
    v_mfma_f32_32x32x16_bf16 v[124:139], v[72:75], v[52:55], v[124:139]
    s_add_u32 m0, s51, 0
    s_nop 0
    buffer_load_dwordx4 v12, s[12:15], s43 offen lds
    s_add_u32 m0, s52, 0
    s_nop 0
    buffer_load_dwordx4 v13, s[12:15], s43 offen lds
    v_mfma_f32_32x32x16_bf16 v[188:203], v[72:75], v[56:59], v[188:203]
    s_add_u32 m0, s53, 0
    s_nop 0
    buffer_load_dwordx4 v14, s[12:15], s43 offen lds
    s_add_u32 s42, s42, 128
    s_add_u32 s43, s43, 458752
    s_waitcnt lgkmcnt(0)
    v_mfma_f32_32x32x16_bf16 v[76:91], v[36:39], v[28:31], v[76:91]
    ds_read_b128 v[52:55], v20 offset:0
    ds_read_b128 v[56:59], v20 offset:4096
    v_mfma_f32_32x32x16_bf16 v[140:155], v[36:39], v[32:35], v[140:155]
    ds_read_b64_tr_b16 v[60:61], v24 offset:3584
    v_mfma_f32_32x32x16_bf16 v[92:107], v[40:43], v[28:31], v[92:107]
    ds_read_b64_tr_b16 v[62:63], v24 offset:4480
    v_mfma_f32_32x32x16_bf16 v[156:171], v[40:43], v[32:35], v[156:171]
    ds_read_b64_tr_b16 v[64:65], v24 offset:3616
    v_mfma_f32_32x32x16_bf16 v[108:123], v[44:47], v[28:31], v[108:123]
    ds_read_b64_tr_b16 v[66:67], v24 offset:4512
    ds_read_b64_tr_b16 v[68:69], v24 offset:3648
    v_mfma_f32_32x32x16_bf16 v[172:187], v[44:47], v[32:35], v[172:187]
    ds_read_b64_tr_b16 v[70:71], v24 offset:4544
    v_mfma_f32_32x32x16_bf16 v[124:139], v[48:51], v[28:31], v[124:139]
    ds_read_b64_tr_b16 v[72:73], v24 offset:3680
    v_mfma_f32_32x32x16_bf16 v[188:203], v[48:51], v[32:35], v[188:203]
    ds_read_b64_tr_b16 v[74:75], v24 offset:4576
    s_waitcnt lgkmcnt(0)
    v_mfma_f32_32x32x16_bf16 v[76:91], v[60:63], v[52:55], v[76:91]
    ds_read_b128 v[28:31], v21 offset:0
    ds_read_b128 v[32:35], v21 offset:4096
    v_mfma_f32_32x32x16_bf16 v[140:155], v[60:63], v[56:59], v[140:155]
    ds_read_b64_tr_b16 v[36:37], v24 offset:7168
    v_mfma_f32_32x32x16_bf16 v[92:107], v[64:67], v[52:55], v[92:107]
    ds_read_b64_tr_b16 v[38:39], v24 offset:8064
    v_mfma_f32_32x32x16_bf16 v[156:171], v[64:67], v[56:59], v[156:171]
    ds_read_b64_tr_b16 v[40:41], v24 offset:7200
    v_mfma_f32_32x32x16_bf16 v[108:123], v[68:71], v[52:55], v[108:123]
    ds_read_b64_tr_b16 v[42:43], v24 offset:8096
    ds_read_b64_tr_b16 v[44:45], v24 offset:7232
    v_mfma_f32_32x32x16_bf16 v[172:187], v[68:71], v[56:59], v[172:187]
    ds_read_b64_tr_b16 v[46:47], v24 offset:8128
    v_mfma_f32_32x32x16_bf16 v[124:139], v[72:75], v[52:55], v[124:139]
    ds_read_b64_tr_b16 v[48:49], v24 offset:7264
    v_mfma_f32_32x32x16_bf16 v[188:203], v[72:75], v[56:59], v[188:203]
    ds_read_b64_tr_b16 v[50:51], v24 offset:8160
    s_waitcnt lgkmcnt(0)
    v_mfma_f32_32x32x16_bf16 v[76:91], v[36:39], v[28:31], v[76:91]
    ds_read_b128 v[52:55], v22 offset:0
    ds_read_b128 v[56:59], v22 offset:4096
    v_mfma_f32_32x32x16_bf16 v[140:155], v[36:39], v[32:35], v[140:155]
    ds_read_b64_tr_b16 v[60:61], v24 offset:10752
    v_mfma_f32_32x32x16_bf16 v[92:107], v[40:43], v[28:31], v[92:107]
    ds_read_b64_tr_b16 v[62:63], v24 offset:11648
    v_mfma_f32_32x32x16_bf16 v[156:171], v[40:43], v[32:35], v[156:171]
    ds_read_b64_tr_b16 v[64:65], v24 offset:10784
    v_mfma_f32_32x32x16_bf16 v[108:123], v[44:47], v[28:31], v[108:123]
    ds_read_b64_tr_b16 v[66:67], v24 offset:11680
    ds_read_b64_tr_b16 v[68:69], v24 offset:10816
    v_mfma_f32_32x32x16_bf16 v[172:187], v[44:47], v[32:35], v[172:187]
    ds_read_b64_tr_b16 v[70:71], v24 offset:11712
    v_mfma_f32_32x32x16_bf16 v[124:139], v[48:51], v[28:31], v[124:139]
    ds_read_b64_tr_b16 v[72:73], v24 offset:10848
    v_mfma_f32_32x32x16_bf16 v[188:203], v[48:51], v[32:35], v[188:203]
    ds_read_b64_tr_b16 v[74:75], v24 offset:11744
    s_waitcnt vmcnt(0) lgkmcnt(0)
    s_barrier
    v_mfma_f32_32x32x16_bf16 v[76:91], v[60:63], v[52:55], v[76:91]
    ds_read_b128 v[28:31], v15 offset:0
    ds_read_b128 v[32:35], v15 offset:4096
    ds_read_b64_tr_b16 v[36:37], v23 offset:0
    v_mfma_f32_32x32x16_bf16 v[140:155], v[60:63], v[56:59], v[140:155]
    ds_read_b64_tr_b16 v[38:39], v23 offset:896
    ds_read_b64_tr_b16 v[40:41], v23 offset:32
    v_mfma_f32_32x32x16_bf16 v[92:107], v[64:67], v[52:55], v[92:107]
    ds_read_b64_tr_b16 v[42:43], v23 offset:928
    ds_read_b64_tr_b16 v[44:45], v23 offset:64
    ds_read_b64_tr_b16 v[46:47], v23 offset:960
    v_mfma_f32_32x32x16_bf16 v[156:171], v[64:67], v[56:59], v[156:171]
    ds_read_b64_tr_b16 v[48:49], v23 offset:96
    ds_read_b64_tr_b16 v[50:51], v23 offset:992
    v_mfma_f32_32x32x16_bf16 v[108:123], v[68:71], v[52:55], v[108:123]
    s_add_u32 m0, s40, 61696
    s_nop 0
    buffer_load_dwordx4 v7, s[8:11], s42 offen lds
    s_add_u32 m0, s40, 62720
    s_nop 0
    buffer_load_dwordx4 v8, s[8:11], s42 offen lds
    v_mfma_f32_32x32x16_bf16 v[172:187], v[68:71], v[56:59], v[172:187]
    s_add_u32 m0, s40, 63744
    s_nop 0
    buffer_load_dwordx4 v9, s[8:11], s42 offen lds
    s_add_u32 m0, s40, 64768
    s_nop 0
    buffer_load_dwordx4 v10, s[8:11], s42 offen lds
    s_add_u32 m0, s50, 61696
    s_nop 0
    buffer_load_dwordx4 v11, s[12:15], s43 offen lds
    v_mfma_f32_32x32x16_bf16 v[124:139], v[72:75], v[52:55], v[124:139]
    s_add_u32 m0, s51, 61696
    s_nop 0
    buffer_load_dwordx4 v12, s[12:15], s43 offen lds
    s_add_u32 m0, s52, 61696
    s_nop 0
    buffer_load_dwordx4 v13, s[12:15], s43 offen lds
    v_mfma_f32_32x32x16_bf16 v[188:203], v[72:75], v[56:59], v[188:203]
    s_add_u32 m0, s53, 61696
    s_nop 0
    buffer_load_dwordx4 v14, s[12:15], s43 offen lds
    s_add_u32 s42, s42, 128
    s_add_u32 s43, s43, 458752
    s_sub_u32 s47, s47, 1
    s_cmp_lg_u32 s47, 0
    s_cbranch_scc1 gu_kernel_loopg0
    s_waitcnt lgkmcnt(0)
    v_mfma_f32_32x32x16_bf16 v[76:91], v[36:39], v[28:31], v[76:91]
    ds_read_b128 v[52:55], v16 offset:0
    ds_read_b128 v[56:59], v16 offset:4096
    v_mfma_f32_32x32x16_bf16 v[140:155], v[36:39], v[32:35], v[140:155]
    ds_read_b64_tr_b16 v[60:61], v23 offset:3584
    v_mfma_f32_32x32x16_bf16 v[92:107], v[40:43], v[28:31], v[92:107]
    ds_read_b64_tr_b16 v[62:63], v23 offset:4480
    v_mfma_f32_32x32x16_bf16 v[156:171], v[40:43], v[32:35], v[156:171]
    ds_read_b64_tr_b16 v[64:65], v23 offset:3616
    v_mfma_f32_32x32x16_bf16 v[108:123], v[44:47], v[28:31], v[108:123]
    ds_read_b64_tr_b16 v[66:67], v23 offset:4512
    ds_read_b64_tr_b16 v[68:69], v23 offset:3648
    v_mfma_f32_32x32x16_bf16 v[172:187], v[44:47], v[32:35], v[172:187]
    ds_read_b64_tr_b16 v[70:71], v23 offset:4544
    v_mfma_f32_32x32x16_bf16 v[124:139], v[48:51], v[28:31], v[124:139]
    ds_read_b64_tr_b16 v[72:73], v23 offset:3680
    v_mfma_f32_32x32x16_bf16 v[188:203], v[48:51], v[32:35], v[188:203]
    ds_read_b64_tr_b16 v[74:75], v23 offset:4576
    s_waitcnt lgkmcnt(0)
    v_mfma_f32_32x32x16_bf16 v[76:91], v[60:63], v[52:55], v[76:91]
    ds_read_b128 v[28:31], v17 offset:0
    ds_read_b128 v[32:35], v17 offset:4096
    v_mfma_f32_32x32x16_bf16 v[140:155], v[60:63], v[56:59], v[140:155]
    ds_read_b64_tr_b16 v[36:37], v23 offset:7168
    v_mfma_f32_32x32x16_bf16 v[92:107], v[64:67], v[52:55], v[92:107]
    ds_read_b64_tr_b16 v[38:39], v23 offset:8064
    v_mfma_f32_32x32x16_bf16 v[156:171], v[64:67], v[56:59], v[156:171]
    ds_read_b64_tr_b16 v[40:41], v23 offset:7200
    v_mfma_f32_32x32x16_bf16 v[108:123], v[68:71], v[52:55], v[108:123]
    ds_read_b64_tr_b16 v[42:43], v23 offset:8096
    ds_read_b64_tr_b16 v[44:45], v23 offset:7232
    v_mfma_f32_32x32x16_bf16 v[172:187], v[68:71], v[56:59], v[172:187]
    ds_read_b64_tr_b16 v[46:47], v23 offset:8128
    v_mfma_f32_32x32x16_bf16 v[124:139], v[72:75], v[52:55], v[124:139]
    ds_read_b64_tr_b16 v[48:49], v23 offset:7264
    v_mfma_f32_32x32x16_bf16 v[188:203], v[72:75], v[56:59], v[188:203]
    ds_read_b64_tr_b16 v[50:51], v23 offset:8160
    s_waitcnt lgkmcnt(0)
    v_mfma_f32_32x32x16_bf16 v[76:91], v[36:39], v[28:31], v[76:91]
    ds_read_b128 v[52:55], v18 offset:0
    ds_read_b128 v[56:59], v18 offset:4096
    v_mfma_f32_32x32x16_bf16 v[140:155], v[36:39], v[32:35], v[140:155]
    ds_read_b64_tr_b16 v[60:61], v23 offset:10752
    v_mfma_f32_32x32x16_bf16 v[92:107], v[40:43], v[28:31], v[92:107]
    ds_read_b64_tr_b16 v[62:63], v23 offset:11648
    v_mfma_f32_32x32x16_bf16 v[156:171], v[40:43], v[32:35], v[156:171]
    ds_read_b64_tr_b16 v[64:65], v23 offset:10784
    v_mfma_f32_32x32x16_bf16 v[108:123], v[44:47], v[28:31], v[108:123]
    ds_read_b64_tr_b16 v[66:67], v23 offset:11680
    ds_read_b64_tr_b16 v[68:69], v23 offset:10816
    v_mfma_f32_32x32x16_bf16 v[172:187], v[44:47], v[32:35], v[172:187]
    ds_read_b64_tr_b16 v[70:71], v23 offset:11712
    v_mfma_f32_32x32x16_bf16 v[124:139], v[48:51], v[28:31], v[124:139]
    ds_read_b64_tr_b16 v[72:73], v23 offset:10848
    v_mfma_f32_32x32x16_bf16 v[188:203], v[48:51], v[32:35], v[188:203]
    ds_read_b64_tr_b16 v[74:75], v23 offset:11744
    s_waitcnt vmcnt(0) lgkmcnt(0)
    s_barrier
    v_mfma_f32_32x32x16_bf16 v[76:91], v[60:63], v[52:55], v[76:91]
    ds_read_b128 v[28:31], v19 offset:0
    ds_read_b128 v[32:35], v19 offset:4096
    v_mfma_f32_32x32x16_bf16 v[140:155], v[60:63], v[56:59], v[140:155]
    ds_read_b64_tr_b16 v[36:37], v24 offset:0
    v_mfma_f32_32x32x16_bf16 v[92:107], v[64:67], v[52:55], v[92:107]
    ds_read_b64_tr_b16 v[38:39], v24 offset:896
    v_mfma_f32_32x32x16_bf16 v[156:171], v[64:67], v[56:59], v[156:171]
    ds_read_b64_tr_b16 v[40:41], v24 offset:32
    v_mfma_f32_32x32x16_bf16 v[108:123], v[68:71], v[52:55], v[108:123]
    ds_read_b64_tr_b16 v[42:43], v24 offset:928
    ds_read_b64_tr_b16 v[44:45], v24 offset:64
    v_mfma_f32_32x32x16_bf16 v[172:187], v[68:71], v[56:59], v[172:187]
    ds_read_b64_tr_b16 v[46:47], v24 offset:960
    v_mfma_f32_32x32x16_bf16 v[124:139], v[72:75], v[52:55], v[124:139]
    ds_read_b64_tr_b16 v[48:49], v24 offset:96
    v_mfma_f32_32x32x16_bf16 v[188:203], v[72:75], v[56:59], v[188:203]
    ds_read_b64_tr_b16 v[50:51], v24 offset:992
    s_waitcnt lgkmcnt(0)
    v_mfma_f32_32x32x16_bf16 v[76:91], v[36:39], v[28:31], v[76:91]
    ds_read_b128 v[52:55], v20 offset:0
    ds_read_b128 v[56:59], v20 offset:4096
    v_mfma_f32_32x32x16_bf16 v[140:155], v[36:39], v[32:35], v[140:155]
    ds_read_b64_tr_b16 v[60:61], v24 offset:3584
    v_mfma_f32_32x32x16_bf16 v[92:107], v[40:43], v[28:31], v[92:107]
    ds_read_b64_tr_b16 v[62:63], v24 offset:4480
    v_mfma_f32_32x32x16_bf16 v[156:171], v[40:43], v[32:35], v[156:171]
    ds_read_b64_tr_b16 v[64:65], v24 offset:3616
    v_mfma_f32_32x32x16_bf16 v[108:123], v[44:47], v[28:31], v[108:123]
    ds_read_b64_tr_b16 v[66:67], v24 offset:4512
    ds_read_b64_tr_b16 v[68:69], v24 offset:3648
    v_mfma_f32_32x32x16_bf16 v[172:187], v[44:47], v[32:35], v[172:187]
    ds_read_b64_tr_b16 v[70:71], v24 offset:4544
    v_mfma_f32_32x32x16_bf16 v[124:139], v[48:51], v[28:31], v[124:139]
    ds_read_b64_tr_b16 v[72:73], v24 offset:3680
    v_mfma_f32_32x32x16_bf16 v[188:203], v[48:51], v[32:35], v[188:203]
    ds_read_b64_tr_b16 v[74:75], v24 offset:4576
    s_waitcnt lgkmcnt(0)
    v_mfma_f32_32x32x16_bf16 v[76:91], v[60:63], v[52:55], v[76:91]
    ds_read_b128 v[28:31], v21 offset:0
    ds_read_b128 v[32:35], v21 offset:4096
    v_mfma_f32_32x32x16_bf16 v[140:155], v[60:63], v[56:59], v[140:155]
    ds_read_b64_tr_b16 v[36:37], v24 offset:7168
    v_mfma_f32_32x32x16_bf16 v[92:107], v[64:67], v[52:55], v[92:107]
    ds_read_b64_tr_b16 v[38:39], v24 offset:8064
    v_mfma_f32_32x32x16_bf16 v[156:171], v[64:67], v[56:59], v[156:171]
    ds_read_b64_tr_b16 v[40:41], v24 offset:7200
    v_mfma_f32_32x32x16_bf16 v[108:123], v[68:71], v[52:55], v[108:123]
    ds_read_b64_tr_b16 v[42:43], v24 offset:8096
    ds_read_b64_tr_b16 v[44:45], v24 offset:7232
    v_mfma_f32_32x32x16_bf16 v[172:187], v[68:71], v[56:59], v[172:187]
    ds_read_b64_tr_b16 v[46:47], v24 offset:8128
    v_mfma_f32_32x32x16_bf16 v[124:139], v[72:75], v[52:55], v[124:139]
    ds_read_b64_tr_b16 v[48:49], v24 offset:7264
    v_mfma_f32_32x32x16_bf16 v[188:203], v[72:75], v[56:59], v[188:203]
    ds_read_b64_tr_b16 v[50:51], v24 offset:8160
    s_waitcnt lgkmcnt(0)
    v_mfma_f32_32x32x16_bf16 v[76:91], v[36:39], v[28:31], v[76:91]
    ds_read_b128 v[52:55], v22 offset:0
    ds_read_b128 v[56:59], v22 offset:4096
    v_mfma_f32_32x32x16_bf16 v[140:155], v[36:39], v[32:35], v[140:155]
    ds_read_b64_tr_b16 v[60:61], v24 offset:10752
    v_mfma_f32_32x32x16_bf16 v[92:107], v[40:43], v[28:31], v[92:107]
    ds_read_b64_tr_b16 v[62:63], v24 offset:11648
    v_mfma_f32_32x32x16_bf16 v[156:171], v[40:43], v[32:35], v[156:171]
    ds_read_b64_tr_b16 v[64:65], v24 offset:10784
    v_mfma_f32_32x32x16_bf16 v[108:123], v[44:47], v[28:31], v[108:123]
    ds_read_b64_tr_b16 v[66:67], v24 offset:11680
    ds_read_b64_tr_b16 v[68:69], v24 offset:10816
    v_mfma_f32_32x32x16_bf16 v[172:187], v[44:47], v[32:35], v[172:187]
    ds_read_b64_tr_b16 v[70:71], v24 offset:11712
    v_mfma_f32_32x32x16_bf16 v[124:139], v[48:51], v[28:31], v[124:139]
    ds_read_b64_tr_b16 v[72:73], v24 offset:10848
    v_mfma_f32_32x32x16_bf16 v[188:203], v[48:51], v[32:35], v[188:203]
    ds_read_b64_tr_b16 v[74:75], v24 offset:11744
    s_waitcnt lgkmcnt(0)
    v_mfma_f32_32x32x16_bf16 v[76:91], v[60:63], v[52:55], v[76:91]
    v_mfma_f32_32x32x16_bf16 v[140:155], v[60:63], v[56:59], v[140:155]
    v_mfma_f32_32x32x16_bf16 v[92:107], v[64:67], v[52:55], v[92:107]
    v_mfma_f32_32x32x16_bf16 v[156:171], v[64:67], v[56:59], v[156:171]
    v_mfma_f32_32x32x16_bf16 v[108:123], v[68:71], v[52:55], v[108:123]
    v_mfma_f32_32x32x16_bf16 v[172:187], v[68:71], v[56:59], v[172:187]
    v_mfma_f32_32x32x16_bf16 v[124:139], v[72:75], v[52:55], v[124:139]
    v_mfma_f32_32x32x16_bf16 v[188:203], v[72:75], v[56:59], v[188:203]
    v_and_b32 v1, 31, v0
    v_lshrrev_b32 v2, 5, v0
    s_mul_i32 s36, s28, 256
    s_mul_i32 s31, s44, 64
    s_add_u32 s36, s36, s31
    v_add_u32 v1, s36, v1
    s_mov_b32 s37, 7168
    v_mul_lo_u32 v3, v1, s37
    v_lshl_add_u32 v3, v2, 4, v3
    s_mul_i32 s37, s29, 224
    v_add_u32 v3, s37, v3
    s_mov_b32 s46, 229376
    s_nop 15
    v_cvt_pk_bf16_f32 v44, v76, v77
    v_cvt_pk_bf16_f32 v45, v78, v79
    v_cvt_pk_bf16_f32 v46, v80, v81
    v_cvt_pk_bf16_f32 v47, v82, v83
    v_cvt_pk_bf16_f32 v48, v84, v85
    v_cvt_pk_bf16_f32 v49, v86, v87
    v_cvt_pk_bf16_f32 v50, v88, v89
    v_cvt_pk_bf16_f32 v51, v90, v91
    v_lshlrev_b32 v76, 16, v44
    v_and_b32 v77, 0xffff0000, v44
    v_lshlrev_b32 v78, 16, v45
    v_and_b32 v79, 0xffff0000, v45
    v_lshlrev_b32 v80, 16, v46
    v_and_b32 v81, 0xffff0000, v46
    v_lshlrev_b32 v82, 16, v47
    v_and_b32 v83, 0xffff0000, v47
    v_lshlrev_b32 v84, 16, v48
    v_and_b32 v85, 0xffff0000, v48
    v_lshlrev_b32 v86, 16, v49
    v_and_b32 v87, 0xffff0000, v49
    v_lshlrev_b32 v88, 16, v50
    v_and_b32 v89, 0xffff0000, v50
    v_lshlrev_b32 v90, 16, v51
    v_and_b32 v91, 0xffff0000, v51
    v_mul_f32 v76, v76, v84
    v_mul_f32 v77, v77, v85
    v_mul_f32 v78, v78, v86
    v_mul_f32 v79, v79, v87
    v_mul_f32 v80, v80, v88
    v_mul_f32 v81, v81, v89
    v_mul_f32 v82, v82, v90
    v_mul_f32 v83, v83, v91
    v_cvt_pk_bf16_f32 v52, v76, v77
    v_cvt_pk_bf16_f32 v53, v78, v79
    v_cvt_pk_bf16_f32 v54, v80, v81
    v_cvt_pk_bf16_f32 v55, v82, v83
    s_nop 1
    v_permlane32_swap_b32 v52, v54
    v_permlane32_swap_b32 v53, v55
    buffer_store_dwordx4 v[52:55], v3, s[16:19], 0 offen offset:0
    v_cvt_pk_bf16_f32 v44, v92, v93
    v_cvt_pk_bf16_f32 v45, v94, v95
    v_cvt_pk_bf16_f32 v46, v96, v97
    v_cvt_pk_bf16_f32 v47, v98, v99
    v_cvt_pk_bf16_f32 v48, v100, v101
    v_cvt_pk_bf16_f32 v49, v102, v103
    v_cvt_pk_bf16_f32 v50, v104, v105
    v_cvt_pk_bf16_f32 v51, v106, v107
    v_lshlrev_b32 v92, 16, v44
    v_and_b32 v93, 0xffff0000, v44
    v_lshlrev_b32 v94, 16, v45
    v_and_b32 v95, 0xffff0000, v45
    v_lshlrev_b32 v96, 16, v46
    v_and_b32 v97, 0xffff0000, v46
    v_lshlrev_b32 v98, 16, v47
    v_and_b32 v99, 0xffff0000, v47
    v_lshlrev_b32 v100, 16, v48
    v_and_b32 v101, 0xffff0000, v48
    v_lshlrev_b32 v102, 16, v49
    v_and_b32 v103, 0xffff0000, v49
    v_lshlrev_b32 v104, 16, v50
    v_and_b32 v105, 0xffff0000, v50
    v_lshlrev_b32 v106, 16, v51
    v_and_b32 v107, 0xffff0000, v51
    v_mul_f32 v92, v92, v100
    v_mul_f32 v93, v93, v101
    v_mul_f32 v94, v94, v102
    v_mul_f32 v95, v95, v103
    v_mul_f32 v96, v96, v104
    v_mul_f32 v97, v97, v105
    v_mul_f32 v98, v98, v106
    v_mul_f32 v99, v99, v107
    v_cvt_pk_bf16_f32 v56, v92, v93
    v_cvt_pk_bf16_f32 v57, v94, v95
    v_cvt_pk_bf16_f32 v58, v96, v97
    v_cvt_pk_bf16_f32 v59, v98, v99
    s_nop 1
    v_permlane32_swap_b32 v56, v58
    v_permlane32_swap_b32 v57, v59
    buffer_store_dwordx4 v[56:59], v3, s[16:19], 0 offen offset:32
    v_cvt_pk_bf16_f32 v44, v108, v109
    v_cvt_pk_bf16_f32 v45, v110, v111
    v_cvt_pk_bf16_f32 v46, v112, v113
    v_cvt_pk_bf16_f32 v47, v114, v115
    v_cvt_pk_bf16_f32 v48, v116, v117
    v_cvt_pk_bf16_f32 v49, v118, v119
    v_cvt_pk_bf16_f32 v50, v120, v121
    v_cvt_pk_bf16_f32 v51, v122, v123
    v_lshlrev_b32 v108, 16, v44
    v_and_b32 v109, 0xffff0000, v44
    v_lshlrev_b32 v110, 16, v45
    v_and_b32 v111, 0xffff0000, v45
    v_lshlrev_b32 v112, 16, v46
    v_and_b32 v113, 0xffff0000, v46
    v_lshlrev_b32 v114, 16, v47
    v_and_b32 v115, 0xffff0000, v47
    v_lshlrev_b32 v116, 16, v48
    v_and_b32 v117, 0xffff0000, v48
    v_lshlrev_b32 v118, 16, v49
    v_and_b32 v119, 0xffff0000, v49
    v_lshlrev_b32 v120, 16, v50
    v_and_b32 v121, 0xffff0000, v50
    v_lshlrev_b32 v122, 16, v51
    v_and_b32 v123, 0xffff0000, v51
    v_mul_f32 v108, v108, v116
    v_mul_f32 v109, v109, v117
    v_mul_f32 v110, v110, v118
    v_mul_f32 v111, v111, v119
    v_mul_f32 v112, v112, v120
    v_mul_f32 v113, v113, v121
    v_mul_f32 v114, v114, v122
    v_mul_f32 v115, v115, v123
    v_cvt_pk_bf16_f32 v60, v108, v109
    v_cvt_pk_bf16_f32 v61, v110, v111
    v_cvt_pk_bf16_f32 v62, v112, v113
    v_cvt_pk_bf16_f32 v63, v114, v115
    s_nop 1
    v_permlane32_swap_b32 v60, v62
    v_permlane32_swap_b32 v61, v63
    buffer_store_dwordx4 v[60:63], v3, s[16:19], 0 offen offset:64
    v_cvt_pk_bf16_f32 v44, v124, v125
    v_cvt_pk_bf16_f32 v45, v126, v127
    v_cvt_pk_bf16_f32 v46, v128, v129
    v_cvt_pk_bf16_f32 v47, v130, v131
    v_cvt_pk_bf16_f32 v48, v132, v133
    v_cvt_pk_bf16_f32 v49, v134, v135
    v_cvt_pk_bf16_f32 v50, v136, v137
    v_cvt_pk_bf16_f32 v51, v138, v139
    v_lshlrev_b32 v124, 16, v44
    v_and_b32 v125, 0xffff0000, v44
    v_lshlrev_b32 v126, 16, v45
    v_and_b32 v127, 0xffff0000, v45
    v_lshlrev_b32 v128, 16, v46
    v_and_b32 v129, 0xffff0000, v46
    v_lshlrev_b32 v130, 16, v47
    v_and_b32 v131, 0xffff0000, v47
    v_lshlrev_b32 v132, 16, v48
    v_and_b32 v133, 0xffff0000, v48
    v_lshlrev_b32 v134, 16, v49
    v_and_b32 v135, 0xffff0000, v49
    v_lshlrev_b32 v136, 16, v50
    v_and_b32 v137, 0xffff0000, v50
    v_lshlrev_b32 v138, 16, v51
    v_and_b32 v139, 0xffff0000, v51
    v_mul_f32 v124, v124, v132
    v_mul_f32 v125, v125, v133
    v_mul_f32 v126, v126, v134
    v_mul_f32 v127, v127, v135
    v_mul_f32 v128, v128, v136
    v_mul_f32 v129, v129, v137
    v_mul_f32 v130, v130, v138
    v_mul_f32 v131, v131, v139
    v_cvt_pk_bf16_f32 v64, v124, v125
    v_cvt_pk_bf16_f32 v65, v126, v127
    v_cvt_pk_bf16_f32 v66, v128, v129
    v_cvt_pk_bf16_f32 v67, v130, v131
    s_nop 1
    v_permlane32_swap_b32 v64, v66
    v_permlane32_swap_b32 v65, v67
    buffer_store_dwordx4 v[64:67], v3, s[16:19], 0 offen offset:96
    v_cvt_pk_bf16_f32 v44, v140, v141
    v_cvt_pk_bf16_f32 v45, v142, v143
    v_cvt_pk_bf16_f32 v46, v144, v145
    v_cvt_pk_bf16_f32 v47, v146, v147
    v_cvt_pk_bf16_f32 v48, v148, v149
    v_cvt_pk_bf16_f32 v49, v150, v151
    v_cvt_pk_bf16_f32 v50, v152, v153
    v_cvt_pk_bf16_f32 v51, v154, v155
    v_lshlrev_b32 v140, 16, v44
    v_and_b32 v141, 0xffff0000, v44
    v_lshlrev_b32 v142, 16, v45
    v_and_b32 v143, 0xffff0000, v45
    v_lshlrev_b32 v144, 16, v46
    v_and_b32 v145, 0xffff0000, v46
    v_lshlrev_b32 v146, 16, v47
    v_and_b32 v147, 0xffff0000, v47
    v_lshlrev_b32 v148, 16, v48
    v_and_b32 v149, 0xffff0000, v48
    v_lshlrev_b32 v150, 16, v49
    v_and_b32 v151, 0xffff0000, v49
    v_lshlrev_b32 v152, 16, v50
    v_and_b32 v153, 0xffff0000, v50
    v_lshlrev_b32 v154, 16, v51
    v_and_b32 v155, 0xffff0000, v51
    v_mul_f32 v140, v140, v148
    v_mul_f32 v141, v141, v149
    v_mul_f32 v142, v142, v150
    v_mul_f32 v143, v143, v151
    v_mul_f32 v144, v144, v152
    v_mul_f32 v145, v145, v153
    v_mul_f32 v146, v146, v154
    v_mul_f32 v147, v147, v155
    v_cvt_pk_bf16_f32 v52, v140, v141
    v_cvt_pk_bf16_f32 v53, v142, v143
    v_cvt_pk_bf16_f32 v54, v144, v145
    v_cvt_pk_bf16_f32 v55, v146, v147
    s_nop 1
    v_permlane32_swap_b32 v52, v54
    v_permlane32_swap_b32 v53, v55
    buffer_store_dwordx4 v[52:55], v3, s[16:19], s46 offen offset:0
    v_cvt_pk_bf16_f32 v44, v156, v157
    v_cvt_pk_bf16_f32 v45, v158, v159
    v_cvt_pk_bf16_f32 v46, v160, v161
    v_cvt_pk_bf16_f32 v47, v162, v163
    v_cvt_pk_bf16_f32 v48, v164, v165
    v_cvt_pk_bf16_f32 v49, v166, v167
    v_cvt_pk_bf16_f32 v50, v168, v169
    v_cvt_pk_bf16_f32 v51, v170, v171
    v_lshlrev_b32 v156, 16, v44
    v_and_b32 v157, 0xffff0000, v44
    v_lshlrev_b32 v158, 16, v45
    v_and_b32 v159, 0xffff0000, v45
    v_lshlrev_b32 v160, 16, v46
    v_and_b32 v161, 0xffff0000, v46
    v_lshlrev_b32 v162, 16, v47
    v_and_b32 v163, 0xffff0000, v47
    v_lshlrev_b32 v164, 16, v48
    v_and_b32 v165, 0xffff0000, v48
    v_lshlrev_b32 v166, 16, v49
    v_and_b32 v167, 0xffff0000, v49
    v_lshlrev_b32 v168, 16, v50
    v_and_b32 v169, 0xffff0000, v50
    v_lshlrev_b32 v170, 16, v51
    v_and_b32 v171, 0xffff0000, v51
    v_mul_f32 v156, v156, v164
    v_mul_f32 v157, v157, v165
    v_mul_f32 v158, v158, v166
    v_mul_f32 v159, v159, v167
    v_mul_f32 v160, v160, v168
    v_mul_f32 v161, v161, v169
    v_mul_f32 v162, v162, v170
    v_mul_f32 v163, v163, v171
    v_cvt_pk_bf16_f32 v56, v156, v157
    v_cvt_pk_bf16_f32 v57, v158, v159
    v_cvt_pk_bf16_f32 v58, v160, v161
    v_cvt_pk_bf16_f32 v59, v162, v163
    s_nop 1
    v_permlane32_swap_b32 v56, v58
    v_permlane32_swap_b32 v57, v59
    buffer_store_dwordx4 v[56:59], v3, s[16:19], s46 offen offset:32
    v_cvt_pk_bf16_f32 v44, v172, v173
    v_cvt_pk_bf16_f32 v45, v174, v175
    v_cvt_pk_bf16_f32 v46, v176, v177
    v_cvt_pk_bf16_f32 v47, v178, v179
    v_cvt_pk_bf16_f32 v48, v180, v181
    v_cvt_pk_bf16_f32 v49, v182, v183
    v_cvt_pk_bf16_f32 v50, v184, v185
    v_cvt_pk_bf16_f32 v51, v186, v187
    v_lshlrev_b32 v172, 16, v44
    v_and_b32 v173, 0xffff0000, v44
    v_lshlrev_b32 v174, 16, v45
    v_and_b32 v175, 0xffff0000, v45
    v_lshlrev_b32 v176, 16, v46
    v_and_b32 v177, 0xffff0000, v46
    v_lshlrev_b32 v178, 16, v47
    v_and_b32 v179, 0xffff0000, v47
    v_lshlrev_b32 v180, 16, v48
    v_and_b32 v181, 0xffff0000, v48
    v_lshlrev_b32 v182, 16, v49
    v_and_b32 v183, 0xffff0000, v49
    v_lshlrev_b32 v184, 16, v50
    v_and_b32 v185, 0xffff0000, v50
    v_lshlrev_b32 v186, 16, v51
    v_and_b32 v187, 0xffff0000, v51
    v_mul_f32 v172, v172, v180
    v_mul_f32 v173, v173, v181
    v_mul_f32 v174, v174, v182
    v_mul_f32 v175, v175, v183
    v_mul_f32 v176, v176, v184
    v_mul_f32 v177, v177, v185
    v_mul_f32 v178, v178, v186
    v_mul_f32 v179, v179, v187
    v_cvt_pk_bf16_f32 v60, v172, v173
    v_cvt_pk_bf16_f32 v61, v174, v175
    v_cvt_pk_bf16_f32 v62, v176, v177
    v_cvt_pk_bf16_f32 v63, v178, v179
    s_nop 1
    v_permlane32_swap_b32 v60, v62
    v_permlane32_swap_b32 v61, v63
    buffer_store_dwordx4 v[60:63], v3, s[16:19], s46 offen offset:64
    v_cvt_pk_bf16_f32 v44, v188, v189
    v_cvt_pk_bf16_f32 v45, v190, v191
    v_cvt_pk_bf16_f32 v46, v192, v193
    v_cvt_pk_bf16_f32 v47, v194, v195
    v_cvt_pk_bf16_f32 v48, v196, v197
    v_cvt_pk_bf16_f32 v49, v198, v199
    v_cvt_pk_bf16_f32 v50, v200, v201
    v_cvt_pk_bf16_f32 v51, v202, v203
    v_lshlrev_b32 v188, 16, v44
    v_and_b32 v189, 0xffff0000, v44
    v_lshlrev_b32 v190, 16, v45
    v_and_b32 v191, 0xffff0000, v45
    v_lshlrev_b32 v192, 16, v46
    v_and_b32 v193, 0xffff0000, v46
    v_lshlrev_b32 v194, 16, v47
    v_and_b32 v195, 0xffff0000, v47
    v_lshlrev_b32 v196, 16, v48
    v_and_b32 v197, 0xffff0000, v48
    v_lshlrev_b32 v198, 16, v49
    v_and_b32 v199, 0xffff0000, v49
    v_lshlrev_b32 v200, 16, v50
    v_and_b32 v201, 0xffff0000, v50
    v_lshlrev_b32 v202, 16, v51
    v_and_b32 v203, 0xffff0000, v51
    v_mul_f32 v188, v188, v196
    v_mul_f32 v189, v189, v197
    v_mul_f32 v190, v190, v198
    v_mul_f32 v191, v191, v199
    v_mul_f32 v192, v192, v200
    v_mul_f32 v193, v193, v201
    v_mul_f32 v194, v194, v202
    v_mul_f32 v195, v195, v203
    v_cvt_pk_bf16_f32 v64, v188, v189
    v_cvt_pk_bf16_f32 v65, v190, v191
    v_cvt_pk_bf16_f32 v66, v192, v193
    v_cvt_pk_bf16_f32 v67, v194, v195
    s_nop 1
    v_permlane32_swap_b32 v64, v66
    v_permlane32_swap_b32 v65, v67
    buffer_store_dwordx4 v[64:67], v3, s[16:19], s46 offen offset:96
    s_branch gu_kernel_join
gu_kernel_grp1:
    s_waitcnt vmcnt(8)
    s_barrier
    ds_read_b128 v[28:31], v15 offset:0
    ds_read_b128 v[32:35], v15 offset:4096
    ds_read_b64_tr_b16 v[36:37], v23 offset:0
    ds_read_b64_tr_b16 v[38:39], v23 offset:896
    ds_read_b64_tr_b16 v[40:41], v23 offset:32
    ds_read_b64_tr_b16 v[42:43], v23 offset:928
    ds_read_b64_tr_b16 v[44:45], v23 offset:64
    ds_read_b64_tr_b16 v[46:47], v23 offset:960
    s_mov_b32 s42, 256
    s_mov_b32 s43, 917504
    s_mov_b32 s47, 7
.p2align 6
gu_kernel_loopg1:
    s_waitcnt lgkmcnt(0)
    v_mfma_f32_32x32x16_bf16 v[76:91], v[36:39], v[28:31], v[76:91]
    ds_read_b128 v[52:55], v16 offset:0
    ds_read_b128 v[56:59], v16 offset:4096
    v_mfma_f32_32x32x16_bf16 v[140:155], v[36:39], v[32:35], v[140:155]
    ds_read_b64_tr_b16 v[60:61], v23 offset:3584
    v_mfma_f32_32x32x16_bf16 v[92:107], v[40:43], v[28:31], v[92:107]
    ds_read_b64_tr_b16 v[62:63], v23 offset:4480
    v_mfma_f32_32x32x16_bf16 v[156:171], v[40:43], v[32:35], v[156:171]
    ds_read_b64_tr_b16 v[64:65], v23 offset:3616
    ds_read_b64_tr_b16 v[66:67], v23 offset:4512
    v_mfma_f32_32x32x16_bf16 v[108:123], v[44:47], v[28:31], v[108:123]
    ds_read_b64_tr_b16 v[68:69], v23 offset:3648
    v_mfma_f32_32x32x16_bf16 v[172:187], v[44:47], v[32:35], v[172:187]
    ds_read_b64_tr_b16 v[70:71], v23 offset:4544
    s_waitcnt lgkmcnt(0)
    v_mfma_f32_32x32x16_bf16 v[76:91], v[60:63], v[52:55], v[76:91]
    ds_read_b128 v[28:31], v17 offset:0
    ds_read_b128 v[32:35], v17 offset:4096
    v_mfma_f32_32x32x16_bf16 v[140:155], v[60:63], v[56:59], v[140:155]
    ds_read_b64_tr_b16 v[36:37], v23 offset:7168
    v_mfma_f32_32x32x16_bf16 v[92:107], v[64:67], v[52:55], v[92:107]
    ds_read_b64_tr_b16 v[38:39], v23 offset:8064
    v_mfma_f32_32x32x16_bf16 v[156:171], v[64:67], v[56:59], v[156:171]
    ds_read_b64_tr_b16 v[40:41], v23 offset:7200
    ds_read_b64_tr_b16 v[42:43], v23 offset:8096
    v_mfma_f32_32x32x16_bf16 v[108:123], v[68:71], v[52:55], v[108:123]
    ds_read_b64_tr_b16 v[44:45], v23 offset:7232
    v_mfma_f32_32x32x16_bf16 v[172:187], v[68:71], v[56:59], v[172:187]
    ds_read_b64_tr_b16 v[46:47], v23 offset:8128
    s_waitcnt lgkmcnt(0)
    v_mfma_f32_32x32x16_bf16 v[76:91], v[36:39], v[28:31], v[76:91]
    ds_read_b128 v[52:55], v18 offset:0
    ds_read_b128 v[56:59], v18 offset:4096
    v_mfma_f32_32x32x16_bf16 v[140:155], v[36:39], v[32:35], v[140:155]
    ds_read_b64_tr_b16 v[60:61], v23 offset:10752
    v_mfma_f32_32x32x16_bf16 v[92:107], v[40:43], v[28:31], v[92:107]
    ds_read_b64_tr_b16 v[62:63], v23 offset:11648
    v_mfma_f32_32x32x16_bf16 v[156:171], v[40:43], v[32:35], v[156:171]
    ds_read_b64_tr_b16 v[64:65], v23 offset:10784
    ds_read_b64_tr_b16 v[66:67], v23 offset:11680
    v_mfma_f32_32x32x16_bf16 v[108:123], v[44:47], v[28:31], v[108:123]
    ds_read_b64_tr_b16 v[68:69], v23 offset:10816
    v_mfma_f32_32x32x16_bf16 v[172:187], v[44:47], v[32:35], v[172:187]
    ds_read_b64_tr_b16 v[70:71], v23 offset:11712
    s_waitcnt vmcnt(0) lgkmcnt(0)
    s_barrier
    v_mfma_f32_32x32x16_bf16 v[76:91], v[60:63], v[52:55], v[76:91]
    ds_read_b128 v[28:31], v19 offset:0
    ds_read_b128 v[32:35], v19 offset:4096
    ds_read_b64_tr_b16 v[36:37], v24 offset:0
    v_mfma_f32_32x32x16_bf16 v[140:155], v[60:63], v[56:59], v[140:155]
    ds_read_b64_tr_b16 v[38:39], v24 offset:896
    ds_read_b64_tr_b16 v[40:41], v24 offset:32
    ds_read_b64_tr_b16 v[42:43], v24 offset:928
    v_mfma_f32_32x32x16_bf16 v[92:107], v[64:67], v[52:55], v[92:107]
    ds_read_b64_tr_b16 v[44:45], v24 offset:64
    ds_read_b64_tr_b16 v[46:47], v24 offset:960
    s_add_u32 m0, s40, 0
    s_nop 0
    buffer_load_dwordx4 v7, s[8:11], s42 offen lds
    v_mfma_f32_32x32x16_bf16 v[156:171], v[64:67], v[56:59], v[156:171]
    s_add_u32 m0, s40, 1024
    s_nop 0
    buffer_load_dwordx4 v8, s[8:11], s42 offen lds
    s_add_u32 m0, s40, 2048
    s_nop 0
    buffer_load_dwordx4 v9, s[8:11], s42 offen lds
    s_add_u32 m0, s40, 3072
    s_nop 0
    buffer_load_dwordx4 v10, s[8:11], s42 offen lds
    v_mfma_f32_32x32x16_bf16 v[108:123], v[68:71], v[52:55], v[108:123]
    s_add_u32 m0, s50, 0
    s_nop 0
    buffer_load_dwordx4 v11, s[12:15], s43 offen lds
    s_add_u32 m0, s51, 0
    s_nop 0
    buffer_load_dwordx4 v12, s[12:15], s43 offen lds
    s_add_u32 m0, s52, 0
    s_nop 0
    buffer_load_dwordx4 v13, s[12:15], s43 offen lds
    v_mfma_f32_32x32x16_bf16 v[172:187], v[68:71], v[56:59], v[172:187]
    s_add_u32 m0, s53, 0
    s_nop 0
    buffer_load_dwordx4 v14, s[12:15], s43 offen lds
    s_add_u32 s42, s42, 128
    s_add_u32 s43, s43, 458752
    s_waitcnt lgkmcnt(0)
    v_mfma_f32_32x32x16_bf16 v[76:91], v[36:39], v[28:31], v[76:91]
    ds_read_b128 v[52:55], v20 offset:0
    ds_read_b128 v[56:59], v20 offset:4096
    v_mfma_f32_32x32x16_bf16 v[140:155], v[36:39], v[32:35], v[140:155]
    ds_read_b64_tr_b16 v[60:61], v24 offset:3584
    v_mfma_f32_32x32x16_bf16 v[92:107], v[40:43], v[28:31], v[92:107]
    ds_read_b64_tr_b16 v[62:63], v24 offset:4480
    v_mfma_f32_32x32x16_bf16 v[156:171], v[40:43], v[32:35], v[156:171]
    ds_read_b64_tr_b16 v[64:65], v24 offset:3616
    ds_read_b64_tr_b16 v[66:67], v24 offset:4512
    v_mfma_f32_32x32x16_bf16 v[108:123], v[44:47], v[28:31], v[108:123]
    ds_read_b64_tr_b16 v[68:69], v24 offset:3648
    v_mfma_f32_32x32x16_bf16 v[172:187], v[44:47], v[32:35], v[172:187]
    ds_read_b64_tr_b16 v[70:71], v24 offset:4544
    s_waitcnt lgkmcnt(0)
    v_mfma_f32_32x32x16_bf16 v[76:91], v[60:63], v[52:55], v[76:91]
    ds_read_b128 v[28:31], v21 offset:0
    ds_read_b128 v[32:35], v21 offset:4096
    v_mfma_f32_32x32x16_bf16 v[140:155], v[60:63], v[56:59], v[140:155]
    ds_read_b64_tr_b16 v[36:37], v24 offset:7168
    v_mfma_f32_32x32x16_bf16 v[92:107], v[64:67], v[52:55], v[92:107]
    ds_read_b64_tr_b16 v[38:39], v24 offset:8064
    v_mfma_f32_32x32x16_bf16 v[156:171], v[64:67], v[56:59], v[156:171]
    ds_read_b64_tr_b16 v[40:41], v24 offset:7200
    ds_read_b64_tr_b16 v[42:43], v24 offset:8096
    v_mfma_f32_32x32x16_bf16 v[108:123], v[68:71], v[52:55], v[108:123]
    ds_read_b64_tr_b16 v[44:45], v24 offset:7232
    v_mfma_f32_32x32x16_bf16 v[172:187], v[68:71], v[56:59], v[172:187]
    ds_read_b64_tr_b16 v[46:47], v24 offset:8128
    s_waitcnt lgkmcnt(0)
    v_mfma_f32_32x32x16_bf16 v[76:91], v[36:39], v[28:31], v[76:91]
    ds_read_b128 v[52:55], v22 offset:0
    ds_read_b128 v[56:59], v22 offset:4096
    v_mfma_f32_32x32x16_bf16 v[140:155], v[36:39], v[32:35], v[140:155]
    ds_read_b64_tr_b16 v[60:61], v24 offset:10752
    v_mfma_f32_32x32x16_bf16 v[92:107], v[40:43], v[28:31], v[92:107]
    ds_read_b64_tr_b16 v[62:63], v24 offset:11648
    v_mfma_f32_32x32x16_bf16 v[156:171], v[40:43], v[32:35], v[156:171]
    ds_read_b64_tr_b16 v[64:65], v24 offset:10784
    ds_read_b64_tr_b16 v[66:67], v24 offset:11680
    v_mfma_f32_32x32x16_bf16 v[108:123], v[44:47], v[28:31], v[108:123]
    ds_read_b64_tr_b16 v[68:69], v24 offset:10816
    v_mfma_f32_32x32x16_bf16 v[172:187], v[44:47], v[32:35], v[172:187]
    ds_read_b64_tr_b16 v[70:71], v24 offset:11712
    s_waitcnt vmcnt(0) lgkmcnt(0)
    s_barrier
    v_mfma_f32_32x32x16_bf16 v[76:91], v[60:63], v[52:55], v[76:91]
    ds_read_b128 v[28:31], v15 offset:0
    ds_read_b128 v[32:35], v15 offset:4096
    ds_read_b64_tr_b16 v[36:37], v23 offset:0
    v_mfma_f32_32x32x16_bf16 v[140:155], v[60:63], v[56:59], v[140:155]
    ds_read_b64_tr_b16 v[38:39], v23 offset:896
    ds_read_b64_tr_b16 v[40:41], v23 offset:32
    ds_read_b64_tr_b16 v[42:43], v23 offset:928
    v_mfma_f32_32x32x16_bf16 v[92:107], v[64:67], v[52:55], v[92:107]
    ds_read_b64_tr_b16 v[44:45], v23 offset:64
    ds_read_b64_tr_b16 v[46:47], v23 offset:960
    s_add_u32 m0, s40, 61696
    s_nop 0
    buffer_load_dwordx4 v7, s[8:11], s42 offen lds
    v_mfma_f32_32x32x16_bf16 v[156:171], v[64:67], v[56:59], v[156:171]
    s_add_u32 m0, s40, 62720
    s_nop 0
    buffer_load_dwordx4 v8, s[8:11], s42 offen lds
    s_add_u32 m0, s40, 63744
    s_nop 0
    buffer_load_dwordx4 v9, s[8:11], s42 offen lds
    s_add_u32 m0, s40, 64768
    s_nop 0
    buffer_load_dwordx4 v10, s[8:11], s42 offen lds
    v_mfma_f32_32x32x16_bf16 v[108:123], v[68:71], v[52:55], v[108:123]
    s_add_u32 m0, s50, 61696
    s_nop 0
    buffer_load_dwordx4 v11, s[12:15], s43 offen lds
    s_add_u32 m0, s51, 61696
    s_nop 0
    buffer_load_dwordx4 v12, s[12:15], s43 offen lds
    s_add_u32 m0, s52, 61696
    s_nop 0
    buffer_load_dwordx4 v13, s[12:15], s43 offen lds
    v_mfma_f32_32x32x16_bf16 v[172:187], v[68:71], v[56:59], v[172:187]
    s_add_u32 m0, s53, 61696
    s_nop 0
    buffer_load_dwordx4 v14, s[12:15], s43 offen lds
    s_add_u32 s42, s42, 128
    s_add_u32 s43, s43, 458752
    s_sub_u32 s47, s47, 1
    s_cmp_lg_u32 s47, 0
    s_cbranch_scc1 gu_kernel_loopg1
    s_waitcnt lgkmcnt(0)
    v_mfma_f32_32x32x16_bf16 v[76:91], v[36:39], v[28:31], v[76:91]
    ds_read_b128 v[52:55], v16 offset:0
    ds_read_b128 v[56:59], v16 offset:4096
    v_mfma_f32_32x32x16_bf16 v[140:155], v[36:39], v[32:35], v[140:155]
    ds_read_b64_tr_b16 v[60:61], v23 offset:3584
    v_mfma_f32_32x32x16_bf16 v[92:107], v[40:43], v[28:31], v[92:107]
    ds_read_b64_tr_b16 v[62:63], v23 offset:4480
    v_mfma_f32_32x32x16_bf16 v[156:171], v[40:43], v[32:35], v[156:171]
    ds_read_b64_tr_b16 v[64:65], v23 offset:3616
    ds_read_b64_tr_b16 v[66:67], v23 offset:4512
    v_mfma_f32_32x32x16_bf16 v[108:123], v[44:47], v[28:31], v[108:123]
    ds_read_b64_tr_b16 v[68:69], v23 offset:3648
    v_mfma_f32_32x32x16_bf16 v[172:187], v[44:47], v[32:35], v[172:187]
    ds_read_b64_tr_b16 v[70:71], v23 offset:4544
    s_waitcnt lgkmcnt(0)
    v_mfma_f32_32x32x16_bf16 v[76:91], v[60:63], v[52:55], v[76:91]
    ds_read_b128 v[28:31], v17 offset:0
    ds_read_b128 v[32:35], v17 offset:4096
    v_mfma_f32_32x32x16_bf16 v[140:155], v[60:63], v[56:59], v[140:155]
    ds_read_b64_tr_b16 v[36:37], v23 offset:7168
    v_mfma_f32_32x32x16_bf16 v[92:107], v[64:67], v[52:55], v[92:107]
    ds_read_b64_tr_b16 v[38:39], v23 offset:8064
    v_mfma_f32_32x32x16_bf16 v[156:171], v[64:67], v[56:59], v[156:171]
    ds_read_b64_tr_b16 v[40:41], v23 offset:7200
    ds_read_b64_tr_b16 v[42:43], v23 offset:8096
    v_mfma_f32_32x32x16_bf16 v[108:123], v[68:71], v[52:55], v[108:123]
    ds_read_b64_tr_b16 v[44:45], v23 offset:7232
    v_mfma_f32_32x32x16_bf16 v[172:187], v[68:71], v[56:59], v[172:187]
    ds_read_b64_tr_b16 v[46:47], v23 offset:8128
    s_waitcnt lgkmcnt(0)
    v_mfma_f32_32x32x16_bf16 v[76:91], v[36:39], v[28:31], v[76:91]
    ds_read_b128 v[52:55], v18 offset:0
    ds_read_b128 v[56:59], v18 offset:4096
    v_mfma_f32_32x32x16_bf16 v[140:155], v[36:39], v[32:35], v[140:155]
    ds_read_b64_tr_b16 v[60:61], v23 offset:10752
    v_mfma_f32_32x32x16_bf16 v[92:107], v[40:43], v[28:31], v[92:107]
    ds_read_b64_tr_b16 v[62:63], v23 offset:11648
    v_mfma_f32_32x32x16_bf16 v[156:171], v[40:43], v[32:35], v[156:171]
    ds_read_b64_tr_b16 v[64:65], v23 offset:10784
    ds_read_b64_tr_b16 v[66:67], v23 offset:11680
    v_mfma_f32_32x32x16_bf16 v[108:123], v[44:47], v[28:31], v[108:123]
    ds_read_b64_tr_b16 v[68:69], v23 offset:10816
    v_mfma_f32_32x32x16_bf16 v[172:187], v[44:47], v[32:35], v[172:187]
    ds_read_b64_tr_b16 v[70:71], v23 offset:11712
    s_waitcnt vmcnt(0) lgkmcnt(0)
    s_barrier
    v_mfma_f32_32x32x16_bf16 v[76:91], v[60:63], v[52:55], v[76:91]
    ds_read_b128 v[28:31], v19 offset:0
    ds_read_b128 v[32:35], v19 offset:4096
    v_mfma_f32_32x32x16_bf16 v[140:155], v[60:63], v[56:59], v[140:155]
    ds_read_b64_tr_b16 v[36:37], v24 offset:0
    v_mfma_f32_32x32x16_bf16 v[92:107], v[64:67], v[52:55], v[92:107]
    ds_read_b64_tr_b16 v[38:39], v24 offset:896
    v_mfma_f32_32x32x16_bf16 v[156:171], v[64:67], v[56:59], v[156:171]
    ds_read_b64_tr_b16 v[40:41], v24 offset:32
    ds_read_b64_tr_b16 v[42:43], v24 offset:928
    v_mfma_f32_32x32x16_bf16 v[108:123], v[68:71], v[52:55], v[108:123]
    ds_read_b64_tr_b16 v[44:45], v24 offset:64
    v_mfma_f32_32x32x16_bf16 v[172:187], v[68:71], v[56:59], v[172:187]
    ds_read_b64_tr_b16 v[46:47], v24 offset:960
    s_waitcnt lgkmcnt(0)
    v_mfma_f32_32x32x16_bf16 v[76:91], v[36:39], v[28:31], v[76:91]
    ds_read_b128 v[52:55], v20 offset:0
    ds_read_b128 v[56:59], v20 offset:4096
    v_mfma_f32_32x32x16_bf16 v[140:155], v[36:39], v[32:35], v[140:155]
    ds_read_b64_tr_b16 v[60:61], v24 offset:3584
    v_mfma_f32_32x32x16_bf16 v[92:107], v[40:43], v[28:31], v[92:107]
    ds_read_b64_tr_b16 v[62:63], v24 offset:4480
    v_mfma_f32_32x32x16_bf16 v[156:171], v[40:43], v[32:35], v[156:171]
    ds_read_b64_tr_b16 v[64:65], v24 offset:3616
    ds_read_b64_tr_b16 v[66:67], v24 offset:4512
    v_mfma_f32_32x32x16_bf16 v[108:123], v[44:47], v[28:31], v[108:123]
    ds_read_b64_tr_b16 v[68:69], v24 offset:3648
    v_mfma_f32_32x32x16_bf16 v[172:187], v[44:47], v[32:35], v[172:187]
    ds_read_b64_tr_b16 v[70:71], v24 offset:4544
    s_waitcnt lgkmcnt(0)
    v_mfma_f32_32x32x16_bf16 v[76:91], v[60:63], v[52:55], v[76:91]
    ds_read_b128 v[28:31], v21 offset:0
    ds_read_b128 v[32:35], v21 offset:4096
    v_mfma_f32_32x32x16_bf16 v[140:155], v[60:63], v[56:59], v[140:155]
    ds_read_b64_tr_b16 v[36:37], v24 offset:7168
    v_mfma_f32_32x32x16_bf16 v[92:107], v[64:67], v[52:55], v[92:107]
    ds_read_b64_tr_b16 v[38:39], v24 offset:8064
    v_mfma_f32_32x32x16_bf16 v[156:171], v[64:67], v[56:59], v[156:171]
    ds_read_b64_tr_b16 v[40:41], v24 offset:7200
    ds_read_b64_tr_b16 v[42:43], v24 offset:8096
    v_mfma_f32_32x32x16_bf16 v[108:123], v[68:71], v[52:55], v[108:123]
    ds_read_b64_tr_b16 v[44:45], v24 offset:7232
    v_mfma_f32_32x32x16_bf16 v[172:187], v[68:71], v[56:59], v[172:187]
    ds_read_b64_tr_b16 v[46:47], v24 offset:8128
    s_waitcnt lgkmcnt(0)
    v_mfma_f32_32x32x16_bf16 v[76:91], v[36:39], v[28:31], v[76:91]
    ds_read_b128 v[52:55], v22 offset:0
    ds_read_b128 v[56:59], v22 offset:4096
    v_mfma_f32_32x32x16_bf16 v[140:155], v[36:39], v[32:35], v[140:155]
    ds_read_b64_tr_b16 v[60:61], v24 offset:10752
    v_mfma_f32_32x32x16_bf16 v[92:107], v[40:43], v[28:31], v[92:107]
    ds_read_b64_tr_b16 v[62:63], v24 offset:11648
    v_mfma_f32_32x32x16_bf16 v[156:171], v[40:43], v[32:35], v[156:171]
    ds_read_b64_tr_b16 v[64:65], v24 offset:10784
    ds_read_b64_tr_b16 v[66:67], v24 offset:11680
    v_mfma_f32_32x32x16_bf16 v[108:123], v[44:47], v[28:31], v[108:123]
    ds_read_b64_tr_b16 v[68:69], v24 offset:10816
    v_mfma_f32_32x32x16_bf16 v[172:187], v[44:47], v[32:35], v[172:187]
    ds_read_b64_tr_b16 v[70:71], v24 offset:11712
    s_waitcnt lgkmcnt(0)
    v_mfma_f32_32x32x16_bf16 v[76:91], v[60:63], v[52:55], v[76:91]
    v_mfma_f32_32x32x16_bf16 v[140:155], v[60:63], v[56:59], v[140:155]
    v_mfma_f32_32x32x16_bf16 v[92:107], v[64:67], v[52:55], v[92:107]
    v_mfma_f32_32x32x16_bf16 v[156:171], v[64:67], v[56:59], v[156:171]
    v_mfma_f32_32x32x16_bf16 v[108:123], v[68:71], v[52:55], v[108:123]
    v_mfma_f32_32x32x16_bf16 v[172:187], v[68:71], v[56:59], v[172:187]
    v_and_b32 v1, 31, v0
    v_lshrrev_b32 v2, 5, v0
    s_mul_i32 s36, s28, 256
    s_mul_i32 s31, s44, 64
    s_add_u32 s36, s36, s31
    v_add_u32 v1, s36, v1
    s_mov_b32 s37, 7168
    v_mul_lo_u32 v3, v1, s37
    v_lshl_add_u32 v3, v2, 4, v3
    s_mul_i32 s37, s29, 224
    s_add_u32 s37, s37, 128
    v_add_u32 v3, s37, v3
    s_mov_b32 s46, 229376
    s_nop 15
    v_cvt_pk_bf16_f32 v44, v76, v77
    v_cvt_pk_bf16_f32 v45, v78, v79
    v_cvt_pk_bf16_f32 v46, v80, v81
    v_cvt_pk_bf16_f32 v47, v82, v83
    v_cvt_pk_bf16_f32 v48, v84, v85
    v_cvt_pk_bf16_f32 v49, v86, v87
    v_cvt_pk_bf16_f32 v50, v88, v89
    v_cvt_pk_bf16_f32 v51, v90, v91
    v_lshlrev_b32 v76, 16, v44
    v_and_b32 v77, 0xffff0000, v44
    v_lshlrev_b32 v78, 16, v45
    v_and_b32 v79, 0xffff0000, v45
    v_lshlrev_b32 v80, 16, v46
    v_and_b32 v81, 0xffff0000, v46
    v_lshlrev_b32 v82, 16, v47
    v_and_b32 v83, 0xffff0000, v47
    v_lshlrev_b32 v84, 16, v48
    v_and_b32 v85, 0xffff0000, v48
    v_lshlrev_b32 v86, 16, v49
    v_and_b32 v87, 0xffff0000, v49
    v_lshlrev_b32 v88, 16, v50
    v_and_b32 v89, 0xffff0000, v50
    v_lshlrev_b32 v90, 16, v51
    v_and_b32 v91, 0xffff0000, v51
    v_mul_f32 v76, v76, v84
    v_mul_f32 v77, v77, v85
    v_mul_f32 v78, v78, v86
    v_mul_f32 v79, v79, v87
    v_mul_f32 v80, v80, v88
    v_mul_f32 v81, v81, v89
    v_mul_f32 v82, v82, v90
    v_mul_f32 v83, v83, v91
    v_cvt_pk_bf16_f32 v52, v76, v77
    v_cvt_pk_bf16_f32 v53, v78, v79
    v_cvt_pk_bf16_f32 v54, v80, v81
    v_cvt_pk_bf16_f32 v55, v82, v83
    s_nop 1
    v_permlane32_swap_b32 v52, v54
    v_permlane32_swap_b32 v53, v55
    buffer_store_dwordx4 v[52:55], v3, s[16:19], 0 offen offset:0
    v_cvt_pk_bf16_f32 v44, v92, v93
    v_cvt_pk_bf16_f32 v45, v94, v95
    v_cvt_pk_bf16_f32 v46, v96, v97
    v_cvt_pk_bf16_f32 v47, v98, v99
    v_cvt_pk_bf16_f32 v48, v100, v101
    v_cvt_pk_bf16_f32 v49, v102, v103
    v_cvt_pk_bf16_f32 v50, v104, v105
    v_cvt_pk_bf16_f32 v51, v106, v107
    v_lshlrev_b32 v92, 16, v44
    v_and_b32 v93, 0xffff0000, v44
    v_lshlrev_b32 v94, 16, v45
    v_and_b32 v95, 0xffff0000, v45
    v_lshlrev_b32 v96, 16, v46
    v_and_b32 v97, 0xffff0000, v46
    v_lshlrev_b32 v98, 16, v47
    v_and_b32 v99, 0xffff0000, v47
    v_lshlrev_b32 v100, 16, v48
    v_and_b32 v101, 0xffff0000, v48
    v_lshlrev_b32 v102, 16, v49
    v_and_b32 v103, 0xffff0000, v49
    v_lshlrev_b32 v104, 16, v50
    v_and_b32 v105, 0xffff0000, v50
    v_lshlrev_b32 v106, 16, v51
    v_and_b32 v107, 0xffff0000, v51
    v_mul_f32 v92, v92, v100
    v_mul_f32 v93, v93, v101
    v_mul_f32 v94, v94, v102
    v_mul_f32 v95, v95, v103
    v_mul_f32 v96, v96, v104
    v_mul_f32 v97, v97, v105
    v_mul_f32 v98, v98, v106
    v_mul_f32 v99, v99, v107
    v_cvt_pk_bf16_f32 v56, v92, v93
    v_cvt_pk_bf16_f32 v57, v94, v95
    v_cvt_pk_bf16_f32 v58, v96, v97
    v_cvt_pk_bf16_f32 v59, v98, v99
    s_nop 1
    v_permlane32_swap_b32 v56, v58
    v_permlane32_swap_b32 v57, v59
    buffer_store_dwordx4 v[56:59], v3, s[16:19], 0 offen offset:32
    v_cvt_pk_bf16_f32 v44, v108, v109
    v_cvt_pk_bf16_f32 v45, v110, v111
    v_cvt_pk_bf16_f32 v46, v112, v113
    v_cvt_pk_bf16_f32 v47, v114, v115
    v_cvt_pk_bf16_f32 v48, v116, v117
    v_cvt_pk_bf16_f32 v49, v118, v119
    v_cvt_pk_bf16_f32 v50, v120, v121
    v_cvt_pk_bf16_f32 v51, v122, v123
    v_lshlrev_b32 v108, 16, v44
    v_and_b32 v109, 0xffff0000, v44
    v_lshlrev_b32 v110, 16, v45
    v_and_b32 v111, 0xffff0000, v45
    v_lshlrev_b32 v112, 16, v46
    v_and_b32 v113, 0xffff0000, v46
    v_lshlrev_b32 v114, 16, v47
    v_and_b32 v115, 0xffff0000, v47
    v_lshlrev_b32 v116, 16, v48
    v_and_b32 v117, 0xffff0000, v48
    v_lshlrev_b32 v118, 16, v49
    v_and_b32 v119, 0xffff0000, v49
    v_lshlrev_b32 v120, 16, v50
    v_and_b32 v121, 0xffff0000, v50
    v_lshlrev_b32 v122, 16, v51
    v_and_b32 v123, 0xffff0000, v51
    v_mul_f32 v108, v108, v116
    v_mul_f32 v109, v109, v117
    v_mul_f32 v110, v110, v118
    v_mul_f32 v111, v111, v119
    v_mul_f32 v112, v112, v120
    v_mul_f32 v113, v113, v121
    v_mul_f32 v114, v114, v122
    v_mul_f32 v115, v115, v123
    v_cvt_pk_bf16_f32 v60, v108, v109
    v_cvt_pk_bf16_f32 v61, v110, v111
    v_cvt_pk_bf16_f32 v62, v112, v113
    v_cvt_pk_bf16_f32 v63, v114, v115
    s_nop 1
    v_permlane32_swap_b32 v60, v62
    v_permlane32_swap_b32 v61, v63
    buffer_store_dwordx4 v[60:63], v3, s[16:19], 0 offen offset:64
    v_cvt_pk_bf16_f32 v44, v140, v141
    v_cvt_pk_bf16_f32 v45, v142, v143
    v_cvt_pk_bf16_f32 v46, v144, v145
    v_cvt_pk_bf16_f32 v47, v146, v147
    v_cvt_pk_bf16_f32 v48, v148, v149
    v_cvt_pk_bf16_f32 v49, v150, v151
    v_cvt_pk_bf16_f32 v50, v152, v153
    v_cvt_pk_bf16_f32 v51, v154, v155
    v_lshlrev_b32 v140, 16, v44
    v_and_b32 v141, 0xffff0000, v44
    v_lshlrev_b32 v142, 16, v45
    v_and_b32 v143, 0xffff0000, v45
    v_lshlrev_b32 v144, 16, v46
    v_and_b32 v145, 0xffff0000, v46
    v_lshlrev_b32 v146, 16, v47
    v_and_b32 v147, 0xffff0000, v47
    v_lshlrev_b32 v148, 16, v48
    v_and_b32 v149, 0xffff0000, v48
    v_lshlrev_b32 v150, 16, v49
    v_and_b32 v151, 0xffff0000, v49
    v_lshlrev_b32 v152, 16, v50
    v_and_b32 v153, 0xffff0000, v50
    v_lshlrev_b32 v154, 16, v51
    v_and_b32 v155, 0xffff0000, v51
    v_mul_f32 v140, v140, v148
    v_mul_f32 v141, v141, v149
    v_mul_f32 v142, v142, v150
    v_mul_f32 v143, v143, v151
    v_mul_f32 v144, v144, v152
    v_mul_f32 v145, v145, v153
    v_mul_f32 v146, v146, v154
    v_mul_f32 v147, v147, v155
    v_cvt_pk_bf16_f32 v64, v140, v141
    v_cvt_pk_bf16_f32 v65, v142, v143
    v_cvt_pk_bf16_f32 v66, v144, v145
    v_cvt_pk_bf16_f32 v67, v146, v147
    s_nop 1
    v_permlane32_swap_b32 v64, v66
    v_permlane32_swap_b32 v65, v67
    buffer_store_dwordx4 v[64:67], v3, s[16:19], s46 offen offset:0
    v_cvt_pk_bf16_f32 v44, v156, v157
    v_cvt_pk_bf16_f32 v45, v158, v159
    v_cvt_pk_bf16_f32 v46, v160, v161
    v_cvt_pk_bf16_f32 v47, v162, v163
    v_cvt_pk_bf16_f32 v48, v164, v165
    v_cvt_pk_bf16_f32 v49, v166, v167
    v_cvt_pk_bf16_f32 v50, v168, v169
    v_cvt_pk_bf16_f32 v51, v170, v171
    v_lshlrev_b32 v156, 16, v44
    v_and_b32 v157, 0xffff0000, v44
    v_lshlrev_b32 v158, 16, v45
    v_and_b32 v159, 0xffff0000, v45
    v_lshlrev_b32 v160, 16, v46
    v_and_b32 v161, 0xffff0000, v46
    v_lshlrev_b32 v162, 16, v47
    v_and_b32 v163, 0xffff0000, v47
    v_lshlrev_b32 v164, 16, v48
    v_and_b32 v165, 0xffff0000, v48
    v_lshlrev_b32 v166, 16, v49
    v_and_b32 v167, 0xffff0000, v49
    v_lshlrev_b32 v168, 16, v50
    v_and_b32 v169, 0xffff0000, v50
    v_lshlrev_b32 v170, 16, v51
    v_and_b32 v171, 0xffff0000, v51
    v_mul_f32 v156, v156, v164
    v_mul_f32 v157, v157, v165
    v_mul_f32 v158, v158, v166
    v_mul_f32 v159, v159, v167
    v_mul_f32 v160, v160, v168
    v_mul_f32 v161, v161, v169
    v_mul_f32 v162, v162, v170
    v_mul_f32 v163, v163, v171
    v_cvt_pk_bf16_f32 v52, v156, v157
    v_cvt_pk_bf16_f32 v53, v158, v159
    v_cvt_pk_bf16_f32 v54, v160, v161
    v_cvt_pk_bf16_f32 v55, v162, v163
    s_nop 1
    v_permlane32_swap_b32 v52, v54
    v_permlane32_swap_b32 v53, v55
    buffer_store_dwordx4 v[52:55], v3, s[16:19], s46 offen offset:32
    v_cvt_pk_bf16_f32 v44, v172, v173
    v_cvt_pk_bf16_f32 v45, v174, v175
    v_cvt_pk_bf16_f32 v46, v176, v177
    v_cvt_pk_bf16_f32 v47, v178, v179
    v_cvt_pk_bf16_f32 v48, v180, v181
    v_cvt_pk_bf16_f32 v49, v182, v183
    v_cvt_pk_bf16_f32 v50, v184, v185
    v_cvt_pk_bf16_f32 v51, v186, v187
    v_lshlrev_b32 v172, 16, v44
    v_and_b32 v173, 0xffff0000, v44
    v_lshlrev_b32 v174, 16, v45
    v_and_b32 v175, 0xffff0000, v45
    v_lshlrev_b32 v176, 16, v46
    v_and_b32 v177, 0xffff0000, v46
    v_lshlrev_b32 v178, 16, v47
    v_and_b32 v179, 0xffff0000, v47
    v_lshlrev_b32 v180, 16, v48
    v_and_b32 v181, 0xffff0000, v48
    v_lshlrev_b32 v182, 16, v49
    v_and_b32 v183, 0xffff0000, v49
    v_lshlrev_b32 v184, 16, v50
    v_and_b32 v185, 0xffff0000, v50
    v_lshlrev_b32 v186, 16, v51
    v_and_b32 v187, 0xffff0000, v51
    v_mul_f32 v172, v172, v180
    v_mul_f32 v173, v173, v181
    v_mul_f32 v174, v174, v182
    v_mul_f32 v175, v175, v183
    v_mul_f32 v176, v176, v184
    v_mul_f32 v177, v177, v185
    v_mul_f32 v178, v178, v186
    v_mul_f32 v179, v179, v187
    v_cvt_pk_bf16_f32 v56, v172, v173
    v_cvt_pk_bf16_f32 v57, v174, v175
    v_cvt_pk_bf16_f32 v58, v176, v177
    v_cvt_pk_bf16_f32 v59, v178, v179
    s_nop 1
    v_permlane32_swap_b32 v56, v58
    v_permlane32_swap_b32 v57, v59
    buffer_store_dwordx4 v[56:59], v3, s[16:19], s46 offen offset:64
gu_kernel_join:
gu_kernel_end:
    s_endpgm
.globl down_kernel
.p2align 8
.type down_kernel,@function
down_kernel:
    s_cmp_ge_u32 s2, 256
    s_cbranch_scc1 down_kernel_end
    s_load_dwordx2 s[4:5], s[0:1], 88
    s_load_dwordx2 s[6:7], s[0:1], 48
    s_load_dwordx2 s[34:35], s[0:1], 72
    v_lshrrev_b32 v1, 6, v0
    v_and_b32 v0, 63, v0
    s_nop 0
    v_readfirstlane_b32 s30, v1
    s_lshr_b32 s48, s30, 2
    s_and_b32 s30, s30, 3
    s_and_b32 s31, s2, 7
    s_lshr_b32 s36, s2, 3
    s_and_b32 s28, s31, 3
    s_lshr_b32 s29, s31, 2
    s_lshl_b32 s28, s28, 2
    s_and_b32 s37, s36, 3
    s_add_u32 s28, s28, s37
    s_lshl_b32 s29, s29, 3
    s_lshr_b32 s37, s36, 2
    s_add_u32 s29, s29, s37
    v_lshrrev_b32 v1, 3, v0
    v_and_b32 v2, 7, v0
    v_lshrrev_b32 v3, 1, v1
    v_xor_b32 v3, v3, v2
    v_xor_b32 v4, 4, v3
    s_mul_i32 s31, s30, 32
    s_mul_i32 s36, s28, 128
    s_add_u32 s36, s36, s31
    v_add_u32 v1, s36, v1
    s_mov_b32 s37, 7168
    v_mul_lo_u32 v1, v1, s37
    v_lshl_add_u32 v7, v3, 4, v1
    v_lshl_add_u32 v8, v4, 4, v1
    v_add_u32 v8, 57344, v8
    v_lshl_add_u32 v9, v3, 4, v1
    v_add_u32 v9, 114688, v9
    v_lshl_add_u32 v10, v4, 4, v1
    v_add_u32 v10, 172032, v10
    s_mov_b32 s31, s30
    s_mul_i32 s31, s31, 2
    s_mul_i32 s38, s29, 128
    s_mov_b32 s39, 16384
    s_add_u32 s37, s31, 0
    s_min_u32 s37, s37, 7
    s_lshl_b32 s50, s37, 10
    s_add_u32 s50, s50, s39
    s_lshl_b32 s37, s37, 6
    v_add_u32 v1, s37, v0
    v_mul_u32_u24 v2, 8192, v1
    v_lshrrev_b32 v2, 16, v2
    v_mul_u32_u24 v3, 8, v2
    v_sub_u32 v3, v1, v3
    v_lshlrev_b32 v4, 1, v2
    v_and_b32 v4, 4, v4
    v_xor_b32 v3, v3, v4
    v_mul_u32_u24 v2, 2048, v2
    v_lshl_add_u32 v2, v3, 4, v2
    v_add_u32 v11, s38, v2
    s_add_u32 s37, s31, 1
    s_min_u32 s37, s37, 7
    s_lshl_b32 s51, s37, 10
    s_add_u32 s51, s51, s39
    s_lshl_b32 s37, s37, 6
    v_add_u32 v1, s37, v0
    v_mul_u32_u24 v2, 8192, v1
    v_lshrrev_b32 v2, 16, v2
    v_mul_u32_u24 v3, 8, v2
    v_sub_u32 v3, v1, v3
    v_lshlrev_b32 v4, 1, v2
    v_and_b32 v4, 4, v4
    v_xor_b32 v3, v3, v4
    v_mul_u32_u24 v2, 2048, v2
    v_lshl_add_u32 v2, v3, 4, v2
    v_add_u32 v12, s38, v2
    s_mul_i32 s40, s30, 4096
    s_waitcnt lgkmcnt(0)
    s_add_u32 s8, s4, 30408704
    s_addc_u32 s9, s5, 0
    s_and_b32 s9, s9, 0xffff
    s_mov_b32 s10, 14680064
    s_mov_b32 s11, 0x00020000
    s_mov_b32 s12, s6
    s_and_b32 s13, s7, 0xffff
    s_mov_b32 s14, 7340032
    s_mov_b32 s15, 0x00020000
    s_cmp_eq_u32 s48, 0
    s_cbranch_scc1 down_kernel_compute
    s_mov_b32 s42, 0
    s_mov_b32 s43, 0
    s_add_u32 m0, s40, 0
    s_nop 0
    buffer_load_dwordx4 v7, s[8:11], s42 offen lds
    s_add_u32 m0, s40, 1024
    s_nop 0
    buffer_load_dwordx4 v8, s[8:11], s42 offen lds
    s_add_u32 m0, s40, 2048
    s_nop 0
    buffer_load_dwordx4 v9, s[8:11], s42 offen lds
    s_add_u32 m0, s40, 3072
    s_nop 0
    buffer_load_dwordx4 v10, s[8:11], s42 offen lds
    s_add_u32 m0, s50, 0
    s_nop 0
    buffer_load_dwordx4 v11, s[12:15], s43 offen lds
    s_add_u32 m0, s51, 0
    s_nop 0
    buffer_load_dwordx4 v12, s[12:15], s43 offen lds
    s_mov_b32 s42, 128
    s_mov_b32 s43, 131072
    s_add_u32 m0, s40, 24576
    s_nop 0
    buffer_load_dwordx4 v7, s[8:11], s42 offen lds
    s_add_u32 m0, s40, 25600
    s_nop 0
    buffer_load_dwordx4 v8, s[8:11], s42 offen lds
    s_add_u32 m0, s40, 26624
    s_nop 0
    buffer_load_dwordx4 v9, s[8:11], s42 offen lds
    s_add_u32 m0, s40, 27648
    s_nop 0
    buffer_load_dwordx4 v10, s[8:11], s42 offen lds
    s_add_u32 m0, s50, 24576
    s_nop 0
    buffer_load_dwordx4 v11, s[12:15], s43 offen lds
    s_add_u32 m0, s51, 24576
    s_nop 0
    buffer_load_dwordx4 v12, s[12:15], s43 offen lds
    s_mov_b32 s42, 256
    s_mov_b32 s43, 262144
    s_add_u32 m0, s40, 49152
    s_nop 0
    buffer_load_dwordx4 v7, s[8:11], s42 offen lds
    s_add_u32 m0, s40, 50176
    s_nop 0
    buffer_load_dwordx4 v8, s[8:11], s42 offen lds
    s_add_u32 m0, s40, 51200
    s_nop 0
    buffer_load_dwordx4 v9, s[8:11], s42 offen lds
    s_add_u32 m0, s40, 52224
    s_nop 0
    buffer_load_dwordx4 v10, s[8:11], s42 offen lds
    s_add_u32 m0, s50, 49152
    s_nop 0
    buffer_load_dwordx4 v11, s[12:15], s43 offen lds
    s_add_u32 m0, s51, 49152
    s_nop 0
    buffer_load_dwordx4 v12, s[12:15], s43 offen lds
    s_mov_b32 s42, 384
    s_mov_b32 s43, 393216
    s_add_u32 m0, s40, 73728
    s_nop 0
    buffer_load_dwordx4 v7, s[8:11], s42 offen lds
    s_add_u32 m0, s40, 74752
    s_nop 0
    buffer_load_dwordx4 v8, s[8:11], s42 offen lds
    s_add_u32 m0, s40, 75776
    s_nop 0
    buffer_load_dwordx4 v9, s[8:11], s42 offen lds
    s_add_u32 m0, s40, 76800
    s_nop 0
    buffer_load_dwordx4 v10, s[8:11], s42 offen lds
    s_add_u32 m0, s50, 73728
    s_nop 0
    buffer_load_dwordx4 v11, s[12:15], s43 offen lds
    s_add_u32 m0, s51, 73728
    s_nop 0
    buffer_load_dwordx4 v12, s[12:15], s43 offen lds
    s_waitcnt vmcnt(18)
    s_barrier
    s_mov_b32 s42, 512
    s_mov_b32 s43, 524288
    s_mov_b32 s47, 13
down_kernel_lloop:
    s_waitcnt vmcnt(12)
    s_barrier
    s_add_u32 m0, s40, 0
    s_nop 0
    buffer_load_dwordx4 v7, s[8:11], s42 offen lds
    s_add_u32 m0, s40, 1024
    s_nop 0
    buffer_load_dwordx4 v8, s[8:11], s42 offen lds
    s_add_u32 m0, s40, 2048
    s_nop 0
    buffer_load_dwordx4 v9, s[8:11], s42 offen lds
    s_add_u32 m0, s40, 3072
    s_nop 0
    buffer_load_dwordx4 v10, s[8:11], s42 offen lds
    s_add_u32 m0, s50, 0
    s_nop 0
    buffer_load_dwordx4 v11, s[12:15], s43 offen lds
    s_add_u32 m0, s51, 0
    s_nop 0
    buffer_load_dwordx4 v12, s[12:15], s43 offen lds
    s_add_u32 s42, s42, 128
    s_add_u32 s43, s43, 131072
    s_waitcnt vmcnt(12)
    s_barrier
    s_add_u32 m0, s40, 24576
    s_nop 0
    buffer_load_dwordx4 v7, s[8:11], s42 offen lds
    s_add_u32 m0, s40, 25600
    s_nop 0
    buffer_load_dwordx4 v8, s[8:11], s42 offen lds
    s_add_u32 m0, s40, 26624
    s_nop 0
    buffer_load_dwordx4 v9, s[8:11], s42 offen lds
    s_add_u32 m0, s40, 27648
    s_nop 0
    buffer_load_dwordx4 v10, s[8:11], s42 offen lds
    s_add_u32 m0, s50, 24576
    s_nop 0
    buffer_load_dwordx4 v11, s[12:15], s43 offen lds
    s_add_u32 m0, s51, 24576
    s_nop 0
    buffer_load_dwordx4 v12, s[12:15], s43 offen lds
    s_add_u32 s42, s42, 128
    s_add_u32 s43, s43, 131072
    s_waitcnt vmcnt(12)
    s_barrier
    s_add_u32 m0, s40, 49152
    s_nop 0
    buffer_load_dwordx4 v7, s[8:11], s42 offen lds
    s_add_u32 m0, s40, 50176
    s_nop 0
    buffer_load_dwordx4 v8, s[8:11], s42 offen lds
    s_add_u32 m0, s40, 51200
    s_nop 0
    buffer_load_dwordx4 v9, s[8:11], s42 offen lds
    s_add_u32 m0, s40, 52224
    s_nop 0
    buffer_load_dwordx4 v10, s[8:11], s42 offen lds
    s_add_u32 m0, s50, 49152
    s_nop 0
    buffer_load_dwordx4 v11, s[12:15], s43 offen lds
    s_add_u32 m0, s51, 49152
    s_nop 0
    buffer_load_dwordx4 v12, s[12:15], s43 offen lds
    s_add_u32 s42, s42, 128
    s_add_u32 s43, s43, 131072
    s_waitcnt vmcnt(12)
    s_barrier
    s_add_u32 m0, s40, 73728
    s_nop 0
    buffer_load_dwordx4 v7, s[8:11], s42 offen lds
    s_add_u32 m0, s40, 74752
    s_nop 0
    buffer_load_dwordx4 v8, s[8:11], s42 offen lds
    s_add_u32 m0, s40, 75776
    s_nop 0
    buffer_load_dwordx4 v9, s[8:11], s42 offen lds
    s_add_u32 m0, s40, 76800
    s_nop 0
    buffer_load_dwordx4 v10, s[8:11], s42 offen lds
    s_add_u32 m0, s50, 73728
    s_nop 0
    buffer_load_dwordx4 v11, s[12:15], s43 offen lds
    s_add_u32 m0, s51, 73728
    s_nop 0
    buffer_load_dwordx4 v12, s[12:15], s43 offen lds
    s_add_u32 s42, s42, 128
    s_add_u32 s43, s43, 131072
    s_sub_u32 s47, s47, 1
    s_cmp_lg_u32 s47, 0
    s_cbranch_scc1 down_kernel_lloop
    s_waitcnt vmcnt(12)
    s_barrier
    s_waitcnt vmcnt(6)
    s_barrier
    s_waitcnt vmcnt(0)
    s_barrier
    s_endpgm
down_kernel_compute:
    s_mov_b32 s16, s34
    s_and_b32 s17, s35, 0xffff
    s_mov_b32 s18, 4194304
    s_mov_b32 s19, 0x00020000
    s_add_u32 s20, s4, 22020096
    s_addc_u32 s21, s5, 0
    s_and_b32 s21, s21, 0xffff
    s_mov_b32 s22, 4194304
    s_mov_b32 s23, 0x00020000
    s_add_u32 s24, s4, 20480
    s_addc_u32 s25, s5, 0
    s_and_b32 s25, s25, 0xffff
    s_mov_b32 s26, 4096
    s_mov_b32 s27, 0x00020000
    s_lshr_b32 s44, s30, 1
    s_and_b32 s45, s30, 1
    v_and_b32 v1, 31, v0
    v_lshrrev_b32 v2, 5, v0
    v_bfe_u32 v3, v1, 1, 3
    v_xor_b32 v3, v3, v2
    s_mul_i32 s31, s44, 8192
    v_lshlrev_b32 v4, 7, v1
    v_lshl_add_u32 v4, v3, 4, v4
    v_add_u32 v4, s31, v4
    v_mov_b32 v13, v4
    v_xor_b32 v14, 32, v4
    v_xor_b32 v15, 64, v4
    v_xor_b32 v16, 96, v4
    v_add_u32 v17, 24576, v4
    v_xor_b32 v18, 32, v4
    v_add_u32 v18, 24576, v18
    v_xor_b32 v19, 64, v4
    v_add_u32 v19, 24576, v19
    v_xor_b32 v20, 96, v4
    v_add_u32 v20, 24576, v20
    v_add_u32 v21, 49152, v4
    v_xor_b32 v22, 32, v4
    v_add_u32 v22, 49152, v22
    v_xor_b32 v23, 64, v4
    v_add_u32 v23, 49152, v23
    v_xor_b32 v24, 96, v4
    v_add_u32 v24, 49152, v24
    v_add_u32 v25, 73728, v4
    v_xor_b32 v26, 32, v4
    v_add_u32 v26, 73728, v26
    v_xor_b32 v27, 64, v4
    v_add_u32 v27, 73728, v27
    v_xor_b32 v28, 96, v4
    v_add_u32 v28, 73728, v28
    v_and_b32 v1, 15, v0
    v_bfe_u32 v2, v0, 4, 1
    v_lshrrev_b32 v3, 5, v0
    v_lshrrev_b32 v4, 2, v1
    v_lshl_add_u32 v4, v3, 3, v4
    v_mul_u32_u24 v4, 128, v4
    v_and_b32 v3, 3, v1
    v_lshl_add_u32 v4, v3, 3, v4
    v_lshl_add_u32 v4, v2, 5, v4
    s_mul_i32 s31, s45, 64
    v_add_u32 v4, s31, v4
    v_lshlrev_b32 v3, 3, v1
    v_and_b32 v3, 64, v3
    v_xor_b32 v4, v4, v3
    v_add_u32 v29, 16384, v4
    v_add_u32 v30, 40960, v4
    v_add_u32 v31, 65536, v4
    v_add_u32 v32, 90112, v4
    v_mov_b32 v132, 0
    v_mov_b32 v133, 0
    v_mov_b32 v134, 0
    v_mov_b32 v135, 0
    v_mov_b32 v136, 0
    v_mov_b32 v137, 0
    v_mov_b32 v138, 0
    v_mov_b32 v139, 0
    v_mov_b32 v140, 0
    v_mov_b32 v141, 0
    v_mov_b32 v142, 0
    v_mov_b32 v143, 0
    v_mov_b32 v144, 0
    v_mov_b32 v145, 0
    v_mov_b32 v146, 0
    v_mov_b32 v147, 0
    v_mov_b32 v148, 0
    v_mov_b32 v149, 0
    v_mov_b32 v150, 0
    v_mov_b32 v151, 0
    v_mov_b32 v152, 0
    v_mov_b32 v153, 0
    v_mov_b32 v154, 0
    v_mov_b32 v155, 0
    v_mov_b32 v156, 0
    v_mov_b32 v157, 0
    v_mov_b32 v158, 0
    v_mov_b32 v159, 0
    v_mov_b32 v160, 0
    v_mov_b32 v161, 0
    v_mov_b32 v162, 0
    v_mov_b32 v163, 0
    s_barrier
    ds_read_b128 v[36:39], v13 offset:0
    ds_read_b128 v[40:43], v13 offset:4096
    ds_read_b64_tr_b16 v[44:45], v29 offset:0
    ds_read_b64_tr_b16 v[46:47], v29 offset:512
    ds_read_b128 v[48:51], v14 offset:0
    ds_read_b128 v[52:55], v14 offset:4096
    ds_read_b64_tr_b16 v[56:57], v29 offset:2048
    ds_read_b64_tr_b16 v[58:59], v29 offset:2560
    ds_read_b128 v[60:63], v15 offset:0
    ds_read_b128 v[64:67], v15 offset:4096
    ds_read_b64_tr_b16 v[68:69], v29 offset:4096
    ds_read_b64_tr_b16 v[70:71], v29 offset:4608
    ds_read_b128 v[72:75], v16 offset:0
    ds_read_b128 v[76:79], v16 offset:4096
    ds_read_b64_tr_b16 v[80:81], v29 offset:6144
    ds_read_b64_tr_b16 v[82:83], v29 offset:6656
    s_mov_b32 s42, 512
    s_mov_b32 s43, 524288
    s_mov_b32 s47, 13
.p2align 6
down_kernel_loop:
    s_waitcnt lgkmcnt(0)
    s_barrier
    v_mfma_f32_32x32x16_bf16 v[132:147], v[44:47], v[36:39], v[132:147]
    ds_read_b128 v[84:87], v17 offset:0
    ds_read_b128 v[88:91], v17 offset:4096
    v_mfma_f32_32x32x16_bf16 v[148:163], v[44:47], v[40:43], v[148:163]
    ds_read_b64_tr_b16 v[92:93], v30 offset:0
    ds_read_b64_tr_b16 v[94:95], v30 offset:512
    v_mfma_f32_32x32x16_bf16 v[132:147], v[56:59], v[48:51], v[132:147]
    ds_read_b128 v[96:99], v18 offset:0
    ds_read_b128 v[100:103], v18 offset:4096
    v_mfma_f32_32x32x16_bf16 v[148:163], v[56:59], v[52:55], v[148:163]
    ds_read_b64_tr_b16 v[104:105], v30 offset:2048
    ds_read_b64_tr_b16 v[106:107], v30 offset:2560
    v_mfma_f32_32x32x16_bf16 v[132:147], v[68:71], v[60:63], v[132:147]
    ds_read_b128 v[108:111], v19 offset:0
    ds_read_b128 v[112:115], v19 offset:4096
    v_mfma_f32_32x32x16_bf16 v[148:163], v[68:71], v[64:67], v[148:163]
    ds_read_b64_tr_b16 v[116:117], v30 offset:4096
    ds_read_b64_tr_b16 v[118:119], v30 offset:4608
    v_mfma_f32_32x32x16_bf16 v[132:147], v[80:83], v[72:75], v[132:147]
    ds_read_b128 v[120:123], v20 offset:0
    ds_read_b128 v[124:127], v20 offset:4096
    v_mfma_f32_32x32x16_bf16 v[148:163], v[80:83], v[76:79], v[148:163]
    ds_read_b64_tr_b16 v[128:129], v30 offset:6144
    ds_read_b64_tr_b16 v[130:131], v30 offset:6656
    s_waitcnt lgkmcnt(0)
    s_barrier
    v_mfma_f32_32x32x16_bf16 v[132:147], v[92:95], v[84:87], v[132:147]
    ds_read_b128 v[36:39], v21 offset:0
    ds_read_b128 v[40:43], v21 offset:4096
    v_mfma_f32_32x32x16_bf16 v[148:163], v[92:95], v[88:91], v[148:163]
    ds_read_b64_tr_b16 v[44:45], v31 offset:0
    ds_read_b64_tr_b16 v[46:47], v31 offset:512
    v_mfma_f32_32x32x16_bf16 v[132:147], v[104:107], v[96:99], v[132:147]
    ds_read_b128 v[48:51], v22 offset:0
    ds_read_b128 v[52:55], v22 offset:4096
    v_mfma_f32_32x32x16_bf16 v[148:163], v[104:107], v[100:103], v[148:163]
    ds_read_b64_tr_b16 v[56:57], v31 offset:2048
    ds_read_b64_tr_b16 v[58:59], v31 offset:2560
    v_mfma_f32_32x32x16_bf16 v[132:147], v[116:119], v[108:111], v[132:147]
    ds_read_b128 v[60:63], v23 offset:0
    ds_read_b128 v[64:67], v23 offset:4096
    v_mfma_f32_32x32x16_bf16 v[148:163], v[116:119], v[112:115], v[148:163]
    ds_read_b64_tr_b16 v[68:69], v31 offset:4096
    ds_read_b64_tr_b16 v[70:71], v31 offset:4608
    v_mfma_f32_32x32x16_bf16 v[132:147], v[128:131], v[120:123], v[132:147]
    ds_read_b128 v[72:75], v24 offset:0
    ds_read_b128 v[76:79], v24 offset:4096
    v_mfma_f32_32x32x16_bf16 v[148:163], v[128:131], v[124:127], v[148:163]
    ds_read_b64_tr_b16 v[80:81], v31 offset:6144
    ds_read_b64_tr_b16 v[82:83], v31 offset:6656
    s_waitcnt lgkmcnt(0)
    s_barrier
    v_mfma_f32_32x32x16_bf16 v[132:147], v[44:47], v[36:39], v[132:147]
    ds_read_b128 v[84:87], v25 offset:0
    ds_read_b128 v[88:91], v25 offset:4096
    v_mfma_f32_32x32x16_bf16 v[148:163], v[44:47], v[40:43], v[148:163]
    ds_read_b64_tr_b16 v[92:93], v32 offset:0
    ds_read_b64_tr_b16 v[94:95], v32 offset:512
    v_mfma_f32_32x32x16_bf16 v[132:147], v[56:59], v[48:51], v[132:147]
    ds_read_b128 v[96:99], v26 offset:0
    ds_read_b128 v[100:103], v26 offset:4096
    v_mfma_f32_32x32x16_bf16 v[148:163], v[56:59], v[52:55], v[148:163]
    ds_read_b64_tr_b16 v[104:105], v32 offset:2048
    ds_read_b64_tr_b16 v[106:107], v32 offset:2560
    v_mfma_f32_32x32x16_bf16 v[132:147], v[68:71], v[60:63], v[132:147]
    ds_read_b128 v[108:111], v27 offset:0
    ds_read_b128 v[112:115], v27 offset:4096
    v_mfma_f32_32x32x16_bf16 v[148:163], v[68:71], v[64:67], v[148:163]
    ds_read_b64_tr_b16 v[116:117], v32 offset:4096
    ds_read_b64_tr_b16 v[118:119], v32 offset:4608
    v_mfma_f32_32x32x16_bf16 v[132:147], v[80:83], v[72:75], v[132:147]
    ds_read_b128 v[120:123], v28 offset:0
    ds_read_b128 v[124:127], v28 offset:4096
    v_mfma_f32_32x32x16_bf16 v[148:163], v[80:83], v[76:79], v[148:163]
    ds_read_b64_tr_b16 v[128:129], v32 offset:6144
    ds_read_b64_tr_b16 v[130:131], v32 offset:6656
    s_waitcnt lgkmcnt(0)
    s_barrier
    v_mfma_f32_32x32x16_bf16 v[132:147], v[92:95], v[84:87], v[132:147]
    ds_read_b128 v[36:39], v13 offset:0
    ds_read_b128 v[40:43], v13 offset:4096
    v_mfma_f32_32x32x16_bf16 v[148:163], v[92:95], v[88:91], v[148:163]
    ds_read_b64_tr_b16 v[44:45], v29 offset:0
    ds_read_b64_tr_b16 v[46:47], v29 offset:512
    v_mfma_f32_32x32x16_bf16 v[132:147], v[104:107], v[96:99], v[132:147]
    ds_read_b128 v[48:51], v14 offset:0
    ds_read_b128 v[52:55], v14 offset:4096
    v_mfma_f32_32x32x16_bf16 v[148:163], v[104:107], v[100:103], v[148:163]
    ds_read_b64_tr_b16 v[56:57], v29 offset:2048
    ds_read_b64_tr_b16 v[58:59], v29 offset:2560
    v_mfma_f32_32x32x16_bf16 v[132:147], v[116:119], v[108:111], v[132:147]
    ds_read_b128 v[60:63], v15 offset:0
    ds_read_b128 v[64:67], v15 offset:4096
    v_mfma_f32_32x32x16_bf16 v[148:163], v[116:119], v[112:115], v[148:163]
    ds_read_b64_tr_b16 v[68:69], v29 offset:4096
    ds_read_b64_tr_b16 v[70:71], v29 offset:4608
    v_mfma_f32_32x32x16_bf16 v[132:147], v[128:131], v[120:123], v[132:147]
    ds_read_b128 v[72:75], v16 offset:0
    ds_read_b128 v[76:79], v16 offset:4096
    v_mfma_f32_32x32x16_bf16 v[148:163], v[128:131], v[124:127], v[148:163]
    ds_read_b64_tr_b16 v[80:81], v29 offset:6144
    ds_read_b64_tr_b16 v[82:83], v29 offset:6656
    s_sub_u32 s47, s47, 1
    s_cmp_lg_u32 s47, 0
    s_cbranch_scc1 down_kernel_loop
    s_waitcnt lgkmcnt(0)
    s_barrier
    v_mfma_f32_32x32x16_bf16 v[132:147], v[44:47], v[36:39], v[132:147]
    ds_read_b128 v[84:87], v17 offset:0
    ds_read_b128 v[88:91], v17 offset:4096
    v_mfma_f32_32x32x16_bf16 v[148:163], v[44:47], v[40:43], v[148:163]
    ds_read_b64_tr_b16 v[92:93], v30 offset:0
    ds_read_b64_tr_b16 v[94:95], v30 offset:512
    v_mfma_f32_32x32x16_bf16 v[132:147], v[56:59], v[48:51], v[132:147]
    ds_read_b128 v[96:99], v18 offset:0
    ds_read_b128 v[100:103], v18 offset:4096
    v_mfma_f32_32x32x16_bf16 v[148:163], v[56:59], v[52:55], v[148:163]
    ds_read_b64_tr_b16 v[104:105], v30 offset:2048
    ds_read_b64_tr_b16 v[106:107], v30 offset:2560
    v_mfma_f32_32x32x16_bf16 v[132:147], v[68:71], v[60:63], v[132:147]
    ds_read_b128 v[108:111], v19 offset:0
    ds_read_b128 v[112:115], v19 offset:4096
    v_mfma_f32_32x32x16_bf16 v[148:163], v[68:71], v[64:67], v[148:163]
    ds_read_b64_tr_b16 v[116:117], v30 offset:4096
    ds_read_b64_tr_b16 v[118:119], v30 offset:4608
    v_mfma_f32_32x32x16_bf16 v[132:147], v[80:83], v[72:75], v[132:147]
    ds_read_b128 v[120:123], v20 offset:0
    ds_read_b128 v[124:127], v20 offset:4096
    v_mfma_f32_32x32x16_bf16 v[148:163], v[80:83], v[76:79], v[148:163]
    ds_read_b64_tr_b16 v[128:129], v30 offset:6144
    ds_read_b64_tr_b16 v[130:131], v30 offset:6656
    s_waitcnt lgkmcnt(0)
    s_barrier
    v_mfma_f32_32x32x16_bf16 v[132:147], v[92:95], v[84:87], v[132:147]
    ds_read_b128 v[36:39], v21 offset:0
    ds_read_b128 v[40:43], v21 offset:4096
    v_mfma_f32_32x32x16_bf16 v[148:163], v[92:95], v[88:91], v[148:163]
    ds_read_b64_tr_b16 v[44:45], v31 offset:0
    ds_read_b64_tr_b16 v[46:47], v31 offset:512
    v_mfma_f32_32x32x16_bf16 v[132:147], v[104:107], v[96:99], v[132:147]
    ds_read_b128 v[48:51], v22 offset:0
    ds_read_b128 v[52:55], v22 offset:4096
    v_mfma_f32_32x32x16_bf16 v[148:163], v[104:107], v[100:103], v[148:163]
    ds_read_b64_tr_b16 v[56:57], v31 offset:2048
    ds_read_b64_tr_b16 v[58:59], v31 offset:2560
    v_mfma_f32_32x32x16_bf16 v[132:147], v[116:119], v[108:111], v[132:147]
    ds_read_b128 v[60:63], v23 offset:0
    ds_read_b128 v[64:67], v23 offset:4096
    v_mfma_f32_32x32x16_bf16 v[148:163], v[116:119], v[112:115], v[148:163]
    ds_read_b64_tr_b16 v[68:69], v31 offset:4096
    ds_read_b64_tr_b16 v[70:71], v31 offset:4608
    v_mfma_f32_32x32x16_bf16 v[132:147], v[128:131], v[120:123], v[132:147]
    ds_read_b128 v[72:75], v24 offset:0
    ds_read_b128 v[76:79], v24 offset:4096
    v_mfma_f32_32x32x16_bf16 v[148:163], v[128:131], v[124:127], v[148:163]
    ds_read_b64_tr_b16 v[80:81], v31 offset:6144
    ds_read_b64_tr_b16 v[82:83], v31 offset:6656
    s_waitcnt lgkmcnt(0)
    s_barrier
    v_mfma_f32_32x32x16_bf16 v[132:147], v[44:47], v[36:39], v[132:147]
    ds_read_b128 v[84:87], v25 offset:0
    ds_read_b128 v[88:91], v25 offset:4096
    v_mfma_f32_32x32x16_bf16 v[148:163], v[44:47], v[40:43], v[148:163]
    ds_read_b64_tr_b16 v[92:93], v32 offset:0
    ds_read_b64_tr_b16 v[94:95], v32 offset:512
    v_mfma_f32_32x32x16_bf16 v[132:147], v[56:59], v[48:51], v[132:147]
    ds_read_b128 v[96:99], v26 offset:0
    ds_read_b128 v[100:103], v26 offset:4096
    v_mfma_f32_32x32x16_bf16 v[148:163], v[56:59], v[52:55], v[148:163]
    ds_read_b64_tr_b16 v[104:105], v32 offset:2048
    ds_read_b64_tr_b16 v[106:107], v32 offset:2560
    v_mfma_f32_32x32x16_bf16 v[132:147], v[68:71], v[60:63], v[132:147]
    ds_read_b128 v[108:111], v27 offset:0
    ds_read_b128 v[112:115], v27 offset:4096
    v_mfma_f32_32x32x16_bf16 v[148:163], v[68:71], v[64:67], v[148:163]
    ds_read_b64_tr_b16 v[116:117], v32 offset:4096
    ds_read_b64_tr_b16 v[118:119], v32 offset:4608
    v_mfma_f32_32x32x16_bf16 v[132:147], v[80:83], v[72:75], v[132:147]
    ds_read_b128 v[120:123], v28 offset:0
    ds_read_b128 v[124:127], v28 offset:4096
    v_mfma_f32_32x32x16_bf16 v[148:163], v[80:83], v[76:79], v[148:163]
    ds_read_b64_tr_b16 v[128:129], v32 offset:6144
    ds_read_b64_tr_b16 v[130:131], v32 offset:6656
    s_waitcnt lgkmcnt(0)
    v_mfma_f32_32x32x16_bf16 v[132:147], v[92:95], v[84:87], v[132:147]
    v_mfma_f32_32x32x16_bf16 v[148:163], v[92:95], v[88:91], v[148:163]
    v_mfma_f32_32x32x16_bf16 v[132:147], v[104:107], v[96:99], v[132:147]
    v_mfma_f32_32x32x16_bf16 v[148:163], v[104:107], v[100:103], v[148:163]
    v_mfma_f32_32x32x16_bf16 v[132:147], v[116:119], v[108:111], v[132:147]
    v_mfma_f32_32x32x16_bf16 v[148:163], v[116:119], v[112:115], v[148:163]
    v_mfma_f32_32x32x16_bf16 v[132:147], v[128:131], v[120:123], v[132:147]
    v_mfma_f32_32x32x16_bf16 v[148:163], v[128:131], v[124:127], v[148:163]
    v_and_b32 v1, 31, v0
    v_lshrrev_b32 v2, 5, v0
    s_mul_i32 s36, s28, 128
    s_mul_i32 s31, s44, 64
    s_add_u32 s36, s36, s31
    v_add_u32 v1, s36, v1
    s_mul_i32 s37, s29, 64
    s_lshl_b32 s31, s45, 5
    s_add_u32 s37, s37, s31
    v_lshlrev_b32 v3, 11, v1
    v_lshl_add_u32 v3, v2, 4, v3
    s_lshl_b32 s31, s37, 1
    v_add_u32 v3, s31, v3
    s_lshl_b32 s31, s37, 2
    v_lshlrev_b32 v4, 5, v2
    v_add_u32 v4, s31, v4
    s_mov_b32 s46, 65536
    s_nop 15
    buffer_load_dwordx4 v[68:71], v4, s[24:27], 0 offen offset:0
    buffer_load_dwordx4 v[72:75], v4, s[24:27], 0 offen offset:16
    buffer_load_dwordx4 v[76:79], v4, s[24:27], 0 offen offset:64
    buffer_load_dwordx4 v[80:83], v4, s[24:27], 0 offen offset:80
    buffer_load_dwordx4 v[84:87], v3, s[20:23], 0 offen offset:0
    buffer_load_dwordx4 v[88:91], v3, s[20:23], 0 offen offset:32
    buffer_load_dwordx4 v[92:95], v3, s[20:23], s46 offen offset:0
    buffer_load_dwordx4 v[96:99], v3, s[20:23], s46 offen offset:32
    v_cvt_pk_bf16_f32 v52, v132, v133
    v_cvt_pk_bf16_f32 v53, v134, v135
    v_cvt_pk_bf16_f32 v54, v136, v137
    v_cvt_pk_bf16_f32 v55, v138, v139
    v_cvt_pk_bf16_f32 v56, v140, v141
    v_cvt_pk_bf16_f32 v57, v142, v143
    v_cvt_pk_bf16_f32 v58, v144, v145
    v_cvt_pk_bf16_f32 v59, v146, v147
    s_nop 1
    v_permlane32_swap_b32 v52, v54
    v_permlane32_swap_b32 v53, v55
    v_permlane32_swap_b32 v56, v58
    v_permlane32_swap_b32 v57, v59
    s_waitcnt vmcnt(0)
    v_lshlrev_b32 v36, 16, v52
    v_and_b32 v37, 0xffff0000, v52
    v_mul_f32 v36, v68, v36
    v_mul_f32 v37, v69, v37
    v_cvt_pk_bf16_f32 v52, v36, v37
    v_lshlrev_b32 v36, 16, v52
    v_and_b32 v37, 0xffff0000, v52
    v_lshlrev_b32 v38, 16, v84
    v_and_b32 v39, 0xffff0000, v84
    v_add_f32 v36, v36, v38
    v_add_f32 v37, v37, v39
    v_cvt_pk_bf16_f32 v84, v36, v37
    v_lshlrev_b32 v36, 16, v53
    v_and_b32 v37, 0xffff0000, v53
    v_mul_f32 v36, v70, v36
    v_mul_f32 v37, v71, v37
    v_cvt_pk_bf16_f32 v53, v36, v37
    v_lshlrev_b32 v36, 16, v53
    v_and_b32 v37, 0xffff0000, v53
    v_lshlrev_b32 v38, 16, v85
    v_and_b32 v39, 0xffff0000, v85
    v_add_f32 v36, v36, v38
    v_add_f32 v37, v37, v39
    v_cvt_pk_bf16_f32 v85, v36, v37
    v_lshlrev_b32 v36, 16, v54
    v_and_b32 v37, 0xffff0000, v54
    v_mul_f32 v36, v72, v36
    v_mul_f32 v37, v73, v37
    v_cvt_pk_bf16_f32 v54, v36, v37
    v_lshlrev_b32 v36, 16, v54
    v_and_b32 v37, 0xffff0000, v54
    v_lshlrev_b32 v38, 16, v86
    v_and_b32 v39, 0xffff0000, v86
    v_add_f32 v36, v36, v38
    v_add_f32 v37, v37, v39
    v_cvt_pk_bf16_f32 v86, v36, v37
    v_lshlrev_b32 v36, 16, v55
    v_and_b32 v37, 0xffff0000, v55
    v_mul_f32 v36, v74, v36
    v_mul_f32 v37, v75, v37
    v_cvt_pk_bf16_f32 v55, v36, v37
    v_lshlrev_b32 v36, 16, v55
    v_and_b32 v37, 0xffff0000, v55
    v_lshlrev_b32 v38, 16, v87
    v_and_b32 v39, 0xffff0000, v87
    v_add_f32 v36, v36, v38
    v_add_f32 v37, v37, v39
    v_cvt_pk_bf16_f32 v87, v36, v37
    buffer_store_dwordx4 v[84:87], v3, s[16:19], 0 offen offset:0
    v_lshlrev_b32 v36, 16, v56
    v_and_b32 v37, 0xffff0000, v56
    v_mul_f32 v36, v76, v36
    v_mul_f32 v37, v77, v37
    v_cvt_pk_bf16_f32 v56, v36, v37
    v_lshlrev_b32 v36, 16, v56
    v_and_b32 v37, 0xffff0000, v56
    v_lshlrev_b32 v38, 16, v88
    v_and_b32 v39, 0xffff0000, v88
    v_add_f32 v36, v36, v38
    v_add_f32 v37, v37, v39
    v_cvt_pk_bf16_f32 v88, v36, v37
    v_lshlrev_b32 v36, 16, v57
    v_and_b32 v37, 0xffff0000, v57
    v_mul_f32 v36, v78, v36
    v_mul_f32 v37, v79, v37
    v_cvt_pk_bf16_f32 v57, v36, v37
    v_lshlrev_b32 v36, 16, v57
    v_and_b32 v37, 0xffff0000, v57
    v_lshlrev_b32 v38, 16, v89
    v_and_b32 v39, 0xffff0000, v89
    v_add_f32 v36, v36, v38
    v_add_f32 v37, v37, v39
    v_cvt_pk_bf16_f32 v89, v36, v37
    v_lshlrev_b32 v36, 16, v58
    v_and_b32 v37, 0xffff0000, v58
    v_mul_f32 v36, v80, v36
    v_mul_f32 v37, v81, v37
    v_cvt_pk_bf16_f32 v58, v36, v37
    v_lshlrev_b32 v36, 16, v58
    v_and_b32 v37, 0xffff0000, v58
    v_lshlrev_b32 v38, 16, v90
    v_and_b32 v39, 0xffff0000, v90
    v_add_f32 v36, v36, v38
    v_add_f32 v37, v37, v39
    v_cvt_pk_bf16_f32 v90, v36, v37
    v_lshlrev_b32 v36, 16, v59
    v_and_b32 v37, 0xffff0000, v59
    v_mul_f32 v36, v82, v36
    v_mul_f32 v37, v83, v37
    v_cvt_pk_bf16_f32 v59, v36, v37
    v_lshlrev_b32 v36, 16, v59
    v_and_b32 v37, 0xffff0000, v59
    v_lshlrev_b32 v38, 16, v91
    v_and_b32 v39, 0xffff0000, v91
    v_add_f32 v36, v36, v38
    v_add_f32 v37, v37, v39
    v_cvt_pk_bf16_f32 v91, v36, v37
    buffer_store_dwordx4 v[88:91], v3, s[16:19], 0 offen offset:32
    v_cvt_pk_bf16_f32 v52, v148, v149
    v_cvt_pk_bf16_f32 v53, v150, v151
    v_cvt_pk_bf16_f32 v54, v152, v153
    v_cvt_pk_bf16_f32 v55, v154, v155
    v_cvt_pk_bf16_f32 v56, v156, v157
    v_cvt_pk_bf16_f32 v57, v158, v159
    v_cvt_pk_bf16_f32 v58, v160, v161
    v_cvt_pk_bf16_f32 v59, v162, v163
    s_nop 1
    v_permlane32_swap_b32 v52, v54
    v_permlane32_swap_b32 v53, v55
    v_permlane32_swap_b32 v56, v58
    v_permlane32_swap_b32 v57, v59
    v_lshlrev_b32 v36, 16, v52
    v_and_b32 v37, 0xffff0000, v52
    v_mul_f32 v36, v68, v36
    v_mul_f32 v37, v69, v37
    v_cvt_pk_bf16_f32 v52, v36, v37
    v_lshlrev_b32 v36, 16, v52
    v_and_b32 v37, 0xffff0000, v52
    v_lshlrev_b32 v38, 16, v92
    v_and_b32 v39, 0xffff0000, v92
    v_add_f32 v36, v36, v38
    v_add_f32 v37, v37, v39
    v_cvt_pk_bf16_f32 v92, v36, v37
    v_lshlrev_b32 v36, 16, v53
    v_and_b32 v37, 0xffff0000, v53
    v_mul_f32 v36, v70, v36
    v_mul_f32 v37, v71, v37
    v_cvt_pk_bf16_f32 v53, v36, v37
    v_lshlrev_b32 v36, 16, v53
    v_and_b32 v37, 0xffff0000, v53
    v_lshlrev_b32 v38, 16, v93
    v_and_b32 v39, 0xffff0000, v93
    v_add_f32 v36, v36, v38
    v_add_f32 v37, v37, v39
    v_cvt_pk_bf16_f32 v93, v36, v37
    v_lshlrev_b32 v36, 16, v54
    v_and_b32 v37, 0xffff0000, v54
    v_mul_f32 v36, v72, v36
    v_mul_f32 v37, v73, v37
    v_cvt_pk_bf16_f32 v54, v36, v37
    v_lshlrev_b32 v36, 16, v54
    v_and_b32 v37, 0xffff0000, v54
    v_lshlrev_b32 v38, 16, v94
    v_and_b32 v39, 0xffff0000, v94
    v_add_f32 v36, v36, v38
    v_add_f32 v37, v37, v39
    v_cvt_pk_bf16_f32 v94, v36, v37
    v_lshlrev_b32 v36, 16, v55
    v_and_b32 v37, 0xffff0000, v55
    v_mul_f32 v36, v74, v36
    v_mul_f32 v37, v75, v37
    v_cvt_pk_bf16_f32 v55, v36, v37
    v_lshlrev_b32 v36, 16, v55
    v_and_b32 v37, 0xffff0000, v55
    v_lshlrev_b32 v38, 16, v95
    v_and_b32 v39, 0xffff0000, v95
    v_add_f32 v36, v36, v38
    v_add_f32 v37, v37, v39
    v_cvt_pk_bf16_f32 v95, v36, v37
    buffer_store_dwordx4 v[92:95], v3, s[16:19], s46 offen offset:0
    v_lshlrev_b32 v36, 16, v56
    v_and_b32 v37, 0xffff0000, v56
    v_mul_f32 v36, v76, v36
    v_mul_f32 v37, v77, v37
    v_cvt_pk_bf16_f32 v56, v36, v37
    v_lshlrev_b32 v36, 16, v56
    v_and_b32 v37, 0xffff0000, v56
    v_lshlrev_b32 v38, 16, v96
    v_and_b32 v39, 0xffff0000, v96
    v_add_f32 v36, v36, v38
    v_add_f32 v37, v37, v39
    v_cvt_pk_bf16_f32 v96, v36, v37
    v_lshlrev_b32 v36, 16, v57
    v_and_b32 v37, 0xffff0000, v57
    v_mul_f32 v36, v78, v36
    v_mul_f32 v37, v79, v37
    v_cvt_pk_bf16_f32 v57, v36, v37
    v_lshlrev_b32 v36, 16, v57
    v_and_b32 v37, 0xffff0000, v57
    v_lshlrev_b32 v38, 16, v97
    v_and_b32 v39, 0xffff0000, v97
    v_add_f32 v36, v36, v38
    v_add_f32 v37, v37, v39
    v_cvt_pk_bf16_f32 v97, v36, v37
    v_lshlrev_b32 v36, 16, v58
    v_and_b32 v37, 0xffff0000, v58
    v_mul_f32 v36, v80, v36
    v_mul_f32 v37, v81, v37
    v_cvt_pk_bf16_f32 v58, v36, v37
    v_lshlrev_b32 v36, 16, v58
    v_and_b32 v37, 0xffff0000, v58
    v_lshlrev_b32 v38, 16, v98
    v_and_b32 v39, 0xffff0000, v98
    v_add_f32 v36, v36, v38
    v_add_f32 v37, v37, v39
    v_cvt_pk_bf16_f32 v98, v36, v37
    v_lshlrev_b32 v36, 16, v59
    v_and_b32 v37, 0xffff0000, v59
    v_mul_f32 v36, v82, v36
    v_mul_f32 v37, v83, v37
    v_cvt_pk_bf16_f32 v59, v36, v37
    v_lshlrev_b32 v36, 16, v59
    v_and_b32 v37, 0xffff0000, v59
    v_lshlrev_b32 v38, 16, v99
    v_and_b32 v39, 0xffff0000, v99
    v_add_f32 v36, v36, v38
    v_add_f32 v37, v37, v39
    v_cvt_pk_bf16_f32 v99, v36, v37
    buffer_store_dwordx4 v[96:99], v3, s[16:19], s46 offen offset:32
down_kernel_end:
    s_endpgm
.section .rodata,"a"
.p2align 6
.amdhsa_kernel mod_kernel
  .amdhsa_next_free_vgpr 104
  .amdhsa_next_free_sgpr 96
  .amdhsa_accum_offset 104
  .amdhsa_group_segment_fixed_size 0
  .amdhsa_kernarg_size 96
  .amdhsa_user_sgpr_count 2
  .amdhsa_user_sgpr_kernarg_segment_ptr 1
  .amdhsa_system_sgpr_workgroup_id_x 1
  .amdhsa_float_denorm_mode_32 3
  .amdhsa_float_denorm_mode_16_64 3
.end_amdhsa_kernel
.p2align 6
.amdhsa_kernel ln1_kernel
  .amdhsa_next_free_vgpr 80
  .amdhsa_next_free_sgpr 96
  .amdhsa_accum_offset 80
  .amdhsa_group_segment_fixed_size 0
  .amdhsa_kernarg_size 96
  .amdhsa_user_sgpr_count 2
  .amdhsa_user_sgpr_kernarg_segment_ptr 1
  .amdhsa_system_sgpr_workgroup_id_x 1
  .amdhsa_float_denorm_mode_32 3
  .amdhsa_float_denorm_mode_16_64 3
.end_amdhsa_kernel
.p2align 6
.amdhsa_kernel qkv_kernel
  .amdhsa_next_free_vgpr 140
  .amdhsa_next_free_sgpr 96
  .amdhsa_accum_offset 140
  .amdhsa_group_segment_fixed_size 0
  .amdhsa_kernarg_size 96
  .amdhsa_user_sgpr_count 2
  .amdhsa_user_sgpr_kernarg_segment_ptr 1
  .amdhsa_system_sgpr_workgroup_id_x 1
  .amdhsa_float_denorm_mode_32 3
  .amdhsa_float_denorm_mode_16_64 3
.end_amdhsa_kernel
.p2align 6
.amdhsa_kernel attn_kernel
  .amdhsa_next_free_vgpr 172
  .amdhsa_next_free_sgpr 96
  .amdhsa_accum_offset 172
  .amdhsa_group_segment_fixed_size 0
  .amdhsa_kernarg_size 96
  .amdhsa_user_sgpr_count 2
  .amdhsa_user_sgpr_kernarg_segment_ptr 1
  .amdhsa_system_sgpr_workgroup_id_x 1
  .amdhsa_float_denorm_mode_32 3
  .amdhsa_float_denorm_mode_16_64 3
.end_amdhsa_kernel
.p2align 6
.amdhsa_kernel wo_kernel
  .amdhsa_next_free_vgpr 164
  .amdhsa_next_free_sgpr 96
  .amdhsa_accum_offset 164
  .amdhsa_group_segment_fixed_size 0
  .amdhsa_kernarg_size 96
  .amdhsa_user_sgpr_count 2
  .amdhsa_user_sgpr_kernarg_segment_ptr 1
  .amdhsa_system_sgpr_workgroup_id_x 1
  .amdhsa_float_denorm_mode_32 3
  .amdhsa_float_denorm_mode_16_64 3
.end_amdhsa_kernel
.p2align 6
.amdhsa_kernel ln2_kernel
  .amdhsa_next_free_vgpr 64
  .amdhsa_next_free_sgpr 96
  .amdhsa_accum_offset 64
  .amdhsa_group_segment_fixed_size 0
  .amdhsa_kernarg_size 96
  .amdhsa_user_sgpr_count 2
  .amdhsa_user_sgpr_kernarg_segment_ptr 1
  .amdhsa_system_sgpr_workgroup_id_x 1
  .amdhsa_float_denorm_mode_32 3
  .amdhsa_float_denorm_mode_16_64 3
.end_amdhsa_kernel
.p2align 6
.amdhsa_kernel gu_kernel
  .amdhsa_next_free_vgpr 204
  .amdhsa_next_free_sgpr 96
  .amdhsa_accum_offset 204
  .amdhsa_group_segment_fixed_size 0
  .amdhsa_kernarg_size 96
  .amdhsa_user_sgpr_count 2
  .amdhsa_user_sgpr_kernarg_segment_ptr 1
  .amdhsa_system_sgpr_workgroup_id_x 1
  .amdhsa_float_denorm_mode_32 3
  .amdhsa_float_denorm_mode_16_64 3
.end_amdhsa_kernel
.p2align 6
.amdhsa_kernel down_kernel
  .amdhsa_next_free_vgpr 164
  .amdhsa_next_free_sgpr 96
  .amdhsa_accum_offset 164
  .amdhsa_group_segment_fixed_size 0
  .amdhsa_kernarg_size 96
  .amdhsa_user_sgpr_count 2
  .amdhsa_user_sgpr_kernarg_segment_ptr 1
  .amdhsa_system_sgpr_workgroup_id_x 1
  .amdhsa_float_denorm_mode_32 3
  .amdhsa_float_denorm_mode_16_64 3
.end_amdhsa_kernel
```
